```python
import torch

def _softmax(x, axis=-1):
    return torch.softmax(x, dim=axis)
def _gelu(x):
    return torch.nn.functional.gelu(x, approximate="tanh")
def _silu(x):
    return torch.nn.functional.silu(x)
def _sigmoid(x):
    return torch.sigmoid(x)
def _layernorm(x, axis=-1, eps=1e-5):
    m = x.mean(dim=axis, keepdim=True)
    v = x.var(dim=axis, keepdim=True, unbiased=False)
    return (x - m) / torch.sqrt(v + eps)
def _scatter_add(tgt, idx, src, axis=0):
    return tgt.clone().index_add_(axis, idx, src)
def _segment_sum(src, seg, n):
    out = torch.zeros((n,) + src.shape[1:], dtype=src.dtype)
    return out.index_add_(0, seg, src)
def _pad(x, pw):
    flat = tuple(v for pair in reversed(pw) for v in pair)
    return torch.nn.functional.pad(x, flat)

kernel_name = 'interleave_layers__linear_kernel_hedgehog__sliding_block__prompt'

def setup_inputs():

    _w = (lambda a: (lambda t: t.to(torch.bfloat16) if t.is_floating_point() else t)(torch.as_tensor(a)))
    def _A_setup():
        B, S, D, H = 1, 2048, 448, 16
        Dh = D // H
        return {
            "x": _w((lambda *s: torch.randn(*s, dtype=torch.bfloat16) * 0.05)(B, S, D)),
            "wqkv": _w((lambda *s: torch.randn(*s, dtype=torch.bfloat16) * 0.4)(D, 3 * D)),
            "w_phi": _w((lambda *s: torch.randn(*s, dtype=torch.bfloat16) * 0.4)(H, Dh, Dh) * (Dh ** -0.5)),
            "wo": _w((lambda *s: torch.randn(*s, dtype=torch.bfloat16) * 0.05)(D, D)),
        }
    _A_in = _A_setup()

    def _B_setup():
        B, S, D = 1, 2048, 448
        return {
            "x": _w((lambda *s: torch.randn(*s, dtype=torch.bfloat16) * 0.05)(B, S, D)),
            "wqkv": _w((lambda *s: torch.randn(*s, dtype=torch.bfloat16) * 0.1)(D, 3 * D)),
            "wo": _w((lambda *s: torch.randn(*s, dtype=torch.bfloat16) * 0.05)(D, D)),
        }
    _B_in = _B_setup()

    return {
        "A_x": _A_in["x"],
        "A_wqkv": _A_in["wqkv"],
        "A_w_phi": _A_in["w_phi"],
        "A_wo": _A_in["wo"],
        "B_x": _B_in["x"],
        "B_wqkv": _B_in["wqkv"],
        "B_wo": _B_in["wo"],
    }

def reference(A_x, A_wqkv, A_w_phi, A_wo, B_x, B_wqkv, B_wo):
    def _A_ref(x, wqkv, w_phi, wo):
        B, S, D = x.shape
        H = 16; Dh = D // H
        qkv = (lambda x, *d: x.permute(*d))((x @ wqkv).reshape(B, S, 3, H, Dh), 2, 0, 3, 1, 4)
        q, k, v = qkv[0], qkv[1], qkv[2]
        pq = torch.einsum("bhsd,hdf->bhsf", q, w_phi)
        pk = torch.einsum("bhsd,hdf->bhsf", k, w_phi)
        phi_q = torch.concatenate([_softmax(pq, axis=-1), _softmax(-pq, axis=-1)], axis=-1)
        phi_k = torch.concatenate([_softmax(pk, axis=-1), _softmax(-pk, axis=-1)], axis=-1)
        kv = torch.einsum("bhsf,bhsd->bhfd", phi_k, v)
        z  = torch.einsum("bhsf->bhf", phi_k)
        num = torch.einsum("bhqf,bhfd->bhqd", phi_q, kv)
        den = torch.einsum("bhqf,bhf->bhq", phi_q, z)[..., None] + 1e-6
        o = num / den
        return (lambda x, *d: x.permute(*d))(o, 0, 2, 1, 3).reshape(B, S, D) @ wo

    def _B_ref(x, wqkv, wo):
        B, S, D = x.shape
        H = 16; Dh = D // H; W = 256
        qkv = (lambda x, *d: x.permute(*d))((x @ wqkv).reshape(B, S, 3, H, Dh), 2, 0, 3, 1, 4)
        q, k, v = qkv[0], qkv[1], qkv[2]
        scores = torch.einsum("bhqd,bhkd->bhqk", q, k) * (Dh ** -0.5)
        idx = torch.arange(S)
        mask = (idx[:, None] - idx[None, :] >= 0) & (idx[:, None] - idx[None, :] < W)
        scores = torch.where(mask[None, None], scores, -1e9)
        p = _softmax(scores, axis=-1)
        o = torch.einsum("bhqk,bhkd->bhqd", p, v)
        return (lambda x, *d: x.permute(*d))(o, 0, 2, 1, 3).reshape(B, S, D) @ wo

    x = A_x
    x = x + _A_ref(_layernorm(x, axis=-1), A_wqkv, A_w_phi, A_wo)
    x = x + _B_ref(_layernorm(x, axis=-1), B_wqkv, B_wo)
    x = x + _A_ref(_layernorm(x, axis=-1), A_wqkv, A_w_phi, A_wo)
    x = x + _B_ref(_layernorm(x, axis=-1), B_wqkv, B_wo)
    return x
```

```asm
; @launch grid=(256,1,1) block=(256,1,1) lds=163840
.amdgcn_target "amdgcn-amd-amdhsa--gfx950"
.text
.globl interleave_layers__linear_kernel_hedgehog__sliding_block__prompt_kernel
.p2align 8
.type interleave_layers__linear_kernel_hedgehog__sliding_block__prompt_kernel,@function
interleave_layers__linear_kernel_hedgehog__sliding_block__prompt_kernel:
Lstart:
    s_load_dwordx2 s[16:17], s[0:1], 8
    s_load_dwordx2 s[28:29], s[0:1], 24
    s_load_dwordx16 s[64:79], s[0:1], 0
    s_load_dwordx4 s[80:83], s[0:1], 64
    s_getpc_b64 s[4:5]
Lpc:
    s_memrealtime s[90:91]
    s_cmp_ge_u32 s2, 256
    s_cbranch_scc1 Lend
    s_lshr_b32 s6, s2, 3
    s_sub_u32 s44, s4, Lpc-Lstart
    s_subb_u32 s5, s5, 0
    s_and_b32 s45, s5, 0xffff
    s_mov_b32 s46, Lcode_end-Lstart
    s_mov_b32 s47, 0x20000
    v_lshrrev_b32 v1, 6, v0
    v_and_b32 v0, 63, v0
    v_readfirstlane_b32 s50, v1
    s_lshl_b32 s3, s6, 11
    v_lshlrev_b32 v2, 5, v0
    s_cmp_lg_u32 s50, 3
    s_nop 0
    s_cbranch_scc1 Lcp_1
    buffer_load_dword v240, v2, s[44:47], s3 offen
Lcp_1:
    s_and_b32 s49, s6, 15
    s_and_b32 s3, s2, 7
    s_lshr_b32 s7, s6, 4
    s_lshl_b32 s3, s3, 1
    s_add_u32 s48, s3, s7
    v_and_b32 v59, 3, v0
    v_lshrrev_b32_e64 v58, 2, v0
    v_mul_u32_u24 v98, 2688, v58
    v_lshl_add_u32 v98, v59, 4, v98
    v_mul_u32_u24 v97, 896, v58
    v_lshl_add_u32 v97, v59, 4, v97
    v_mul_u32_u24 v96, 56, v58
    v_lshl_add_u32 v96, v59, 4, v96
    v_lshlrev_b32 v1, 4, v0
    s_lshl_b32 s87, s48, 2
    s_add_u32 s87, s87, s50
    s_lshl_b32 s101, s48, 4
    s_add_u32 s101, s101, s49
    s_and_b32 s100, s101, 3
    s_lshl_b32 s100, s100, 2
    s_add_u32 s100, s100, s50
    s_nop 0
    s_mov_b32 s18, 1204224
    s_mov_b32 s19, 0x20000
    s_mov_b32 s30, 401408
    s_mov_b32 s31, 0x20000
    s_mul_i32 s61, s50, 7168
    s_add_u32 s61, s61, 114688
    s_lshr_b32 s57, s101, 2
    s_cmp_ge_u32 s57, 28
    s_cselect_b32 s58, 1, 0
    s_cmp_ge_u32 s57, 56
    s_cselect_b32 s58, 2, s58
    s_mul_i32 s59, s58, 28
    s_sub_u32 s59, s57, s59
    s_mul_i32 s59, s59, 43008
    s_add_u32 s58, s58, 1
    s_cmp_eq_u32 s58, 3
    s_cselect_b32 s58, 0, s58
    s_mul_i32 s58, s58, 896
    s_add_u32 s59, s59, s58
    s_mul_i32 s56, s100, 56
    s_add_u32 s97, s59, s56
    s_add_u32 s59, s57, 8
    s_mul_i32 s59, s59, 43008
    s_add_u32 s98, s59, s56
    s_sub_u32 s60, s101, 80
    s_lshr_b32 s58, s60, 3
    s_bfe_u32 s60, s60, 65538
    s_mul_i32 s59, s58, 25088
    s_add_u32 s56, s56, s59
    s_mul_i32 s59, s60, 14336
    s_add_u32 s56, s56, s59
    s_cmp_ge_u32 s101, 80
    s_cselect_b32 s98, s56, s98
    s_mov_b32 m0, s61
    s_waitcnt lgkmcnt(0)
    buffer_load_dwordx4 v98, s[16:19], s97 offen lds
    s_add_u32 m0, s61, 1024
    s_cmp_ge_u32 s101, 80
    s_cbranch_scc1 La_2
    buffer_load_dwordx4 v98, s[16:19], s98 offen lds
    s_branch Lb_3
La_2:
    buffer_load_dwordx4 v97, s[28:31], s98 offen lds
Lb_3:
    s_mov_b32 s40, s80
    s_and_b32 s41, s81, 0xffff
    s_mov_b32 s42, 256
    s_mov_b32 s43, 0x20000
    s_add_u32 s7, s2, s50
    s_lshl_b32 s7, s7, 8
    s_andn2_b32 s3, s90, 15
    s_or_b32 s4, s91, 1073741824
    v_mov_b32 v56, s3
    v_mov_b32 v57, s4
    s_mov_b64 exec, 1
    buffer_store_dwordx2 v[56:57], v0, s[40:43], s7 offen sc1
    s_mov_b64 exec, -1
    s_mov_b32 s12, s64
    s_and_b32 s13, s65, 0xffff
    s_mov_b32 s14, 1835008
    s_mov_b32 s15, 0x20000
    s_mov_b32 s24, s68
    s_and_b32 s25, s69, 0xffff
    s_mov_b32 s26, 25088
    s_mov_b32 s27, 0x20000
    s_mov_b32 s20, s74
    s_and_b32 s21, s75, 0xffff
    s_mov_b32 s22, 1204224
    s_mov_b32 s23, 0x20000
    s_mov_b32 s32, s76
    s_and_b32 s33, s77, 0xffff
    s_mov_b32 s34, 401408
    s_mov_b32 s35, 0x20000
    s_mov_b32 s36, s78
    s_and_b32 s37, s79, 0xffff
    s_mov_b32 s38, 1835008
    s_mov_b32 s39, 0x20000
    s_mov_b32 s8, s82
    s_and_b32 s9, s83, 0xffff
    s_mov_b32 s10, 31457280
    s_mov_b32 s11, 0x20000
    s_lshl_b32 s74, s50, 10
    s_mov_b32 s75, s61
    s_mul_i32 s65, s49, 1568
    s_add_u32 m0, s75, 5120
    s_nop 0
    buffer_load_dwordx4 v96, s[24:27], s65 offen lds
    s_add_u32 s65, s65, 896
    s_add_u32 m0, s75, 6144
    s_nop 0
    buffer_load_dwordx4 v96, s[24:27], s65 offen lds
    v_lshrrev_b32 v56, 3, v0
    s_lshl_b32 s65, s87, 5
    v_add_u32 v55, s65, v56
    v_mul_u32_u24 v101, 896, v55
    v_and_b32 v55, 7, v0
    v_lshrrev_b32 v56, 4, v0
    v_xor_b32 v55, v55, v56
    v_lshl_add_u32 v101, v55, 4, v101
    v_xor_b32 v102, 64, v101
    s_and_b32 s65, s48, 1
    s_mul_i32 s65, s65, 3
    s_add_u32 s99, s49, s65
    s_cmp_ge_u32 s99, 7
    s_cselect_b32 s65, 7, 0
    s_cmp_ge_u32 s99, 14
    s_cselect_b32 s65, 14, s65
    s_sub_u32 s99, s99, s65
    s_add_u32 s64, s99, 0
    s_cmp_ge_u32 s64, 7
    s_cselect_b32 s69, 7, 0
    s_sub_u32 s64, s64, s69
    s_lshl_b32 s64, s64, 7
    s_add_u32 m0, s74, 0
    s_nop 0
    buffer_load_dwordx4 v101, s[12:15], s64 offen lds
    s_add_u32 s64, s64, 7168
    s_add_u32 m0, s74, 4096
    s_nop 0
    buffer_load_dwordx4 v102, s[12:15], s64 offen lds
    s_add_u32 s64, s64, 7168
    s_add_u32 m0, s74, 8192
    s_nop 0
    buffer_load_dwordx4 v101, s[12:15], s64 offen lds
    s_add_u32 s64, s64, 7168
    s_add_u32 m0, s74, 12288
    s_nop 0
    buffer_load_dwordx4 v102, s[12:15], s64 offen lds
    s_mul_i32 s66, s100, 86016
    s_mul_i32 s67, s57, 1024
    s_add_u32 s95, s66, s67
    s_add_u32 s95, s95, 26214400
    s_add_u32 s96, s95, 65536
    s_mul_i32 s67, s100, 32768
    s_mul_i32 s58, s58, 2048
    s_add_u32 s67, s67, s58
    s_mul_i32 s60, s60, 1024
    s_add_u32 s67, s67, s60
    s_add_u32 s67, s67, 29360128
    s_cmp_ge_u32 s101, 208
    s_cselect_b32 s67, 117440512, s67
    s_cmp_ge_u32 s101, 80
    s_cselect_b32 s96, s67, s96
    s_mul_i32 s82, s100, 10752
    s_lshl_b32 s65, s57, 7
    s_add_u32 s82, s82, s65
    s_nop 0
    s_add_u32 s82, s82, 30408704
    s_add_u32 s83, s82, 8192
    s_cmp_ge_u32 s101, 80
    s_cselect_b32 s83, 117440512, s83
    v_and_b32 v60, 31, v0
    v_lshrrev_b32 v61, 5, v0
    v_bfe_u32 v62, v0, 2, 2
    v_bfe_u32 v63, v0, 4, 1
    v_lshlrev_b32_e64 v57, 5, v63
    v_lshl_add_u32 v57, v59, 3, v57
    v_lshl_add_u32 v56, v61, 3, v62
    v_lshl_add_u32 v2, v56, 6, v57
    v_mul_u32_u24 v3, 448, v61
    v_lshl_add_u32 v3, v60, 4, v3
    v_mov_b32 v55, 117440512
    v_cmp_gt_u32 vcc, 28, v60
    s_nop 1
    v_cndmask_b32 v3, v55, v3, vcc
    v_add_u32 v4, 57344, v1
    v_add_u32 v99, s75, v2
    v_lshl_add_u32 v56, v61, 2, v62
    v_lshl_add_u32 v100, v56, 6, v57
    v_add_u32_e64 v100, s75, v100
    v_mul_u32_u24 v56, 264, v61
    v_lshl_add_u32 v56, v62, 6, v56
    s_and_b32 s65, s50, 1
    s_nop 0
    s_mul_i32 s65, s65, 8448
    s_add_u32 s65, s65, 86016
    v_add3_u32 v11, v56, v57, s65
    v_mov_b32 v57, 0x3f803f80
    s_cmp_ge_u32 s101, 80
    s_cselect_b64 vcc, -1, 0
    s_cselect_b32 s65, 2, 1
    s_lshl_b32 s65, s65, 8
    v_cndmask_b32 v110, v99, v100, vcc
    v_add_u32 v111, s65, v110
    s_sub_u32 s65, s101, 80
    s_bitcmp1_b32 s65, 2
    s_cselect_b32 s7, -1, 0
    s_cmp_ge_u32 s101, 80
    s_cselect_b32 s7, s7, 0
    s_waitcnt vmcnt(7)
    s_nop 0
    ds_read_b64_tr_b16 v[64:65], v99 offset:0
    ds_read_b64_tr_b16 v[66:67], v99 offset:256
    ds_read_b64_tr_b16 v[68:69], v110 offset:1024
    ds_read_b64_tr_b16 v[70:71], v111 offset:1024
    s_waitcnt lgkmcnt(2)
    buffer_store_dwordx4 v[64:67], v3, s[8:11], s95 offen offset:0 sc1
    s_waitcnt lgkmcnt(0)
    s_mov_b32 exec_lo, 0
    s_mov_b32 exec_hi, s7
    v_mov_b32 v70, 0
    v_mov_b32 v71, 0
    s_mov_b64 exec, -1
    buffer_store_dwordx4 v[68:71], v3, s[8:11], s96 offen offset:0 sc1
    v_mov_b32 v76, 0
    v_mov_b32_e64 v78, 0
    v_dot2_f32_bf16 v76, v64, v57, v76
    v_dot2_f32_bf16 v78, v68, v57, v78
    v_dot2_f32_bf16 v76, v65, v57, v76
    v_dot2_f32_bf16 v78, v69, v57, v78
    v_dot2_f32_bf16 v76, v66, v57, v76
    v_dot2_f32_bf16 v78, v70, v57, v78
    v_dot2_f32_bf16 v76, v67, v57, v76
    v_dot2_f32_bf16 v78, v71, v57, v78
    s_nop 2
    v_permlane32_swap_b32 v76, v78
    v_add_f32 v76, v76, v78
    v_and_b32 v78, 31, v0
    v_lshlrev_b32 v78, 2, v78
    s_mov_b32 exec_hi, 0
    buffer_store_dword v76, v78, s[8:11], s82 offen sc1
    s_mov_b32 exec_hi, -1
    s_mov_b32 exec_lo, 0
    buffer_store_dword v76, v78, s[8:11], s83 offen sc1
    s_mov_b32 exec_lo, -1
    s_add_u32 s82, s82, 172032
    s_add_u32 s83, s83, 172032
    v_mov_b32 v82, 0
    buffer_load_dwordx2 v[80:81], v82, s[40:43], 0 offen sc1
    s_add_u32 m0, s75, 2048
    s_nop 0
    buffer_load_dwordx4 v98, s[20:23], s97 offen lds
    s_add_u32 m0, s75, 3072
    s_cmp_ge_u32 s101, 80
    s_cbranch_scc1 La_4
    buffer_load_dwordx4 v98, s[20:23], s98 offen lds
    s_branch Lb_5
La_4:
    buffer_load_dwordx4 v97, s[32:35], s98 offen lds
Lb_5:
    s_add_u32 s64, s99, 1
    s_cmp_ge_u32 s64, 7
    s_cselect_b32 s69, 7, 0
    s_sub_u32 s64, s64, s69
    s_lshl_b32 s64, s64, 7
    s_add_u32 m0, s74, 16384
    s_nop 0
    buffer_load_dwordx4 v101, s[12:15], s64 offen lds
    s_add_u32 s64, s64, 7168
    s_add_u32 m0, s74, 20480
    s_nop 0
    buffer_load_dwordx4 v102, s[12:15], s64 offen lds
    s_add_u32 s64, s64, 7168
    s_add_u32 m0, s74, 24576
    s_nop 0
    buffer_load_dwordx4 v101, s[12:15], s64 offen lds
    s_add_u32 s64, s64, 7168
    s_add_u32 m0, s74, 28672
    s_nop 0
    buffer_load_dwordx4 v102, s[12:15], s64 offen lds
    s_getreg_b32 s54, hwreg(HW_REG_XCC_ID)
    s_and_b32 s54, s54, 15
    s_mov_b32 s94, s6
    s_lshl_b32 s70, s6, 2
    s_add_u32 s70, s70, s50
    s_lshl_b32 s70, s70, 7
    s_lshr_b32 s3, s49, 2
    s_lshl_b32 s51, s48, 2
    s_add_u32 s51, s51, s3
    s_and_b32 s52, s49, 3
    s_mov_b32 s79, 0
    s_mov_b32 s53, 0
    s_lshl_b32 s56, s87, 15
    s_lshl_b32 s65, s49, 11
    s_add_u32 s57, s56, s65
    s_lshl_b32 s59, s51, 15
    s_lshl_b32 s65, s50, 13
    s_add_u32 s58, s59, s65
    s_lshl_b32 s65, s49, 16
    s_lshl_b32 s66, s48, 12
    s_add_u32 s60, s65, s66
    s_lshl_b32 s66, s50, 11
    s_add_u32 s60, s60, s66
    s_add_u32 s61, s65, s74
    s_lshl_b32 s65, s49, 18
    s_lshl_b32 s66, s87, 12
    s_add_u32 s62, s65, s66
    s_add_u32 s66, s87, s50
    s_sub_u32 s66, s66, 8
    s_lshl_b32 s66, s66, 12
    s_add_u32 s63, s65, s66
    s_mul_i32 s73, s49, 86016
    s_mul_i32 s65, s50, 1024
    s_add_u32 s73, s73, s65
    s_and_b32 s66, s48, 1
    s_mul_i32 s65, s50, 14336
    s_mul_i32 s67, s66, 7168
    s_add_u32 s46, s65, s67
    s_sub_u32 s47, s65, s67
    s_nop 0
    s_add_u32 s47, s47, 7168
    s_mul_i32 s65, s50, 7168
    s_mul_i32 s67, s66, 3072
    s_add_u32 s65, s65, 57344
    s_add_u32 s76, s65, s67
    s_sub_u32 s77, s65, s67
    s_add_u32 s77, s77, 3072
    s_mul_i32 s78, s49, 86016
    s_lshl_b32 s65, s52, 2
    s_add_u32 s65, s65, s50
    s_mul_i32 s86, s65, 32768
    v_bfe_u32 v55, v60, 1, 3
    v_xor_b32 v55, v55, v61
    v_and_b32 v56, 7, v60
    v_lshl_add_u32 v56, v56, 7, s74
    v_lshrrev_b32_e64 v58, 3, v60
    v_lshl_add_u32 v56, v58, 12, v56
    v_lshl_add_u32 v104, v55, 4, v56
    v_xor_b32 v105, 32, v104
    v_xor_b32 v106, 64, v104
    v_xor_b32 v107, 96, v104
    v_add_u32 v84, 65536, v104
    v_add_u32 v85, 65536, v105
    v_add_u32 v86, 65536, v106
    v_add_u32 v87, 65536, v107
    v_lshrrev_b32 v56, 2, v60
    s_lshl_b32 s65, s50, 3
    v_add_u32_e64 v56, s65, v56
    v_mul_u32_u24 v56, 264, v56
    v_lshl_add_u32 v56, v59, 6, v56
    v_lshl_add_u32 v56, v61, 3, v56
    v_add_u32 v10, 86016, v56
    s_lshl_b32 s65, s50, 7
    s_add_u32 s65, s65, 155648
    v_lshl_add_u32 v12, v60, 2, s65
    v_lshl_add_u32 v13, v61, 4, s65
    s_lshl_b32 s65, s50, 12
    s_add_u32 s65, s65, 86016
    v_add_u32 v14, s65, v1
    s_lshl_b32 s65, s50, 13
    s_add_u32 s65, s65, 86016
    v_add_u32 v6, s65, v1
    s_lshl_b32 s65, s50, 11
    s_add_u32 s65, s65, 103424
    v_add_u32 v22, s65, v1
    s_add_u32 s65, s50, 0
    s_and_b32 s65, s65, 3
    s_lshl_b32 s65, s65, 13
    s_sub_u32 s65, 155648, s65
    v_add_u32 v23, s65, v1
    s_add_u32 s65, s50, 1
    s_and_b32 s65, s65, 3
    s_lshl_b32 s65, s65, 13
    s_sub_u32 s65, 155648, s65
    v_add_u32 v16, s65, v1
    s_add_u32 s65, s50, 2
    s_and_b32 s65, s65, 3
    s_lshl_b32 s65, s65, 13
    s_sub_u32 s65, 155648, s65
    v_add_u32 v17, s65, v1
    s_add_u32 s65, s50, 3
    s_and_b32 s65, s65, 3
    s_lshl_b32 s65, s65, 13
    s_sub_u32 s65, 155648, s65
    v_add_u32 v18, s65, v1
    s_mul_i32 s65, s52, 28
    s_mul_i32 s66, s50, 7
    s_add_u32 s65, s65, s66
    v_add_u32 v56, s65, v61
    v_lshrrev_b32 v55, 1, v56
    v_lshlrev_b32 v55, 9, v55
    v_and_b32 v56, 1, v56
    v_lshl_add_u32 v55, v56, 3, v55
    v_lshl_add_u32 v7, v60, 4, v55
    s_lshr_b32 s66, s52, 1
    s_lshl_b32 s66, s66, 9
    s_and_b32 s67, s52, 1
    s_lshl_b32 s67, s67, 3
    s_add_u32 s66, s66, s67
    s_add_u32 s66, s66, 28672
    v_lshl_add_u32 v8, v60, 4, s66
    v_and_b32 v56, 15, v0
    v_mul_u32_u24 v56, 7, v56
    v_add_u32 v56, 6, v56
    v_lshrrev_b32 v55, 1, v56
    v_lshlrev_b32 v55, 9, v55
    v_and_b32 v56, 1, v56
    v_lshl_add_u32 v55, v56, 3, v55
    v_lshrrev_b32 v56, 4, v0
    v_lshl_add_u32 v55, v56, 7, v55
    v_add_u32 v9, 112, v55
    s_lshl_b32 s65, s51, 5
    v_add_u32 v56, s65, v60
    v_mul_u32_u24 v56, 896, v56
    s_mul_i32 s65, s52, 224
    s_mul_i32 s66, s50, 56
    s_add_u32 s65, s65, s66
    v_lshl_add_u32 v56, v61, 3, v56
    v_add_u32 v15, s65, v56
    v_cmp_eq_u32 vcc, 0, v61
    v_mov_b32 v56, 1.0
    v_mov_b32 v55, 0x7f61b1e6
    v_cndmask_b32 v19, 0, v56, vcc
    v_mov_b32 v56, 0
    v_cndmask_b32 v20, v55, v56, vcc
    v_lshlrev_b32 v56, 2, v61
    v_sub_u32 v21, v60, v56
    v_cmp_eq_u32 vcc, 28, v60
    v_mov_b32 v56, 1.0
    s_nop 0
    v_cndmask_b32 v2, 0, v56, vcc
    v_cmp_le_u32 s[84:85], 28, v60
    v_mov_b32 v60, 0
    v_mov_b32 v61, 0
    v_mov_b32 v62, 0
    v_mov_b32 v63, 0
    s_add_u32 s64, s99, 2
    s_cmp_ge_u32 s64, 7
    s_cselect_b32 s69, 7, 0
    s_sub_u32 s64, s64, s69
    s_lshl_b32 s64, s64, 7
    s_add_u32 m0, s74, 32768
    s_nop 0
    buffer_load_dwordx4 v101, s[12:15], s64 offen lds
    s_add_u32 s64, s64, 7168
    s_add_u32 m0, s74, 36864
    s_nop 0
    buffer_load_dwordx4 v102, s[12:15], s64 offen lds
    s_add_u32 s64, s64, 7168
    s_add_u32 m0, s74, 40960
    s_nop 0
    buffer_load_dwordx4 v101, s[12:15], s64 offen lds
    s_add_u32 s64, s64, 7168
    s_add_u32 m0, s74, 45056
    s_nop 0
    buffer_load_dwordx4 v102, s[12:15], s64 offen lds
    s_waitcnt vmcnt(15)
    ds_read_b128 v[144:147], v104 offset:0
    ds_read_b128 v[148:151], v105 offset:0
    ds_read_b128 v[152:155], v106 offset:0
    ds_read_b128 v[156:159], v107 offset:0
    ds_read_b64_tr_b16 v[24:25], v100 offset:5120
    ds_read_b64_tr_b16 v[26:27], v100 offset:5632
    ds_read_b64_tr_b16 v[28:29], v100 offset:6144
    ds_read_b64_tr_b16 v[30:31], v100 offset:6656
    s_waitcnt lgkmcnt(0)
    s_mov_b32 exec_lo, 0
    v_mov_b32 v30, 0
    v_mov_b32 v31, 0
    s_mov_b64 exec, s[84:85]
    v_mov_b32 v24, 0
    v_mov_b32 v25, 0
    v_mov_b32 v26, 0
    v_mov_b32 v27, 0
    v_mov_b32 v28, 0
    v_mov_b32 v29, 0
    v_mov_b32 v30, 0
    v_mov_b32 v31, 0
    s_mov_b64 exec, -1
    v_dot2_f32_bf16 v60, v144, v57, v60
    v_dot2_f32_bf16 v61, v144, v144, v61
    v_dot2_f32_bf16 v60, v145, v57, v60
    v_dot2_f32_bf16 v61, v145, v145, v61
    v_dot2_f32_bf16 v60, v146, v57, v60
    v_dot2_f32_bf16 v61, v146, v146, v61
    v_dot2_f32_bf16 v60, v147, v57, v60
    v_dot2_f32_bf16 v61, v147, v147, v61
    v_dot2_f32_bf16 v60, v148, v57, v60
    v_dot2_f32_bf16 v61, v148, v148, v61
    v_dot2_f32_bf16 v60, v149, v57, v60
    v_dot2_f32_bf16 v61, v149, v149, v61
    v_dot2_f32_bf16 v60, v150, v57, v60
    v_dot2_f32_bf16 v61, v150, v150, v61
    v_dot2_f32_bf16 v60, v151, v57, v60
    v_dot2_f32_bf16 v61, v151, v151, v61
    v_dot2_f32_bf16 v60, v152, v57, v60
    v_dot2_f32_bf16 v61, v152, v152, v61
    v_dot2_f32_bf16 v60, v153, v57, v60
    v_dot2_f32_bf16 v61, v153, v153, v61
    v_dot2_f32_bf16 v60, v154, v57, v60
    v_dot2_f32_bf16 v61, v154, v154, v61
    v_dot2_f32_bf16 v60, v155, v57, v60
    v_dot2_f32_bf16 v61, v155, v155, v61
    v_dot2_f32_bf16 v60, v156, v57, v60
    v_dot2_f32_bf16 v61, v156, v156, v61
    v_dot2_f32_bf16 v60, v157, v57, v60
    v_dot2_f32_bf16 v61, v157, v157, v61
    v_dot2_f32_bf16 v60, v158, v57, v60
    v_dot2_f32_bf16 v61, v158, v158, v61
    v_dot2_f32_bf16 v60, v159, v57, v60
    v_dot2_f32_bf16 v61, v159, v159, v61
    s_add_u32 s68, s99, 0
    s_cmp_ge_u32 s68, 7
    s_cselect_b32 s69, 7, 0
    s_sub_u32 s68, s68, s69
    s_lshl_b32 s68, s68, 12
    s_add_u32 s68, s68, s73
    s_add_u32 s16, s68, 26214400
    s_add_u32 s68, s99, 1
    s_cmp_ge_u32 s68, 7
    s_cselect_b32 s69, 7, 0
    s_sub_u32 s68, s68, s69
    s_lshl_b32 s68, s68, 12
    s_add_u32 s68, s68, s73
    s_add_u32 s17, s68, 26214400
    s_add_u32 s68, s99, 2
    s_cmp_ge_u32 s68, 7
    s_cselect_b32 s69, 7, 0
    s_sub_u32 s68, s68, s69
    s_lshl_b32 s68, s68, 12
    s_add_u32 s68, s68, s73
    s_add_u32 s18, s68, 26214400
    s_add_u32 s68, s99, 3
    s_cmp_ge_u32 s68, 7
    s_cselect_b32 s69, 7, 0
    s_sub_u32 s68, s68, s69
    s_lshl_b32 s68, s68, 12
    s_add_u32 s68, s68, s73
    s_add_u32 s19, s68, 26214400
    s_add_u32 s68, s99, 4
    s_cmp_ge_u32 s68, 7
    s_cselect_b32 s69, 7, 0
    s_sub_u32 s68, s68, s69
    s_lshl_b32 s68, s68, 12
    s_add_u32 s68, s68, s73
    s_add_u32 s20, s68, 26214400
    s_add_u32 s68, s99, 5
    s_cmp_ge_u32 s68, 7
    s_cselect_b32 s69, 7, 0
    s_sub_u32 s68, s68, s69
    s_lshl_b32 s68, s68, 12
    s_add_u32 s68, s68, s73
    s_add_u32 s21, s68, 26214400
    s_add_u32 s68, s99, 6
    s_cmp_ge_u32 s68, 7
    s_cselect_b32 s69, 7, 0
    s_sub_u32 s68, s68, s69
    s_lshl_b32 s68, s68, 12
    s_add_u32 s68, s68, s73
    s_add_u32 s22, s68, 26214400
    s_waitcnt vmcnt(10)
    s_mov_b32 s55, 0
Lfe_7:
    v_readfirstlane_b32 s4, v80
    v_readfirstlane_b32 s5, v81
    s_nop 0
    s_cmp_eq_u32 s5, 0
    s_nop 1
    s_cbranch_scc1 Lfe_6
Lfe_8:
    s_or_b32 s4, s4, s54
    s_barrier
    s_cmp_lg_u32 s50, 3
    s_cbranch_scc1 Lfx_9
    v_mov_b32 v80, s4
    v_mov_b32 v81, s5
    s_and_b32 s3, s101, 3
    s_lshl_b32 s3, s3, 9
    s_lshr_b32 s6, s101, 2
    s_lshl_b32 s6, s6, 3
    s_add_u32 s3, s3, s6
    s_add_u32 s3, s3, 25952256
    s_mov_b64 exec, 1
    buffer_store_dwordx2 v[80:81], v0, s[8:11], s3 offen sc1
    s_mov_b64 exec, -1
Lfx_9:
    s_add_u32 s64, s99, 3
    s_cmp_ge_u32 s64, 7
    s_cselect_b32 s69, 7, 0
    s_sub_u32 s64, s64, s69
    s_lshl_b32 s64, s64, 7
    s_add_u32 m0, s74, 49152
    s_nop 0
    buffer_load_dwordx4 v101, s[12:15], s64 offen lds
    s_add_u32 s64, s64, 7168
    s_add_u32 m0, s74, 53248
    s_nop 0
    buffer_load_dwordx4 v102, s[12:15], s64 offen lds
    s_add_u32 s64, s64, 7168
    s_add_u32 m0, s74, 57344
    s_nop 0
    buffer_load_dwordx4 v101, s[12:15], s64 offen lds
    s_add_u32 s64, s64, 7168
    s_add_u32 m0, s74, 61440
    s_nop 0
    buffer_load_dwordx4 v102, s[12:15], s64 offen lds
    s_add_u32 s64, s99, 4
    s_cmp_ge_u32 s64, 7
    s_cselect_b32 s69, 7, 0
    s_sub_u32 s64, s64, s69
    s_lshl_b32 s64, s64, 7
    s_add_u32 m0, s74, 65536
    s_nop 0
    buffer_load_dwordx4 v101, s[12:15], s64 offen lds
    s_add_u32 s64, s64, 7168
    s_add_u32 m0, s74, 69632
    s_nop 0
    buffer_load_dwordx4 v102, s[12:15], s64 offen lds
    s_add_u32 s64, s64, 7168
    s_add_u32 m0, s74, 73728
    s_nop 0
    buffer_load_dwordx4 v101, s[12:15], s64 offen lds
    s_add_u32 s64, s64, 7168
    s_add_u32 m0, s74, 77824
    s_nop 0
    buffer_load_dwordx4 v102, s[12:15], s64 offen lds
    s_add_u32 s64, s99, 5
    s_cmp_ge_u32 s64, 7
    s_cselect_b32 s69, 7, 0
    s_sub_u32 s64, s64, s69
    s_lshl_b32 s64, s64, 7
    s_add_u32 m0, s74, 81920
    s_nop 0
    buffer_load_dwordx4 v101, s[12:15], s64 offen lds
    s_add_u32 s64, s64, 7168
    s_add_u32 m0, s74, 86016
    s_nop 0
    buffer_load_dwordx4 v102, s[12:15], s64 offen lds
    s_add_u32 s64, s64, 7168
    s_add_u32 m0, s74, 90112
    s_nop 0
    buffer_load_dwordx4 v101, s[12:15], s64 offen lds
    s_add_u32 s64, s64, 7168
    s_add_u32 m0, s74, 94208
    s_nop 0
    buffer_load_dwordx4 v102, s[12:15], s64 offen lds
    s_add_u32 s64, s99, 6
    s_cmp_ge_u32 s64, 7
    s_cselect_b32 s69, 7, 0
    s_sub_u32 s64, s64, s69
    s_lshl_b32 s64, s64, 7
    s_add_u32 m0, s74, 98304
    s_nop 0
    buffer_load_dwordx4 v101, s[12:15], s64 offen lds
    s_add_u32 s64, s64, 7168
    s_add_u32 m0, s74, 102400
    s_nop 0
    buffer_load_dwordx4 v102, s[12:15], s64 offen lds
    s_add_u32 s64, s64, 7168
    s_add_u32 m0, s74, 106496
    s_nop 0
    buffer_load_dwordx4 v101, s[12:15], s64 offen lds
    s_add_u32 s64, s64, 7168
    s_add_u32 m0, s74, 110592
    s_nop 0
    s_nop 0
    buffer_load_dwordx4 v102, s[12:15], s64 offen lds
    buffer_load_dwordx2 a[128:129], v15, s[12:15], 0 offen offset:0
    buffer_load_dwordx2 a[130:131], v15, s[12:15], 0 offen offset:16
    buffer_load_dwordx2 a[132:133], v15, s[12:15], 0 offen offset:32
    buffer_load_dwordx2 a[134:135], v15, s[12:15], 0 offen offset:48
    s_waitcnt vmcnt(24)
    s_nop 0
    ds_read_b128 v[160:163], v104 offset:16384
    ds_read_b128 v[164:167], v105 offset:16384
    ds_read_b128 v[168:171], v106 offset:16384
    ds_read_b128 v[172:175], v107 offset:16384
    v_lshlrev_b32_e64 v74, 3, v0
    s_lshr_b32 s6, s49, 2
    s_lshl_b32 s6, s6, 9
    s_add_u32 s6, s6, 25952256
    buffer_load_dwordx2 v[72:73], v74, s[8:11], s6 offen sc1
    s_waitcnt lgkmcnt(0)
    s_nop 0
    ds_read_b64_tr_b16 v[64:65], v99 offset:2048
    ds_read_b64_tr_b16 v[66:67], v99 offset:2304
    ds_read_b64_tr_b16 v[68:69], v110 offset:3072
    ds_read_b64_tr_b16 v[70:71], v111 offset:3072
    s_waitcnt lgkmcnt(2)
    s_add_u32 s66, s95, 1376256
    buffer_store_dwordx4 v[64:67], v3, s[8:11], s66 offen offset:0 sc1
    s_waitcnt lgkmcnt(0)
    s_mov_b32 exec_lo, 0
    s_mov_b32 exec_hi, s7
    v_mov_b32_e64 v70, 0
    v_mov_b32 v71, 0
    s_mov_b64 exec, -1
    s_mov_b32 s67, 1376256
    s_cmp_ge_u32 s101, 80
    s_cselect_b32 s67, 524288, s67
    s_add_u32 s96, s96, s67
    buffer_store_dwordx4 v[68:71], v3, s[8:11], s96 offen offset:0 sc1
    v_mov_b32 v76, 0
    v_mov_b32_e64 v78, 0
    v_dot2_f32_bf16 v76, v64, v57, v76
    v_dot2_f32_bf16 v78, v68, v57, v78
    v_dot2_f32_bf16 v76, v65, v57, v76
    v_dot2_f32_bf16 v78, v69, v57, v78
    v_dot2_f32_bf16 v76, v66, v57, v76
    v_dot2_f32_bf16 v78, v70, v57, v78
    v_dot2_f32_bf16 v76, v67, v57, v76
    v_dot2_f32_bf16 v78, v71, v57, v78
    s_nop 2
    v_permlane32_swap_b32 v76, v78
    v_add_f32 v76, v76, v78
    v_and_b32 v78, 31, v0
    v_lshlrev_b32 v78, 2, v78
    s_mov_b32 exec_hi, 0
    buffer_store_dword v76, v78, s[8:11], s82 offen sc1
    s_mov_b32 exec_hi, -1
    s_mov_b32 exec_lo, 0
    buffer_store_dword v76, v78, s[8:11], s83 offen sc1
    s_mov_b32 exec_lo, -1
    v_mov_b32 v108, -1
    v_mov_b32 v109, -1
    v_mov_b32 v110, -1
    v_mov_b32 v111, -1
    s_lshl_b32 s97, s48, 12
    s_add_u32 s97, s97, s61
    s_lshl_b32 s98, s49, 12
    s_add_u32 s98, s98, s74
    s_lshl_b32 s67, s48, 16
    s_add_u32 s98, s98, s67
    s_mov_b32 s67, 117440512
    s_cmp_lt_u32 s48, 2
    s_cselect_b32 s67, 25690112, s67
    s_add_u32 s98, s98, s67
    s_add_u32 s66, s97, 14680064
    buffer_store_dwordx4 v[108:111], v1, s[8:11], s66 offen offset:0 sc1
    buffer_store_dwordx4 v[108:111], v1, s[8:11], s98 offen offset:0 sc1
    s_waitcnt vmcnt(27)
    ds_read_b128 v[176:179], v104 offset:32768
    ds_read_b128 v[180:183], v105 offset:32768
    ds_read_b128 v[184:187], v106 offset:32768
    ds_read_b128 v[188:191], v107 offset:32768
    v_dot2_f32_bf16 v60, v160, v57, v60
    v_dot2_f32_bf16 v61, v160, v160, v61
    v_dot2_f32_bf16 v60, v161, v57, v60
    v_dot2_f32_bf16 v61, v161, v161, v61
    v_dot2_f32_bf16 v60, v162, v57, v60
    v_dot2_f32_bf16 v61, v162, v162, v61
    v_dot2_f32_bf16 v60, v163, v57, v60
    v_dot2_f32_bf16 v61, v163, v163, v61
    v_dot2_f32_bf16 v60, v164, v57, v60
    v_dot2_f32_bf16 v61, v164, v164, v61
    v_dot2_f32_bf16 v60, v165, v57, v60
    v_dot2_f32_bf16 v61, v165, v165, v61
    v_dot2_f32_bf16 v60, v166, v57, v60
    v_dot2_f32_bf16 v61, v166, v166, v61
    v_dot2_f32_bf16 v60, v167, v57, v60
    v_dot2_f32_bf16 v61, v167, v167, v61
    v_dot2_f32_bf16 v60, v168, v57, v60
    v_dot2_f32_bf16 v61, v168, v168, v61
    v_dot2_f32_bf16 v60, v169, v57, v60
    v_dot2_f32_bf16 v61, v169, v169, v61
    v_dot2_f32_bf16 v60, v170, v57, v60
    v_dot2_f32_bf16 v61, v170, v170, v61
    v_dot2_f32_bf16 v60, v171, v57, v60
    v_dot2_f32_bf16 v61, v171, v171, v61
    v_dot2_f32_bf16 v60, v172, v57, v60
    v_dot2_f32_bf16 v61, v172, v172, v61
    v_dot2_f32_bf16 v60, v173, v57, v60
    v_dot2_f32_bf16 v61, v173, v173, v61
    v_dot2_f32_bf16 v60, v174, v57, v60
    v_dot2_f32_bf16 v61, v174, v174, v61
    v_dot2_f32_bf16 v60, v175, v57, v60
    v_dot2_f32_bf16 v61, v175, v175, v61
    s_waitcnt vmcnt(23)
    s_nop 0
    ds_read_b128 v[192:195], v104 offset:49152
    ds_read_b128 v[196:199], v105 offset:49152
    ds_read_b128 v[200:203], v106 offset:49152
    ds_read_b128 v[204:207], v107 offset:49152
    s_waitcnt lgkmcnt(4)
    s_nop 0
    v_dot2_f32_bf16 v60, v176, v57, v60
    v_dot2_f32_bf16 v61, v176, v176, v61
    v_dot2_f32_bf16 v60, v177, v57, v60
    v_dot2_f32_bf16 v61, v177, v177, v61
    v_dot2_f32_bf16 v60, v178, v57, v60
    v_dot2_f32_bf16 v61, v178, v178, v61
    v_dot2_f32_bf16 v60, v179, v57, v60
    v_dot2_f32_bf16 v61, v179, v179, v61
    v_dot2_f32_bf16 v60, v180, v57, v60
    v_dot2_f32_bf16 v61, v180, v180, v61
    v_dot2_f32_bf16 v60, v181, v57, v60
    v_dot2_f32_bf16 v61, v181, v181, v61
    v_dot2_f32_bf16 v60, v182, v57, v60
    v_dot2_f32_bf16 v61, v182, v182, v61
    v_dot2_f32_bf16 v60, v183, v57, v60
    v_dot2_f32_bf16 v61, v183, v183, v61
    v_dot2_f32_bf16 v60, v184, v57, v60
    v_dot2_f32_bf16 v61, v184, v184, v61
    v_dot2_f32_bf16 v60, v185, v57, v60
    v_dot2_f32_bf16 v61, v185, v185, v61
    v_dot2_f32_bf16 v60, v186, v57, v60
    v_dot2_f32_bf16 v61, v186, v186, v61
    v_dot2_f32_bf16 v60, v187, v57, v60
    v_dot2_f32_bf16 v61, v187, v187, v61
    v_dot2_f32_bf16 v60, v188, v57, v60
    v_dot2_f32_bf16 v61, v188, v188, v61
    v_dot2_f32_bf16 v60, v189, v57, v60
    v_dot2_f32_bf16 v61, v189, v189, v61
    v_dot2_f32_bf16 v60, v190, v57, v60
    v_dot2_f32_bf16 v61, v190, v190, v61
    v_dot2_f32_bf16 v60, v191, v57, v60
    v_dot2_f32_bf16 v61, v191, v191, v61
    s_waitcnt lgkmcnt(0)
    s_mov_b32 s55, 0
    s_waitcnt vmcnt(6)
Lqp_10:
    v_xor_b32 v72, s4, v72
    v_xor_b32 v73, s5, v73
    v_and_b32 v72, -16, v72
    v_or_b32_e64 v72, v72, v73
    v_cmp_ne_u32 vcc, 0, v72
    s_nop 0
    s_cmp_eq_u64 vcc, 0
    s_nop 1
    s_cbranch_scc1 Lqo_12
    s_add_u32 s55, s55, 1
    s_cmp_ge_u32 s55, 200000
    s_cselect_b32 s88, 268435456, 0
    s_or_b32 s79, s79, s88
    s_cmp_lg_u32 s88, 0
    s_cbranch_scc1 Lqo_12
    s_sleep 4
    buffer_load_dwordx2 v[72:73], v74, s[8:11], s6 offen sc1
    s_waitcnt vmcnt(0)
    s_branch Lqp_10
Lqo_12:
Lpf_13:
    s_add_u32 s6, s70, Lpf_13-Lstart+1024
    s_min_u32 s6, s6, Lcode_end-Lstart-4
    s_load_dword s72, s[44:45], s6
    s_add_u32 m0, s74, 0
    s_nop 0
    buffer_load_dwordx4 v3, s[8:11], s16 offen sc1 lds
    s_add_u32 m0, s74, 28672
    s_add_u32 s69, s16, 28672
    buffer_load_dwordx4 v3, s[8:11], s69 offen sc1 lds
    s_add_u32 m0, s74, 4096
    s_nop 0
    s_nop 0
    buffer_load_dwordx4 v3, s[8:11], s17 offen sc1 lds
    s_add_u32 m0, s74, 32768
    s_add_u32 s69, s17, 28672
    buffer_load_dwordx4 v3, s[8:11], s69 offen sc1 lds
    s_add_u32 m0, s74, 8192
    s_nop 0
    s_nop 0
    buffer_load_dwordx4 v3, s[8:11], s18 offen sc1 lds
    s_add_u32 m0, s74, 36864
    s_add_u32 s69, s18, 28672
    buffer_load_dwordx4 v3, s[8:11], s69 offen sc1 lds
    s_add_u32 m0, s74, 12288
    s_nop 0
    s_nop 0
    buffer_load_dwordx4 v3, s[8:11], s19 offen sc1 lds
    s_add_u32 m0, s74, 40960
    s_add_u32 s69, s19, 28672
    buffer_load_dwordx4 v3, s[8:11], s69 offen sc1 lds
    ds_read_b128 v[208:211], v84 offset:0
    ds_read_b128 v[212:215], v85 offset:0
    ds_read_b128 v[216:219], v86 offset:0
    ds_read_b128 v[220:223], v87 offset:0
    ds_read_b128 v[224:227], v84 offset:16384
    ds_read_b128 v[228:231], v85 offset:16384
    ds_read_b128 v[232:235], v86 offset:16384
    ds_read_b128 v[236:239], v87 offset:16384
    ds_read_b128 v[240:243], v84 offset:32768
    ds_read_b128 v[244:247], v85 offset:32768
    ds_read_b128 v[248:251], v86 offset:32768
    ds_read_b128 v[252:255], v87 offset:32768
    v_dot2_f32_bf16 v60, v192, v57, v60
    v_dot2_f32_bf16 v61, v192, v192, v61
    v_dot2_f32_bf16 v60, v193, v57, v60
    v_dot2_f32_bf16 v61, v193, v193, v61
    v_dot2_f32_bf16 v60, v194, v57, v60
    v_dot2_f32_bf16 v61, v194, v194, v61
    v_dot2_f32_bf16 v60, v195, v57, v60
    v_dot2_f32_bf16 v61, v195, v195, v61
    v_dot2_f32_bf16 v60, v196, v57, v60
    v_dot2_f32_bf16 v61, v196, v196, v61
    v_dot2_f32_bf16 v60, v197, v57, v60
    v_dot2_f32_bf16 v61, v197, v197, v61
    v_dot2_f32_bf16 v60, v198, v57, v60
    v_dot2_f32_bf16 v61, v198, v198, v61
    v_dot2_f32_bf16 v60, v199, v57, v60
    v_dot2_f32_bf16 v61, v199, v199, v61
    v_dot2_f32_bf16 v60, v200, v57, v60
    v_dot2_f32_bf16 v61, v200, v200, v61
    v_dot2_f32_bf16 v60, v201, v57, v60
    v_dot2_f32_bf16 v61, v201, v201, v61
    v_dot2_f32_bf16 v60, v202, v57, v60
    v_dot2_f32_bf16 v61, v202, v202, v61
    v_dot2_f32_bf16 v60, v203, v57, v60
    v_dot2_f32_bf16 v61, v203, v203, v61
    v_dot2_f32_bf16 v60, v204, v57, v60
    v_dot2_f32_bf16 v61, v204, v204, v61
    v_dot2_f32_bf16 v60, v205, v57, v60
    v_dot2_f32_bf16 v61, v205, v205, v61
    v_dot2_f32_bf16 v60, v206, v57, v60
    v_dot2_f32_bf16 v61, v206, v206, v61
    v_dot2_f32_bf16 v60, v207, v57, v60
    v_dot2_f32_bf16 v61, v207, v207, v61
    s_waitcnt lgkmcnt(0)
    s_add_u32 m0, s74, 16384
    s_nop 0
    buffer_load_dwordx4 v3, s[8:11], s20 offen sc1 lds
    s_add_u32 m0, s74, 45056
    s_add_u32 s69, s20, 28672
    buffer_load_dwordx4 v3, s[8:11], s69 offen sc1 lds
    v_dot2_f32_bf16 v60, v208, v57, v60
    v_dot2_f32_bf16 v61, v208, v208, v61
    v_dot2_f32_bf16 v60, v209, v57, v60
    v_dot2_f32_bf16 v61, v209, v209, v61
    v_dot2_f32_bf16 v60, v210, v57, v60
    v_dot2_f32_bf16 v61, v210, v210, v61
    v_dot2_f32_bf16 v60, v211, v57, v60
    v_dot2_f32_bf16 v61, v211, v211, v61
    v_dot2_f32_bf16 v60, v212, v57, v60
    v_dot2_f32_bf16 v61, v212, v212, v61
    v_dot2_f32_bf16 v60, v213, v57, v60
    v_dot2_f32_bf16 v61, v213, v213, v61
    v_dot2_f32_bf16 v60, v214, v57, v60
    v_dot2_f32_bf16 v61, v214, v214, v61
    v_dot2_f32_bf16 v60, v215, v57, v60
    v_dot2_f32_bf16 v61, v215, v215, v61
    v_dot2_f32_bf16 v60, v216, v57, v60
    v_dot2_f32_bf16 v61, v216, v216, v61
    v_dot2_f32_bf16 v60, v217, v57, v60
    v_dot2_f32_bf16 v61, v217, v217, v61
    v_dot2_f32_bf16 v60, v218, v57, v60
    v_dot2_f32_bf16 v61, v218, v218, v61
    v_dot2_f32_bf16 v60, v219, v57, v60
    v_dot2_f32_bf16 v61, v219, v219, v61
    v_dot2_f32_bf16 v60, v220, v57, v60
    v_dot2_f32_bf16 v61, v220, v220, v61
    v_dot2_f32_bf16 v60, v221, v57, v60
    v_dot2_f32_bf16 v61, v221, v221, v61
    v_dot2_f32_bf16 v60, v222, v57, v60
    v_dot2_f32_bf16 v61, v222, v222, v61
    v_dot2_f32_bf16 v60, v223, v57, v60
    v_dot2_f32_bf16 v61, v223, v223, v61
    s_add_u32 m0, s74, 20480
    s_nop 0
    s_nop 0
    buffer_load_dwordx4 v3, s[8:11], s21 offen sc1 lds
    s_add_u32 m0, s74, 49152
    s_add_u32 s69, s21, 28672
    buffer_load_dwordx4 v3, s[8:11], s69 offen sc1 lds
    v_dot2_f32_bf16 v60, v224, v57, v60
    v_dot2_f32_bf16 v61, v224, v224, v61
    v_dot2_f32_bf16 v60, v225, v57, v60
    v_dot2_f32_bf16 v61, v225, v225, v61
    v_dot2_f32_bf16 v60, v226, v57, v60
    v_dot2_f32_bf16 v61, v226, v226, v61
    v_dot2_f32_bf16 v60, v227, v57, v60
    v_dot2_f32_bf16 v61, v227, v227, v61
    v_dot2_f32_bf16 v60, v228, v57, v60
    v_dot2_f32_bf16 v61, v228, v228, v61
    v_dot2_f32_bf16 v60, v229, v57, v60
    v_dot2_f32_bf16 v61, v229, v229, v61
    v_dot2_f32_bf16 v60, v230, v57, v60
    v_dot2_f32_bf16 v61, v230, v230, v61
    v_dot2_f32_bf16 v60, v231, v57, v60
    v_dot2_f32_bf16 v61, v231, v231, v61
    v_dot2_f32_bf16 v60, v232, v57, v60
    v_dot2_f32_bf16 v61, v232, v232, v61
    v_dot2_f32_bf16 v60, v233, v57, v60
    v_dot2_f32_bf16 v61, v233, v233, v61
    v_dot2_f32_bf16 v60, v234, v57, v60
    v_dot2_f32_bf16 v61, v234, v234, v61
    v_dot2_f32_bf16 v60, v235, v57, v60
    v_dot2_f32_bf16 v61, v235, v235, v61
    v_dot2_f32_bf16 v60, v236, v57, v60
    v_dot2_f32_bf16 v61, v236, v236, v61
    v_dot2_f32_bf16 v60, v237, v57, v60
    v_dot2_f32_bf16 v61, v237, v237, v61
    v_dot2_f32_bf16 v60, v238, v57, v60
    v_dot2_f32_bf16 v61, v238, v238, v61
    v_dot2_f32_bf16 v60, v239, v57, v60
    v_dot2_f32_bf16 v61, v239, v239, v61
    s_add_u32 m0, s74, 24576
    s_nop 0
    s_nop 0
    buffer_load_dwordx4 v3, s[8:11], s22 offen sc1 lds
    s_add_u32 m0, s74, 53248
    s_add_u32 s69, s22, 28672
    buffer_load_dwordx4 v3, s[8:11], s69 offen sc1 lds
    v_dot2_f32_bf16 v60, v240, v57, v60
    v_dot2_f32_bf16 v61, v240, v240, v61
    v_dot2_f32_bf16 v60, v241, v57, v60
    v_dot2_f32_bf16 v61, v241, v241, v61
    v_dot2_f32_bf16 v60, v242, v57, v60
    v_dot2_f32_bf16 v61, v242, v242, v61
    v_dot2_f32_bf16 v60, v243, v57, v60
    v_dot2_f32_bf16 v61, v243, v243, v61
    v_dot2_f32_bf16 v60, v244, v57, v60
    v_dot2_f32_bf16 v61, v244, v244, v61
    v_dot2_f32_bf16 v60, v245, v57, v60
    v_dot2_f32_bf16 v61, v245, v245, v61
    v_dot2_f32_bf16 v60, v246, v57, v60
    v_dot2_f32_bf16 v61, v246, v246, v61
    v_dot2_f32_bf16 v60, v247, v57, v60
    v_dot2_f32_bf16 v61, v247, v247, v61
    v_dot2_f32_bf16 v60, v248, v57, v60
    v_dot2_f32_bf16 v61, v248, v248, v61
    v_dot2_f32_bf16 v60, v249, v57, v60
    v_dot2_f32_bf16 v61, v249, v249, v61
    v_dot2_f32_bf16 v60, v250, v57, v60
    v_dot2_f32_bf16 v61, v250, v250, v61
    v_dot2_f32_bf16 v60, v251, v57, v60
    v_dot2_f32_bf16 v61, v251, v251, v61
    v_dot2_f32_bf16 v60, v252, v57, v60
    v_dot2_f32_bf16 v61, v252, v252, v61
    v_dot2_f32_bf16 v60, v253, v57, v60
    v_dot2_f32_bf16 v61, v253, v253, v61
    v_dot2_f32_bf16 v60, v254, v57, v60
    v_dot2_f32_bf16 v61, v254, v254, v61
    v_dot2_f32_bf16 v60, v255, v57, v60
    v_dot2_f32_bf16 v61, v255, v255, v61
    s_mul_i32 s80, s49, 10752
    s_mul_i32 s3, s50, 3072
    s_add_u32 s80, s80, s3
    s_add_u32 s80, s80, 30408704
    s_add_u32 m0, s3, 143360
    s_nop 0
    buffer_load_dwordx4 v1, s[8:11], s80 offen offset:0 sc1 lds
    buffer_load_dwordx4 v1, s[8:11], s80 offen offset:1024 sc1 lds
    buffer_load_dwordx4 v1, s[8:11], s80 offen offset:2048 sc1 lds
    s_lshl_b32 s80, s94, 2
    s_add_u32 s80, s80, s50
    s_lshl_b32 s80, s80, 12
    s_add_u32 s80, s80, 29360128
    v_lshlrev_b32 v59, 7, v0
    s_mov_b64 exec, 2139062143
    buffer_load_dword a255, v59, s[8:11], s80 offen sc1
    s_mov_b64 exec, -1
    v_lshlrev_b32 v104, 5, v0
    s_mov_b32 s3, 25952256
    buffer_load_dwordx4 v[96:99], v104, s[8:11], s3 offen sc1
    buffer_load_dwordx4 v[100:103], v104, s[8:11], s3 offen offset:16 sc1
    v_mov_b32 v58, v60
    s_nop 1
    v_permlane32_swap_b32 v60, v58
    v_add_f32 v60, v60, v58
    v_mov_b32 v58, v61
    s_nop 1
    v_permlane32_swap_b32 v61, v58
    v_add_f32 v61, v61, v58
    v_mul_f32 v60, 0x3b124925, v60
    v_mul_f32 v61, 0x3b124925, v61
    v_fma_f32 v61, -v60, v60, v61
    v_max_f32_e64 v61, 0, v61
    v_cvt_pk_bf16_f32 v54, v60, v60
    v_cvt_pk_bf16_f32 v61, v61, v61
    v_and_b32 v61, 0xffff0000, v61
    v_add_f32 v61, 0x3727c5ac, v61
    v_cvt_pk_bf16_f32 v61, v61, v61
    v_and_b32 v61, 0xffff0000, v61
    v_sqrt_f32 v61, v61
    s_nop 0
    v_cvt_pk_bf16_f32 v61, v61, v61
    v_and_b32 v61, 0xffff0000, v61
    v_rcp_f32 v56, v61
    s_nop 0
    ds_write_b32 v12, v56
    s_waitcnt vmcnt(12)
    s_waitcnt lgkmcnt(0)
    s_barrier
    s_nop 0
    ds_read_b128 v[112:115], v1 offset:0
    ds_read_b128 v[116:119], v1 offset:28672
    ds_read_b128 v[120:123], v1 offset:1024
    ds_read_b128 v[124:127], v1 offset:29696
    ds_read_b128 v[128:131], v1 offset:2048
    ds_read_b128 v[132:135], v1 offset:30720
    s_cmp_lg_u32 s50, 3
    s_cbranch_scc1 Lfx_14
    v_mov_b32 v106, s4
    v_mov_b32 v107, s5
    s_and_b32 s3, s101, 3
    s_lshl_b32 s3, s3, 9
    s_lshr_b32 s6, s101, 2
    s_lshl_b32 s6, s6, 3
    s_add_u32 s3, s3, s6
    s_add_u32 s3, s3, 25954304
    s_mov_b64 exec, 1
    buffer_store_dwordx2 v[106:107], v0, s[8:11], s3 offen sc1
    s_mov_b64 exec, -1
Lfx_14:
    s_waitcnt lgkmcnt(4)
    v_mfma_f32_32x32x16_bf16 v[64:79], v[112:115], v[144:147], 0
    v_mfma_f32_32x32x16_bf16 v[80:95], v[144:147], v[116:119], 0
    ds_read_b128 v[136:139], v1 offset:3072
    ds_read_b128 v[140:143], v1 offset:31744
    s_waitcnt lgkmcnt(4)
    s_nop 0
    v_mfma_f32_32x32x16_bf16 v[64:79], v[120:123], v[148:151], v[64:79]
    v_mfma_f32_32x32x16_bf16 v[80:95], v[148:151], v[124:127], v[80:95]
    ds_read_b128 v[112:115], v1 offset:4096
    ds_read_b128 v[116:119], v1 offset:32768
    s_waitcnt lgkmcnt(4)
    s_nop 0
    v_mfma_f32_32x32x16_bf16 v[64:79], v[128:131], v[152:155], v[64:79]
    v_mfma_f32_32x32x16_bf16 v[80:95], v[152:155], v[132:135], v[80:95]
    ds_read_b128 v[120:123], v1 offset:5120
    ds_read_b128 v[124:127], v1 offset:33792
    s_waitcnt lgkmcnt(4)
    s_nop 0
    v_mfma_f32_32x32x16_bf16 v[64:79], v[136:139], v[156:159], v[64:79]
    v_mfma_f32_32x32x16_bf16 v[80:95], v[156:159], v[140:143], v[80:95]
    ds_read_b128 v[128:131], v1 offset:6144
    ds_read_b128 v[132:135], v1 offset:34816
    s_waitcnt lgkmcnt(4)
    s_nop 0
    v_mfma_f32_32x32x16_bf16 v[64:79], v[112:115], v[160:163], v[64:79]
    v_mfma_f32_32x32x16_bf16 v[80:95], v[160:163], v[116:119], v[80:95]
    ds_read_b128 v[136:139], v1 offset:7168
    ds_read_b128 v[140:143], v1 offset:35840
    s_waitcnt lgkmcnt(4)
    s_nop 0
    v_mfma_f32_32x32x16_bf16 v[64:79], v[120:123], v[164:167], v[64:79]
    v_mfma_f32_32x32x16_bf16 v[80:95], v[164:167], v[124:127], v[80:95]
    ds_read_b128 v[112:115], v1 offset:8192
    ds_read_b128 v[116:119], v1 offset:36864
    s_waitcnt lgkmcnt(4)
    s_nop 0
    v_mfma_f32_32x32x16_bf16 v[64:79], v[128:131], v[168:171], v[64:79]
    v_mfma_f32_32x32x16_bf16 v[80:95], v[168:171], v[132:135], v[80:95]
    ds_read_b128 v[120:123], v1 offset:9216
    ds_read_b128 v[124:127], v1 offset:37888
    s_waitcnt lgkmcnt(4)
    s_nop 0
    v_mfma_f32_32x32x16_bf16 v[64:79], v[136:139], v[172:175], v[64:79]
    v_mfma_f32_32x32x16_bf16 v[80:95], v[172:175], v[140:143], v[80:95]
    ds_read_b128 v[128:131], v1 offset:10240
    ds_read_b128 v[132:135], v1 offset:38912
    s_waitcnt lgkmcnt(4)
    s_nop 0
    v_mfma_f32_32x32x16_bf16 v[64:79], v[112:115], v[176:179], v[64:79]
    v_mfma_f32_32x32x16_bf16 v[80:95], v[176:179], v[116:119], v[80:95]
    ds_read_b128 v[136:139], v1 offset:11264
    ds_read_b128 v[140:143], v1 offset:39936
    s_add_u32 m0, s74, 57344
    s_add_u32 s69, s16, 57344
    buffer_load_dwordx4 v3, s[8:11], s69 offen sc1 lds
    s_waitcnt lgkmcnt(4)
    s_nop 0
    v_mfma_f32_32x32x16_bf16 v[64:79], v[120:123], v[180:183], v[64:79]
    v_mfma_f32_32x32x16_bf16 v[80:95], v[180:183], v[124:127], v[80:95]
    ds_read_b128 v[112:115], v1 offset:12288
    ds_read_b128 v[116:119], v1 offset:40960
    s_add_u32 m0, s74, 61440
    s_add_u32 s69, s17, 57344
    buffer_load_dwordx4 v3, s[8:11], s69 offen sc1 lds
    s_waitcnt lgkmcnt(4)
    s_nop 0
    v_mfma_f32_32x32x16_bf16 v[64:79], v[128:131], v[184:187], v[64:79]
    v_mfma_f32_32x32x16_bf16 v[80:95], v[184:187], v[132:135], v[80:95]
    ds_read_b128 v[120:123], v1 offset:13312
    ds_read_b128 v[124:127], v1 offset:41984
    s_add_u32 m0, s74, 65536
    s_add_u32 s69, s18, 57344
    buffer_load_dwordx4 v3, s[8:11], s69 offen sc1 lds
    s_waitcnt lgkmcnt(4)
    s_nop 0
    v_mfma_f32_32x32x16_bf16 v[64:79], v[136:139], v[188:191], v[64:79]
    v_mfma_f32_32x32x16_bf16 v[80:95], v[188:191], v[140:143], v[80:95]
    ds_read_b128 v[128:131], v1 offset:14336
    ds_read_b128 v[132:135], v1 offset:43008
    s_add_u32 m0, s74, 69632
    s_add_u32 s69, s19, 57344
    buffer_load_dwordx4 v3, s[8:11], s69 offen sc1 lds
    s_waitcnt lgkmcnt(4)
    s_nop 0
    v_mfma_f32_32x32x16_bf16 v[64:79], v[112:115], v[192:195], v[64:79]
    v_mfma_f32_32x32x16_bf16 v[80:95], v[192:195], v[116:119], v[80:95]
    ds_read_b128 v[136:139], v1 offset:15360
    ds_read_b128 v[140:143], v1 offset:44032
    s_add_u32 m0, s74, 73728
    s_add_u32 s69, s20, 57344
    buffer_load_dwordx4 v3, s[8:11], s69 offen sc1 lds
    s_waitcnt lgkmcnt(4)
    s_nop 0
    v_mfma_f32_32x32x16_bf16 v[64:79], v[120:123], v[196:199], v[64:79]
    v_mfma_f32_32x32x16_bf16 v[80:95], v[196:199], v[124:127], v[80:95]
    s_add_u32 m0, s74, 77824
    s_add_u32 s69, s21, 57344
    buffer_load_dwordx4 v3, s[8:11], s69 offen sc1 lds
    s_waitcnt lgkmcnt(2)
    s_nop 0
    v_mfma_f32_32x32x16_bf16 v[64:79], v[128:131], v[200:203], v[64:79]
    v_mfma_f32_32x32x16_bf16 v[80:95], v[200:203], v[132:135], v[80:95]
    s_add_u32 m0, s74, 81920
    s_add_u32 s69, s22, 57344
    buffer_load_dwordx4 v3, s[8:11], s69 offen sc1 lds
    s_waitcnt lgkmcnt(0)
    v_mfma_f32_32x32x16_bf16 v[64:79], v[136:139], v[204:207], v[64:79]
    v_mfma_f32_32x32x16_bf16 v[80:95], v[204:207], v[140:143], v[80:95]
    s_mov_b32 s55, 0
    s_waitcnt vmcnt(7)
Lfp_15:
    v_xor_b32 v96, s4, v96
    v_xor_b32 v97, s5, v97
    v_xor_b32 v98, s4, v98
    v_xor_b32 v99, s5, v99
    v_xor_b32 v100, s4, v100
    v_xor_b32 v101, s5, v101
    v_xor_b32 v102, s4, v102
    v_xor_b32 v103, s5, v103
    v_or3_b32 v96, v96, v98, v100
    v_or_b32 v96, v96, v102
    v_or3_b32 v97, v97, v99, v101
    v_or_b32 v97, v97, v103
    v_and_b32 v98, -16, v96
    v_or_b32 v98, v98, v97
    v_cmp_ne_u32 vcc, 0, v98
    s_nop 0
    s_cmp_eq_u64 vcc, 0
    s_nop 1
    s_cbranch_scc0 Lfr_16
Lgo_17:
    v_cmp_eq_u32 vcc, 0, v96
    s_nop 0
    s_lshr_b64 s[84:85], vcc, s48
    s_and_b32 s3, s84, s85
    s_and_b32 s3, s3, 65537
    s_cmp_eq_u32 s3, 65537
    s_cselect_b32 s53, 1, 0
    s_barrier
    ds_read_b128 v[112:115], v1 offset:16384
    ds_read_b128 v[116:119], v1 offset:45056
    ds_read_b128 v[120:123], v1 offset:17408
    ds_read_b128 v[124:127], v1 offset:46080
    ds_read_b128 v[128:131], v1 offset:18432
    ds_read_b128 v[132:135], v1 offset:47104
    s_add_u32 s65, s57, 6291456
    s_cmp_eq_u32 s53, 0
    s_cbranch_scc1 Lslow_18
    buffer_store_dwordx4 v[108:111], v1, s[8:11], s65 offen offset:0
    buffer_store_dwordx4 v[108:111], v1, s[8:11], s65 offen offset:1024
Ldone_19:
    s_waitcnt lgkmcnt(4)
    v_mfma_f32_32x32x16_bf16 v[64:79], v[112:115], v[208:211], v[64:79]
    v_lshlrev_b32 v55, 2, v0
    v_add_u32 v55, 143360, v55
    ds_read_b32 v32, v55 offset:0
    ds_read_b32 v33, v55 offset:256
    ds_read_b32 v34, v55 offset:512
    ds_read_b32 v35, v55 offset:768
    ds_read_b32 v36, v55 offset:1024
    ds_read_b32 v37, v55 offset:1280
    ds_read_b32 v38, v55 offset:1536
    v_mfma_f32_32x32x16_bf16 v[80:95], v[208:211], v[116:119], v[80:95]
    ds_read_b128 v[136:139], v1 offset:19456
    ds_read_b128 v[140:143], v1 offset:48128
    s_add_u32 s81, s50, 0
    s_and_b32 s81, s81, 3
    s_lshl_b32 s81, s81, 13
    s_add_u32 s81, s81, s86
    s_add_u32 s81, s81, 29360128
    buffer_load_dwordx4 a[0:3], v3, s[8:11], s81 offen offset:0 sc1
    s_waitcnt lgkmcnt(11)
    s_nop 0
    v_mfma_f32_32x32x16_bf16 v[64:79], v[120:123], v[212:215], v[64:79]
    ds_read_b32 v39, v55 offset:1792
    ds_read_b32 v40, v55 offset:2048
    ds_read_b32 v41, v55 offset:2304
    ds_read_b32 v42, v55 offset:2560
    ds_read_b32 v43, v55 offset:2816
    ds_read_b32 v44, v55 offset:3072
    ds_read_b32 v45, v55 offset:3328
    v_mfma_f32_32x32x16_bf16 v[80:95], v[212:215], v[124:127], v[80:95]
    ds_read_b128 v[112:115], v1 offset:20480
    ds_read_b128 v[116:119], v1 offset:49152
    buffer_load_dwordx4 a[4:7], v3, s[8:11], s81 offen offset:1024 sc1
    s_waitcnt lgkmcnt(15)
    v_mfma_f32_32x32x16_bf16 v[64:79], v[128:131], v[216:219], v[64:79]
    s_waitcnt lgkmcnt(2)
    v_add_f32 v32, v32, v33
    v_add_f32 v32, v32, v34
    v_add_f32_e64 v32, v32, v35
    v_mfma_f32_32x32x16_bf16 v[80:95], v[216:219], v[132:135], v[80:95]
    ds_read_b128 v[120:123], v1 offset:21504
    ds_read_b128 v[124:127], v1 offset:50176
    v_add_f32 v32, v32, v36
    v_add_f32 v32, v32, v37
    v_add_f32_e64 v32, v32, v38
    buffer_load_dwordx4 a[8:11], v3, s[8:11], s81 offen offset:2048 sc1
    v_mfma_f32_32x32x16_bf16 v[64:79], v[136:139], v[220:223], v[64:79]
    v_add_f32 v32, v32, v39
    v_add_f32 v32, v32, v40
    v_add_f32 v32, v32, v41
    v_add_f32 v32, v32, v42
    v_mfma_f32_32x32x16_bf16 v[80:95], v[220:223], v[140:143], v[80:95]
    ds_read_b128 v[128:131], v1 offset:22528
    ds_read_b128 v[132:135], v1 offset:51200
    v_add_f32 v32, v32, v43
    v_add_f32 v32, v32, v44
    v_add_f32 v32, v32, v45
    buffer_load_dwordx4 a[12:15], v3, s[8:11], s81 offen offset:3072 sc1
    s_waitcnt lgkmcnt(4)
    v_mfma_f32_32x32x16_bf16 v[64:79], v[112:115], v[224:227], v[64:79]
    v_mov_b32 v33, v32
    s_nop 1
    v_permlane32_swap_b32 v32, v33
    v_add_f32 v32, v32, v33
    v_cmp_gt_u32 vcc, 448, v3
    v_mfma_f32_32x32x16_bf16 v[80:95], v[224:227], v[116:119], v[80:95]
    ds_read_b128 v[136:139], v1 offset:23552
    ds_read_b128 v[140:143], v1 offset:52224
    v_sub_f32 v32, 0, v32
    v_cndmask_b32 v32, 0, v32, vcc
    v_cvt_pk_bf16_f32 v33, v32, v32
    v_and_b32 v33, 0xffff0000, v33
    s_add_u32 s81, s81, 4096
    buffer_load_dwordx4 a[16:19], v3, s[8:11], s81 offen offset:0 sc1
    s_waitcnt lgkmcnt(4)
    v_mfma_f32_32x32x16_bf16 v[64:79], v[120:123], v[228:231], v[64:79]
    v_sub_f32 v34, v32, v33
    v_cvt_pk_bf16_f32 v49, v33, v34
    ds_read_b32 v32, v55 offset:3584
    ds_read_b32 v33, v55 offset:3840
    ds_read_b32 v34, v55 offset:4096
    ds_read_b32 v35, v55 offset:4352
    ds_read_b32 v36, v55 offset:4608
    ds_read_b32 v37, v55 offset:4864
    ds_read_b32 v38, v55 offset:5120
    v_mfma_f32_32x32x16_bf16 v[80:95], v[228:231], v[124:127], v[80:95]
    ds_read_b128 v[112:115], v1 offset:24576
    ds_read_b128 v[116:119], v1 offset:53248
    buffer_load_dwordx4 a[20:23], v3, s[8:11], s81 offen offset:1024 sc1
    s_waitcnt lgkmcnt(11)
    s_nop 0
    v_mfma_f32_32x32x16_bf16 v[64:79], v[128:131], v[232:235], v[64:79]
    ds_read_b32 v39, v55 offset:5376
    ds_read_b32 v40, v55 offset:5632
    ds_read_b32 v41, v55 offset:5888
    ds_read_b32 v42, v55 offset:6144
    ds_read_b32 v43, v55 offset:6400
    ds_read_b32 v44, v55 offset:6656
    ds_read_b32 v45, v55 offset:6912
    v_mfma_f32_32x32x16_bf16 v[80:95], v[232:235], v[132:135], v[80:95]
    ds_read_b128 v[120:123], v1 offset:25600
    ds_read_b128 v[124:127], v1 offset:54272
    buffer_load_dwordx4 a[24:27], v3, s[8:11], s81 offen offset:2048 sc1
    s_waitcnt lgkmcnt(15)
    v_mfma_f32_32x32x16_bf16 v[64:79], v[136:139], v[236:239], v[64:79]
    s_waitcnt lgkmcnt(2)
    v_add_f32 v32, v32, v33
    v_add_f32 v32, v32, v34
    v_add_f32_e64 v32, v32, v35
    v_mfma_f32_32x32x16_bf16 v[80:95], v[236:239], v[140:143], v[80:95]
    ds_read_b128 v[128:131], v1 offset:26624
    ds_read_b128 v[132:135], v1 offset:55296
    v_add_f32 v32, v32, v36
    v_add_f32 v32, v32, v37
    v_add_f32_e64 v32, v32, v38
    s_add_u32 s75, s62, 16777216
    buffer_store_dwordx4 v[108:111], v1, s[8:11], s75 offen offset:0 sc1
    v_mfma_f32_32x32x16_bf16 v[64:79], v[112:115], v[240:243], v[64:79]
    v_add_f32 v32, v32, v39
    v_add_f32 v32, v32, v40
    v_add_f32 v32, v32, v41
    v_add_f32 v32, v32, v42
    v_mfma_f32_32x32x16_bf16 v[80:95], v[240:243], v[116:119], v[80:95]
    ds_read_b128 v[136:139], v1 offset:27648
    ds_read_b128 v[140:143], v1 offset:56320
    v_add_f32 v32, v32, v43
    v_add_f32 v32, v32, v44
    v_add_f32 v32, v32, v45
    buffer_store_dwordx4 v[108:111], v1, s[8:11], s75 offen offset:1024 sc1
    s_waitcnt lgkmcnt(4)
    v_mfma_f32_32x32x16_bf16 v[64:79], v[120:123], v[244:247], v[64:79]
    v_mov_b32 v33, v32
    s_nop 1
    v_permlane32_swap_b32 v32, v33
    v_add_f32 v32, v32, v33
    v_cmp_gt_u32 vcc, 448, v3
    v_mfma_f32_32x32x16_bf16 v[80:95], v[244:247], v[124:127], v[80:95]
    v_sub_f32 v32, 0, v32
    v_cndmask_b32 v32, 0, v32, vcc
    v_cvt_pk_bf16_f32 v33, v32, v32
    v_and_b32 v33, 0xffff0000, v33
    buffer_store_dwordx4 v[108:111], v1, s[8:11], s75 offen offset:2048 sc1
    s_waitcnt lgkmcnt(2)
    v_mfma_f32_32x32x16_bf16 v[64:79], v[128:131], v[248:251], v[64:79]
    v_sub_f32 v34, v32, v33
    v_cvt_pk_bf16_f32 v50, v33, v34
    v_mfma_f32_32x32x16_bf16 v[80:95], v[248:251], v[132:135], v[80:95]
    buffer_store_dwordx4 v[108:111], v1, s[8:11], s75 offen offset:3072 sc1
    s_waitcnt lgkmcnt(0)
    s_nop 0
    v_mfma_f32_32x32x16_bf16 v[64:79], v[136:139], v[252:255], v[64:79]
    v_mfma_f32_32x32x16_bf16 v[80:95], v[252:255], v[140:143], v[80:95]
    s_add_u32 s75, s97, 15728640
    buffer_store_dwordx4 v[108:111], v1, s[8:11], s75 offen offset:0 sc1
    v_mov_b32 v112, v54
    v_mov_b32 v116, v49
    v_mov_b32 v120, v50
    v_mov_b32 v113, 0
    v_mov_b32 v117, 0
    v_mov_b32 v121, 0
    v_mov_b32 v114, 0
    v_mov_b32 v118, 0
    v_mov_b32 v122, 0
    v_mov_b32 v115, 0
    v_mov_b32_e64 v119, 0
    v_mov_b32 v123, 0
    s_nop 0
    v_mfma_f32_32x32x16_bf16 v[64:79], v[116:119], v[112:115], v[64:79]
    v_mfma_f32_32x32x16_bf16 v[80:95], v[112:115], v[120:123], v[80:95]
    ds_read_b128 v[128:131], v13 offset:0
    ds_read_b128 v[132:135], v13 offset:32
    ds_read_b128 v[136:139], v13 offset:64
    ds_read_b128 v[140:143], v13 offset:96
    s_nop 6
    s_nop 0
    v_cvt_pk_bf16_f32 v64, v64, v65
    v_cvt_pk_bf16_f32 v65, v66, v67
    v_cvt_pk_bf16_f32 v66, v68, v69
    v_cvt_pk_bf16_f32 v67, v70, v71
    v_cvt_pk_bf16_f32 v68, v72, v73
    v_cvt_pk_bf16_f32 v69, v74, v75
    v_cvt_pk_bf16_f32 v70, v76, v77
    v_cvt_pk_bf16_f32 v71, v78, v79
    v_mfma_f32_32x32x16_bf16 v[112:127], v[24:27], v[64:67], 0
    s_nop 0
    v_mfma_f32_32x32x16_bf16 v[112:127], v[28:31], v[68:71], v[112:127]
    s_waitcnt lgkmcnt(0)
    v_pk_fma_f32 v[80:81], v[80:81], v[128:129], v[2:3] op_sel_hi:[1,1,0]
    v_pk_fma_f32 v[82:83], v[82:83], v[130:131], v[2:3] op_sel_hi:[1,1,0]
    v_pk_fma_f32 v[84:85], v[84:85], v[132:133], v[2:3] op_sel_hi:[1,1,0]
    v_pk_fma_f32 v[86:87], v[86:87], v[134:135], v[2:3] op_sel_hi:[1,1,0]
    v_pk_fma_f32 v[88:89], v[88:89], v[136:137], v[2:3] op_sel_hi:[1,1,0]
    v_pk_fma_f32 v[90:91], v[90:91], v[138:139], v[2:3] op_sel_hi:[1,1,0]
    v_pk_fma_f32 v[92:93], v[92:93], v[140:141], v[2:3] op_sel_hi:[1,1,0]
    v_pk_fma_f32 v[94:95], v[94:95], v[142:143], v[2:3] op_sel_hi:[1,1,0]
    v_cvt_pk_bf16_f32 v80, v80, v81
    v_cvt_pk_bf16_f32 v81, v82, v83
    v_cvt_pk_bf16_f32 v82, v84, v85
    v_cvt_pk_bf16_f32 v83, v86, v87
    v_cvt_pk_bf16_f32 v84, v88, v89
    v_cvt_pk_bf16_f32 v85, v90, v91
    v_cvt_pk_bf16_f32 v86, v92, v93
    v_cvt_pk_bf16_f32 v87, v94, v95
    buffer_load_dwordx4 a[28:31], v3, s[8:11], s81 offen offset:3072 sc1
    s_add_u32 s81, s50, 1
    s_and_b32 s81, s81, 3
    s_lshl_b32 s81, s81, 13
    s_add_u32 s81, s81, s86
    s_add_u32 s81, s81, 29360128
    buffer_load_dwordx4 a[32:35], v3, s[8:11], s81 offen offset:0 sc1
    buffer_load_dwordx4 a[36:39], v3, s[8:11], s81 offen offset:1024 sc1
    buffer_load_dwordx4 a[40:43], v3, s[8:11], s81 offen offset:2048 sc1
    buffer_load_dwordx4 a[44:47], v3, s[8:11], s81 offen offset:3072 sc1
    ds_write_b128 v22, v[80:83]
    ds_write_b128 v22, v[84:87] offset:1024
    v_mul_f32 v57, 0x3fb8aa3b, v56
    v_max3_f32 v58, v112, v113, v114
    v_min3_f32 v60, v112, v113, v114
    v_max3_f32 v58, v115, v116, v58
    v_min3_f32 v60, v115, v116, v60
    v_max3_f32 v58, v117, v118, v58
    v_min3_f32 v60, v117, v118, v60
    v_max3_f32 v58, v119, v120, v58
    v_min3_f32 v60, v119, v120, v60
    v_max3_f32 v58, v121, v122, v58
    v_min3_f32 v60, v121, v122, v60
    v_max3_f32 v62, v124, v125, v126
    v_min3_f32 v63, v124, v125, v126
    v_max_f32 v62, v62, v127
    v_min_f32 v63, v63, v127
    v_sub_f32 v62, v62, v20
    v_add_f32 v63, v63, v20
    v_max3_f32 v58, v123, v62, v58
    v_min3_f32 v60, v123, v63, v60
    v_mov_b32 v62, v58
    v_mov_b32 v63, v60
    s_nop 0
    v_permlane32_swap_b32 v58, v62
    v_permlane32_swap_b32 v60, v63
    v_max_f32 v58, v58, v62
    v_min_f32 v60, v60, v63
    v_mul_f32 v58, v57, v58
    v_mul_f32 v60, v57, v60
    v_add_f32 v59, v58, v20
    v_sub_f32_e64 v61, v60, v20
    v_pk_fma_f32 v[128:129], v[112:113], v[56:57], v[60:61] op_sel:[0,1,0] op_sel_hi:[1,1,0] neg_lo:[1,0,0] neg_hi:[1,0,0]
    v_pk_fma_f32 v[112:113], v[112:113], v[56:57], v[58:59] op_sel:[0,1,0] op_sel_hi:[1,1,0] neg_lo:[0,0,1] neg_hi:[0,0,1]
    v_pk_fma_f32 v[130:131], v[114:115], v[56:57], v[60:61] op_sel:[0,1,0] op_sel_hi:[1,1,0] neg_lo:[1,0,0] neg_hi:[1,0,0]
    v_pk_fma_f32 v[114:115], v[114:115], v[56:57], v[58:59] op_sel:[0,1,0] op_sel_hi:[1,1,0] neg_lo:[0,0,1] neg_hi:[0,0,1]
    v_pk_fma_f32 v[132:133], v[116:117], v[56:57], v[60:61] op_sel:[0,1,0] op_sel_hi:[1,1,0] neg_lo:[1,0,0] neg_hi:[1,0,0]
    v_pk_fma_f32 v[116:117], v[116:117], v[56:57], v[58:59] op_sel:[0,1,0] op_sel_hi:[1,1,0] neg_lo:[0,0,1] neg_hi:[0,0,1]
    v_pk_fma_f32 v[134:135], v[118:119], v[56:57], v[60:61] op_sel:[0,1,0] op_sel_hi:[1,1,0] neg_lo:[1,0,0] neg_hi:[1,0,0]
    v_pk_fma_f32 v[118:119], v[118:119], v[56:57], v[58:59] op_sel:[0,1,0] op_sel_hi:[1,1,0] neg_lo:[0,0,1] neg_hi:[0,0,1]
    v_pk_fma_f32 v[136:137], v[120:121], v[56:57], v[60:61] op_sel:[0,1,0] op_sel_hi:[1,1,0] neg_lo:[1,0,0] neg_hi:[1,0,0]
    v_pk_fma_f32 v[120:121], v[120:121], v[56:57], v[58:59] op_sel:[0,1,0] op_sel_hi:[1,1,0] neg_lo:[0,0,1] neg_hi:[0,0,1]
    v_pk_fma_f32 v[138:139], v[122:123], v[56:57], v[60:61] op_sel:[0,1,0] op_sel_hi:[1,1,0] neg_lo:[1,0,0] neg_hi:[1,0,0]
    v_pk_fma_f32 v[122:123], v[122:123], v[56:57], v[58:59] op_sel:[0,1,0] op_sel_hi:[1,1,0] neg_lo:[0,0,1] neg_hi:[0,0,1]
    v_pk_fma_f32 v[140:141], v[124:125], v[56:57], v[60:61] op_sel:[0,1,1] op_sel_hi:[1,1,1] neg_lo:[1,0,0] neg_hi:[1,0,0]
    v_pk_fma_f32 v[124:125], v[124:125], v[56:57], v[58:59] op_sel:[0,1,1] op_sel_hi:[1,1,1] neg_lo:[0,0,1] neg_hi:[0,0,1]
    v_pk_fma_f32 v[142:143], v[126:127], v[56:57], v[60:61] op_sel:[0,1,1] op_sel_hi:[1,1,1] neg_lo:[1,0,0] neg_hi:[1,0,0]
    v_pk_fma_f32 v[126:127], v[126:127], v[56:57], v[58:59] op_sel:[0,1,1] op_sel_hi:[1,1,1] neg_lo:[0,0,1] neg_hi:[0,0,1]
    v_exp_f32 v128, v128
    v_exp_f32 v112, v112
    v_exp_f32 v129, v129
    v_exp_f32 v113, v113
    v_exp_f32 v130, v130
    v_exp_f32 v114, v114
    v_exp_f32 v131, v131
    v_exp_f32 v115, v115
    v_exp_f32 v132, v132
    v_exp_f32 v116, v116
    v_exp_f32 v133, v133
    v_exp_f32 v117, v117
    v_exp_f32 v134, v134
    v_exp_f32 v118, v118
    v_exp_f32 v135, v135
    v_exp_f32 v119, v119
    v_exp_f32 v136, v136
    v_exp_f32 v120, v120
    v_exp_f32 v137, v137
    v_exp_f32 v121, v121
    v_exp_f32 v138, v138
    v_exp_f32 v122, v122
    v_exp_f32 v139, v139
    v_exp_f32 v123, v123
    v_exp_f32 v140, v140
    v_exp_f32 v124, v124
    v_exp_f32 v141, v141
    v_exp_f32 v125, v125
    v_exp_f32 v142, v142
    v_exp_f32 v126, v126
    v_exp_f32 v143, v143
    v_exp_f32 v127, v127
    v_pk_add_f32 v[58:59], v[112:113], v[114:115]
    v_pk_add_f32 v[58:59], v[58:59], v[116:117]
    v_pk_add_f32 v[58:59], v[58:59], v[118:119]
    v_pk_add_f32 v[58:59], v[58:59], v[120:121]
    v_pk_add_f32 v[58:59], v[58:59], v[122:123]
    v_pk_add_f32 v[58:59], v[58:59], v[124:125]
    v_pk_add_f32 v[58:59], v[58:59], v[126:127]
    v_add_f32_e64 v58, v58, v59
    v_pk_add_f32 v[60:61], v[128:129], v[130:131]
    v_pk_add_f32 v[60:61], v[60:61], v[132:133]
    v_pk_add_f32 v[60:61], v[60:61], v[134:135]
    v_pk_add_f32 v[60:61], v[60:61], v[136:137]
    v_pk_add_f32 v[60:61], v[60:61], v[138:139]
    v_pk_add_f32 v[60:61], v[60:61], v[140:141]
    v_pk_add_f32 v[60:61], v[60:61], v[142:143]
    v_add_f32 v60, v60, v61
    v_mov_b32 v62, v58
    v_mov_b32 v63, v60
    s_nop 0
    v_permlane32_swap_b32 v58, v62
    v_permlane32_swap_b32 v60, v63
    v_add_f32 v58, v58, v62
    v_add_f32 v60, v60, v63
    v_rcp_f32 v58, v58
    v_rcp_f32 v60, v60
    v_pk_mul_f32 v[112:113], v[112:113], v[58:59] op_sel_hi:[1,0]
    v_pk_mul_f32 v[114:115], v[114:115], v[58:59] op_sel_hi:[1,0]
    v_pk_mul_f32 v[116:117], v[116:117], v[58:59] op_sel_hi:[1,0]
    v_pk_mul_f32 v[118:119], v[118:119], v[58:59] op_sel_hi:[1,0]
    v_pk_mul_f32 v[120:121], v[120:121], v[58:59] op_sel_hi:[1,0]
    v_pk_mul_f32 v[122:123], v[122:123], v[58:59] op_sel_hi:[1,0]
    v_pk_mul_f32 v[124:125], v[124:125], v[58:59] op_sel_hi:[1,0]
    v_pk_mul_f32 v[126:127], v[126:127], v[58:59] op_sel_hi:[1,0]
    v_cvt_pk_bf16_f32 v112, v112, v113
    v_cvt_pk_bf16_f32 v113, v114, v115
    v_cvt_pk_bf16_f32 v114, v116, v117
    v_cvt_pk_bf16_f32 v115, v118, v119
    v_cvt_pk_bf16_f32 v116, v120, v121
    v_cvt_pk_bf16_f32 v117, v122, v123
    v_cvt_pk_bf16_f32 v118, v124, v125
    v_cvt_pk_bf16_f32 v119, v126, v127
    ds_write_b64 v10, v[112:113] offset:0
    ds_write_b64 v10, v[114:115] offset:16
    ds_write_b64 v10, v[116:117] offset:32
    ds_write_b64 v10, v[118:119] offset:48
    v_pk_mul_f32 v[128:129], v[128:129], v[60:61] op_sel_hi:[1,0]
    v_pk_mul_f32 v[130:131], v[130:131], v[60:61] op_sel_hi:[1,0]
    v_pk_mul_f32 v[132:133], v[132:133], v[60:61] op_sel_hi:[1,0]
    v_pk_mul_f32 v[134:135], v[134:135], v[60:61] op_sel_hi:[1,0]
    v_pk_mul_f32 v[136:137], v[136:137], v[60:61] op_sel_hi:[1,0]
    v_pk_mul_f32 v[138:139], v[138:139], v[60:61] op_sel_hi:[1,0]
    v_pk_mul_f32 v[140:141], v[140:141], v[60:61] op_sel_hi:[1,0]
    v_pk_mul_f32 v[142:143], v[142:143], v[60:61] op_sel_hi:[1,0]
    v_cvt_pk_bf16_f32 v128, v128, v129
    v_cvt_pk_bf16_f32 v129, v130, v131
    v_cvt_pk_bf16_f32 v130, v132, v133
    v_cvt_pk_bf16_f32 v131, v134, v135
    v_cvt_pk_bf16_f32 v132, v136, v137
    v_cvt_pk_bf16_f32 v133, v138, v139
    v_cvt_pk_bf16_f32 v134, v140, v141
    v_cvt_pk_bf16_f32 v135, v142, v143
    ds_write_b64 v10, v[128:129] offset:8448
    ds_write_b64 v10, v[130:131] offset:8464
    ds_write_b64 v10, v[132:133] offset:8480
    ds_write_b64 v10, v[134:135] offset:8496
    s_waitcnt vmcnt(19)
    s_waitcnt vmcnt(17)
    s_add_u32 s81, s81, 4096
    buffer_load_dwordx4 a[48:51], v3, s[8:11], s81 offen offset:0 sc1
    buffer_load_dwordx4 a[52:55], v3, s[8:11], s81 offen offset:1024 sc1
    buffer_load_dwordx4 a[56:59], v3, s[8:11], s81 offen offset:2048 sc1
    buffer_load_dwordx4 a[60:63], v3, s[8:11], s81 offen offset:3072 sc1
    s_add_u32 s81, s50, 2
    s_and_b32 s81, s81, 3
    s_lshl_b32 s81, s81, 13
    s_add_u32 s81, s81, s86
    s_add_u32 s81, s81, 29360128
    buffer_load_dwordx4 a[64:67], v3, s[8:11], s81 offen offset:0 sc1
    v_lshlrev_b32 v62, 3, v0
    s_lshr_b32 s6, s49, 2
    s_lshl_b32 s6, s6, 9
    s_add_u32 s6, s6, 25954304
    s_lshl_b32 s7, s52, 9
    s_add_u32 s7, s7, 25954304
    buffer_load_dwordx2 v[58:59], v62, s[8:11], s6 offen sc1
    buffer_load_dwordx2 v[60:61], v62, s[8:11], s7 offen sc1
    s_waitcnt lgkmcnt(0)
    s_barrier
    s_cmp_lg_u32 s50, 3
    s_cbranch_scc1 Lfx_20
    v_mov_b32 v92, s4
    v_mov_b32 v93, s5
    s_and_b32 s3, s101, 3
    s_lshl_b32 s3, s3, 9
    s_lshr_b32 s6, s101, 2
    s_lshl_b32 s6, s6, 3
    s_add_u32 s3, s3, s6
    s_add_u32 s3, s3, 25956352
    s_mov_b64 exec, 1
    buffer_store_dwordx2 v[92:93], v0, s[8:11], s3 offen sc1
    s_mov_b64 exec, -1
Lfx_20:
    s_cmp_ge_u32 s50, 2
    s_cbranch_scc1 Lq_21
    s_nop 0
    v_add_u32 v55, 103424, v1
    ds_read_b64_tr_b16 v[112:113], v11 offset:0
    ds_read_b64_tr_b16 v[114:115], v11 offset:528
    ds_read_b128 v[64:67], v55 offset:0
    ds_read_b64_tr_b16 v[116:117], v11 offset:1056
    ds_read_b64_tr_b16 v[118:119], v11 offset:1584
    ds_read_b128 v[68:71], v55 offset:1024
    ds_read_b64_tr_b16 v[120:121], v11 offset:2112
    ds_read_b64_tr_b16 v[122:123], v11 offset:2640
    ds_read_b128 v[72:75], v55 offset:2048
    ds_read_b64_tr_b16 v[124:125], v11 offset:3168
    ds_read_b64_tr_b16 v[126:127], v11 offset:3696
    ds_read_b128 v[76:79], v55 offset:3072
    ds_read_b64_tr_b16 v[128:129], v11 offset:4224
    ds_read_b64_tr_b16 v[130:131], v11 offset:4752
    ds_read_b128 v[80:83], v55 offset:4096
    s_add_u32 s65, s60, 14680064
    s_waitcnt lgkmcnt(12)
    s_nop 0
    v_mfma_f32_32x32x16_bf16 v[96:111], v[112:115], v[64:67], 0
    ds_read_b64_tr_b16 v[132:133], v11 offset:5280
    ds_read_b64_tr_b16 v[134:135], v11 offset:5808
    ds_read_b128 v[84:87], v55 offset:5120
    s_waitcnt lgkmcnt(12)
    s_nop 0
    v_mfma_f32_32x32x16_bf16 v[96:111], v[116:119], v[68:71], v[96:111]
    ds_read_b64_tr_b16 v[136:137], v11 offset:6336
    ds_read_b64_tr_b16 v[138:139], v11 offset:6864
    ds_read_b128 v[88:91], v55 offset:6144
    s_waitcnt lgkmcnt(12)
    s_nop 0
    v_mfma_f32_32x32x16_bf16 v[96:111], v[120:123], v[72:75], v[96:111]
    ds_read_b64_tr_b16 v[140:141], v11 offset:7392
    ds_read_b64_tr_b16 v[142:143], v11 offset:7920
    ds_read_b128 v[92:95], v55 offset:7168
    s_waitcnt lgkmcnt(12)
    v_mfma_f32_32x32x16_bf16 v[96:111], v[124:127], v[76:79], v[96:111]
    s_waitcnt lgkmcnt(9)
    v_mfma_f32_32x32x16_bf16 v[96:111], v[128:131], v[80:83], v[96:111]
    s_waitcnt lgkmcnt(6)
    v_mfma_f32_32x32x16_bf16 v[96:111], v[132:135], v[84:87], v[96:111]
    s_waitcnt lgkmcnt(3)
    v_mfma_f32_32x32x16_bf16 v[96:111], v[136:139], v[88:91], v[96:111]
    s_waitcnt lgkmcnt(0)
    v_mfma_f32_32x32x16_bf16 v[96:111], v[140:143], v[92:95], v[96:111]
    s_nop 11
    v_cvt_pk_bf16_f32 v64, v96, v97
    v_cvt_pk_bf16_f32 v65, v98, v99
    v_cvt_pk_bf16_f32 v66, v100, v101
    v_cvt_pk_bf16_f32 v67, v102, v103
    v_cvt_pk_bf16_f32 v68, v104, v105
    v_cvt_pk_bf16_f32 v69, v106, v107
    v_cvt_pk_bf16_f32 v70, v108, v109
    v_cvt_pk_bf16_f32 v71, v110, v111
    buffer_store_dwordx4 v[64:67], v1, s[8:11], s65 offen offset:0 sc1
    buffer_store_dwordx4 v[68:71], v1, s[8:11], s65 offen offset:1024 sc1
    s_waitcnt vmcnt(2)
    s_branch Lq_22
Lq_21:
    s_waitcnt vmcnt(1)
    s_cmp_eq_u32 s50, 3
    s_cbranch_scc1 Lq_22
    s_waitcnt vmcnt(0)
Lq_22:
    s_lshr_b32 s6, s49, 2
    s_lshl_b32 s6, s6, 9
    s_add_u32 s6, s6, 25954304
    s_mov_b32 s55, 0
Lqp_23:
    v_xor_b32 v58, s4, v58
    v_xor_b32 v59, s5, v59
    v_xor_b32 v60, s4, v60
    v_xor_b32 v61, s5, v61
    v_or_b32 v58, v58, v60
    v_or_b32 v59, v59, v61
    v_and_b32 v58, -16, v58
    v_or_b32_e64 v58, v58, v59
    v_cmp_ne_u32 vcc, 0, v58
    s_nop 0
    s_cmp_eq_u64 vcc, 0
    s_nop 1
    s_cbranch_scc1 Lqo_25
    s_add_u32 s55, s55, 1
    s_cmp_ge_u32 s55, 200000
    s_cselect_b32 s88, 268435456, 0
    s_or_b32 s79, s79, s88
    s_cmp_lg_u32 s88, 0
    s_cbranch_scc1 Lqo_25
    s_sleep 4
    buffer_load_dwordx2 v[58:59], v62, s[8:11], s6 offen sc1
    buffer_load_dwordx2 v[60:61], v62, s[8:11], s7 offen sc1
    s_waitcnt vmcnt(0)
    s_branch Lqp_23
Lqo_25:
    s_mul_i32 s65, s50, 3968
    s_add_u32 s65, s65, 4294930432
    v_add_u32 v12, s65, v12
    v_add_u32 v13, s65, v13
    v_mov_b32 v124, -1
    v_mov_b32 v125, -1
    v_mov_b32_e64 v126, -1
    v_mov_b32 v127, -1
    s_cmp_eq_u32 s53, 0
    s_cbranch_scc1 Lslow_26
    s_add_u32 s65, s57, 0
    buffer_store_dwordx4 v[124:127], v1, s[8:11], s65 offen offset:0
    buffer_store_dwordx4 v[124:127], v1, s[8:11], s65 offen offset:1024
    s_add_u32 s65, s57, 8388608
    buffer_store_dwordx4 v[124:127], v1, s[8:11], s65 offen offset:0
    buffer_store_dwordx4 v[124:127], v1, s[8:11], s65 offen offset:1024
    s_add_u32 s65, s57, 2097152
    buffer_store_dwordx4 v[124:127], v1, s[8:11], s65 offen offset:0
    buffer_store_dwordx4 v[124:127], v1, s[8:11], s65 offen offset:1024
Ldone_27:
    buffer_load_dwordx4 a[68:71], v3, s[8:11], s81 offen offset:1024 sc1
    buffer_load_dwordx4 a[72:75], v3, s[8:11], s81 offen offset:2048 sc1
    s_add_u32 m0, s46, 0
    s_add_u32 s80, s46, s78
    s_add_u32 s80, s80, 27590656
    buffer_load_dwordx4 v3, s[8:11], s80 offen offset:0 sc1 lds
    s_lshl_b32 s65, s49, 16
    s_lshl_b32 s66, s87, 6
    s_add_u32 s65, s65, s66
    s_add_u32 s65, s65, 14680064
    v_lshrrev_b32 v59, 2, v0
    v_lshlrev_b32 v59, 12, v59
    v_and_b32 v58, 3, v0
    v_lshl_add_u32 v59, v58, 4, v59
    ds_read_b128 v[112:115], v4 offset:0
    ds_read_b128 v[116:119], v4 offset:1024
    ds_read_b128 v[120:123], v4 offset:2048
    ds_read_b128 v[124:127], v4 offset:3072
    ds_read_b128 v[128:131], v4 offset:4096
    ds_read_b128 v[132:135], v4 offset:5120
    s_waitcnt lgkmcnt(5)
    v_mfma_f32_32x32x16_bf16 v[96:111], v[112:115], v[144:147], 0
    ds_read_b128 v[136:139], v4 offset:6144
    v_lshlrev_b32 v55, 2, v0
    v_add_u32 v55, 143360, v55
    ds_read_b32 v72, v55 offset:7168
    ds_read_b32 v73, v55 offset:7424
    ds_read_b32 v74, v55 offset:7680
    ds_read_b32 v75, v55 offset:7936
    ds_read_b32 v76, v55 offset:8192
    ds_read_b32 v77, v55 offset:8448
    ds_read_b32 v78, v55 offset:8704
    s_waitcnt lgkmcnt(12)
    v_mfma_f32_32x32x16_bf16 v[96:111], v[116:119], v[148:151], v[96:111]
    ds_read_b128 v[140:143], v4 offset:7168
    s_waitcnt lgkmcnt(12)
    v_mfma_f32_32x32x16_bf16 v[96:111], v[120:123], v[152:155], v[96:111]
    ds_read_b128 v[112:115], v4 offset:8192
    ds_read_b32 v79, v55 offset:8960
    ds_read_b32 v80, v55 offset:9216
    ds_read_b32 v81, v55 offset:9472
    ds_read_b32 v82, v55 offset:9728
    ds_read_b32 v83, v55 offset:9984
    ds_read_b32 v84, v55 offset:10240
    ds_read_b32 v85, v55 offset:10496
    s_waitcnt lgkmcnt(15)
    v_mfma_f32_32x32x16_bf16 v[96:111], v[124:127], v[156:159], v[96:111]
    ds_read_b128 v[116:119], v4 offset:9216
    s_waitcnt lgkmcnt(1)
    v_add_f32_e64 v72, v72, v73
    buffer_load_dwordx4 a[76:79], v3, s[8:11], s81 offen offset:3072 sc1
    v_mfma_f32_32x32x16_bf16 v[96:111], v[128:131], v[160:163], v[96:111]
    ds_read_b128 v[120:123], v4 offset:10240
    v_add_f32 v72, v72, v74
    v_add_f32 v72, v72, v75
    v_add_f32 v72, v72, v76
    v_add_f32 v72, v72, v77
    v_mfma_f32_32x32x16_bf16 v[96:111], v[132:135], v[164:167], v[96:111]
    s_add_u32 s81, s81, 4096
    buffer_load_dwordx4 a[80:83], v3, s[8:11], s81 offen offset:0 sc1
    ds_read_b128 v[124:127], v4 offset:11264
    v_add_f32 v72, v72, v78
    v_add_f32 v72, v72, v79
    v_add_f32 v72, v72, v80
    v_add_f32 v72, v72, v81
    v_mfma_f32_32x32x16_bf16 v[96:111], v[136:139], v[168:171], v[96:111]
    ds_read_b128 v[128:131], v4 offset:12288
    v_add_f32 v72, v72, v82
    v_add_f32 v72, v72, v83
    buffer_load_dwordx4 v3, s[8:11], s80 offen offset:1024 sc1 lds
    v_add_f32 v72, v72, v84
    v_add_f32 v72, v72, v85
    v_mfma_f32_32x32x16_bf16 v[96:111], v[140:143], v[172:175], v[96:111]
    ds_read_b128 v[132:135], v4 offset:13312
    v_mov_b32 v73, v72
    s_nop 1
    v_permlane32_swap_b32 v72, v73
    v_add_f32 v72, v72, v73
    v_cmp_gt_u32 vcc, 448, v3
    v_mfma_f32_32x32x16_bf16 v[96:111], v[112:115], v[176:179], v[96:111]
    buffer_load_dwordx4 a[84:87], v3, s[8:11], s81 offen offset:1024 sc1
    ds_read_b128 v[136:139], v4 offset:14336
    v_sub_f32 v72, 0, v72
    v_cndmask_b32 v72, 0, v72, vcc
    v_cvt_pk_bf16_f32 v73, v72, v72
    v_and_b32 v73, 0xffff0000, v73
    v_sub_f32 v74, v72, v73
    s_waitcnt lgkmcnt(5)
    v_mfma_f32_32x32x16_bf16 v[96:111], v[116:119], v[180:183], v[96:111]
    ds_read_b128 v[140:143], v4 offset:15360
    v_cvt_pk_bf16_f32 v48, v73, v74
    buffer_load_dwordx4 a[88:91], v3, s[8:11], s81 offen offset:2048 sc1
    v_accvgpr_read_b32 v33, a128
    v_lshlrev_b32 v32, 16, v33
    v_and_b32 v33, 0xffff0000, v33
    s_waitcnt lgkmcnt(5)
    v_mfma_f32_32x32x16_bf16 v[96:111], v[120:123], v[184:187], v[96:111]
    ds_read_b128 v[112:115], v4 offset:16384
    v_accvgpr_read_b32 v35, a129
    v_lshlrev_b32_e64 v34, 16, v35
    v_and_b32 v35, 0xffff0000, v35
    buffer_load_dwordx4 v3, s[8:11], s80 offen offset:2048 sc1 lds
    v_accvgpr_read_b32 v37, a130
    s_waitcnt lgkmcnt(5)
    v_mfma_f32_32x32x16_bf16 v[96:111], v[124:127], v[188:191], v[96:111]
    ds_read_b128 v[116:119], v4 offset:17408
    v_lshlrev_b32 v36, 16, v37
    v_and_b32 v37, 0xffff0000, v37
    v_accvgpr_read_b32 v39, a131
    v_lshlrev_b32 v38, 16, v39
    s_waitcnt lgkmcnt(5)
    v_mfma_f32_32x32x16_bf16 v[96:111], v[128:131], v[192:195], v[96:111]
    buffer_load_dwordx4 a[92:95], v3, s[8:11], s81 offen offset:3072 sc1
    ds_read_b128 v[120:123], v4 offset:18432
    v_and_b32 v39, 0xffff0000, v39
    v_accvgpr_read_b32 v41, a132
    v_lshlrev_b32 v40, 16, v41
    v_and_b32 v41, 0xffff0000, v41
    s_waitcnt lgkmcnt(5)
    v_mfma_f32_32x32x16_bf16 v[96:111], v[132:135], v[196:199], v[96:111]
    ds_read_b128 v[124:127], v4 offset:19456
    v_accvgpr_read_b32 v43, a133
    s_add_u32 s81, s50, 3
    s_and_b32 s81, s81, 3
    s_lshl_b32 s81, s81, 13
    s_add_u32 s81, s81, s86
    s_add_u32 s81, s81, 29360128
    buffer_load_dwordx4 a[96:99], v3, s[8:11], s81 offen offset:0 sc1
    v_lshlrev_b32_e64 v42, 16, v43
    v_and_b32 v43, 0xffff0000, v43
    v_accvgpr_read_b32 v45, a134
    s_waitcnt lgkmcnt(5)
    v_mfma_f32_32x32x16_bf16 v[96:111], v[136:139], v[200:203], v[96:111]
    ds_read_b128 v[128:131], v4 offset:20480
    v_lshlrev_b32 v44, 16, v45
    v_and_b32 v45, 0xffff0000, v45
    v_accvgpr_read_b32 v47, a135
    buffer_load_dwordx4 v3, s[8:11], s80 offen offset:3072 sc1 lds
    v_lshlrev_b32 v46, 16, v47
    s_waitcnt lgkmcnt(5)
    v_mfma_f32_32x32x16_bf16 v[96:111], v[140:143], v[204:207], v[96:111]
    ds_read_b128 v[132:135], v4 offset:21504
    v_and_b32 v47, 0xffff0000, v47
    s_mov_b32 exec_lo, 0
    v_mov_b32 v44, 0
    v_mov_b32 v45, 0
    v_mov_b32 v46, 0
    v_mov_b32_e64 v47, 0
    s_mov_b32 exec_lo, -1
    s_waitcnt lgkmcnt(5)
    v_mfma_f32_32x32x16_bf16 v[96:111], v[112:115], v[208:211], v[96:111]
    buffer_load_dwordx4 a[100:103], v3, s[8:11], s81 offen offset:1024 sc1
    ds_read_b128 v[136:139], v4 offset:22528
    s_waitcnt lgkmcnt(5)
    v_mfma_f32_32x32x16_bf16 v[96:111], v[116:119], v[212:215], v[96:111]
    ds_read_b128 v[140:143], v4 offset:23552
    s_waitcnt lgkmcnt(5)
    v_mfma_f32_32x32x16_bf16 v[96:111], v[120:123], v[216:219], v[96:111]
    buffer_load_dwordx4 a[104:107], v3, s[8:11], s81 offen offset:2048 sc1
    ds_read_b128 v[112:115], v4 offset:24576
    s_waitcnt lgkmcnt(5)
    v_mfma_f32_32x32x16_bf16 v[96:111], v[124:127], v[220:223], v[96:111]
    ds_read_b128 v[116:119], v4 offset:25600
    s_waitcnt lgkmcnt(5)
    v_mfma_f32_32x32x16_bf16 v[96:111], v[128:131], v[224:227], v[96:111]
    s_add_u32 m0, s46, 4096
    s_add_u32 s80, s46, s78
    s_add_u32 s80, s80, 27594752
    buffer_load_dwordx4 v3, s[8:11], s80 offen offset:0 sc1 lds
    ds_read_b128 v[120:123], v4 offset:26624
    s_waitcnt lgkmcnt(5)
    v_mfma_f32_32x32x16_bf16 v[96:111], v[132:135], v[228:231], v[96:111]
    ds_read_b128 v[124:127], v4 offset:27648
    s_waitcnt lgkmcnt(5)
    v_mfma_f32_32x32x16_bf16 v[96:111], v[136:139], v[232:235], v[96:111]
    s_waitcnt lgkmcnt(4)
    v_mfma_f32_32x32x16_bf16 v[96:111], v[140:143], v[236:239], v[96:111]
    s_waitcnt lgkmcnt(3)
    v_mfma_f32_32x32x16_bf16 v[96:111], v[112:115], v[240:243], v[96:111]
    v_mov_b32 v128, v54
    v_mov_b32 v132, v48
    s_waitcnt lgkmcnt(2)
    v_mfma_f32_32x32x16_bf16 v[96:111], v[116:119], v[244:247], v[96:111]
    v_mov_b32 v129, 0
    v_mov_b32 v133, 0
    s_waitcnt lgkmcnt(1)
    v_mfma_f32_32x32x16_bf16 v[96:111], v[120:123], v[248:251], v[96:111]
    v_mov_b32 v130, 0
    v_mov_b32 v134, 0
    s_waitcnt lgkmcnt(0)
    v_mfma_f32_32x32x16_bf16 v[96:111], v[124:127], v[252:255], v[96:111]
    buffer_load_dwordx4 v[144:147], v59, s[8:11], s65 offen offset:0 sc1
    v_mov_b32 v131, 0
    v_mov_b32 v135, 0
    s_nop 1
    v_mfma_f32_32x32x16_bf16 v[96:111], v[132:135], v[128:131], v[96:111]
    v_lshrrev_b32 v60, 4, v0
    v_lshlrev_b32_e64 v60, 2, v60
    v_lshl_add_u32 v152, v58, 4, v60
    v_mov_b32 v154, 0x3f80
    v_mov_b32 v155, 1.0
    v_mov_b32 v148, 0
    v_mov_b32 v149, 0
    s_nop 4
    v_cvt_pk_bf16_f32 v96, v96, v97
    v_cvt_pk_bf16_f32 v97, v98, v99
    v_cvt_pk_bf16_f32 v98, v100, v101
    v_cvt_pk_bf16_f32 v99, v102, v103
    v_cvt_pk_bf16_f32 v100, v104, v105
    v_cvt_pk_bf16_f32 v101, v106, v107
    v_cvt_pk_bf16_f32 v102, v108, v109
    v_cvt_pk_bf16_f32 v103, v110, v111
    v_mfma_f32_32x32x16_bf16 v[64:79], v[24:27], v[96:99], 0
    s_nop 0
    v_mfma_f32_32x32x16_bf16 v[64:79], v[28:31], v[100:103], v[64:79]
    s_mov_b32 s55, 0
    s_mov_b32 s88, 0
    s_nop 8
    s_branch Lp3_31
Lp2_30:
    s_sleep 1
    buffer_load_dwordx4 v[144:147], v59, s[8:11], s65 offen offset:0 sc1
    s_add_u32 s55, s55, 1
    s_cmp_ge_u32 s55, 200000
    s_cselect_b32 s88, 2, 0
    s_or_b32 s79, s79, s88
Lp3_31:
    s_waitcnt vmcnt(0)
    v_max3_u32 v62, v144, v145, v146
    v_max_u32 v62, v147, v62
    v_cmp_eq_u32 vcc, -1, v62
    s_nop 0
    s_cmp_eq_u64 vcc, 0
    s_cselect_b32 s89, 1, s88
    s_cmp_eq_u32 s89, 0
    s_cbranch_scc1 Lp2_30
    v_permlane32_swap_b32 v144, v146
    v_permlane32_swap_b32 v145, v147
    s_nop 1
    v_permlane16_swap_b32 v144, v145
    v_permlane16_swap_b32 v146, v147
    v_dot2_f32_bf16 v148, v144, v154, v148
    v_dot2_f32_bf16 v149, v144, v155, v149
    v_dot2_f32_bf16 v148, v145, v154, v148
    v_dot2_f32_bf16 v149, v145, v155, v149
    v_dot2_f32_bf16 v148, v146, v154, v148
    v_dot2_f32_bf16 v149, v146, v155, v149
    v_dot2_f32_bf16 v148, v147, v154, v148
    v_dot2_f32_bf16 v149, v147, v155, v149
    s_lshl_b32 s65, s49, 12
    s_add_u32 s65, s65, 25690112
    s_add_u32 s66, s66, s65
    v_add_f32_dpp v148, v148, v148 row_ror:4 row_mask:0xf bank_mask:0xf
    v_add_f32_dpp v149, v149, v149 row_ror:4 row_mask:0xf bank_mask:0xf
    s_nop 0
    v_add_f32_dpp v148, v148, v148 row_ror:8 row_mask:0xf bank_mask:0xf
    v_add_f32_dpp v149, v149, v149 row_ror:8 row_mask:0xf bank_mask:0xf
    v_cvt_pk_bf16_f32 v148, v148, v149
    v_min_u32 v148, -2, v148
    s_mov_b32 exec_lo, 983055
    s_mov_b32 exec_hi, 983055
    buffer_store_dword v148, v152, s[8:11], s66 offen sc1
    s_mov_b64 exec, -1
    s_barrier
    s_mul_i32 s80, s49, 10752
    s_mul_i32 s3, s50, 3072
    s_add_u32 s80, s80, s3
    s_add_u32 s80, s80, 30580736
    s_add_u32 m0, s3, 86016
    s_nop 0
    buffer_load_dwordx4 v1, s[8:11], s80 offen offset:0 sc1 lds
    buffer_load_dwordx4 v1, s[8:11], s80 offen offset:1024 sc1 lds
    buffer_load_dwordx4 v1, s[8:11], s80 offen offset:2048 sc1 lds
    buffer_load_dwordx4 a[108:111], v3, s[8:11], s81 offen offset:3072 sc1
    s_add_u32 s81, s81, 4096
    buffer_load_dwordx4 a[112:115], v3, s[8:11], s81 offen offset:0 sc1
    s_add_u32 m0, s46, 4096
    s_add_u32 s80, s46, s78
    s_nop 0
    s_add_u32 s80, s80, 27594752
    buffer_load_dwordx4 v3, s[8:11], s80 offen offset:1024 sc1 lds
    v_mul_f32 v57, 0x3fb8aa3b, v56
    v_max3_f32 v58, v64, v65, v66
    v_min3_f32 v60, v64, v65, v66
    v_max3_f32 v58, v67, v68, v58
    v_min3_f32 v60, v67, v68, v60
    v_max3_f32 v58, v69, v70, v58
    v_min3_f32 v60, v69, v70, v60
    v_max3_f32 v58, v71, v72, v58
    v_min3_f32 v60, v71, v72, v60
    v_max3_f32 v58, v73, v74, v58
    v_min3_f32 v60, v73, v74, v60
    v_max3_f32 v62, v76, v77, v78
    v_min3_f32 v63, v76, v77, v78
    v_max_f32 v62, v62, v79
    v_min_f32 v63, v63, v79
    v_sub_f32 v62, v62, v20
    v_add_f32 v63, v63, v20
    v_max3_f32 v58, v75, v62, v58
    v_min3_f32 v60, v75, v63, v60
    v_mov_b32 v62, v58
    v_mov_b32 v63, v60
    s_nop 0
    v_permlane32_swap_b32 v58, v62
    v_permlane32_swap_b32 v60, v63
    v_max_f32 v58, v58, v62
    v_min_f32 v60, v60, v63
    v_mul_f32 v58, v57, v58
    v_mul_f32 v60, v57, v60
    v_add_f32 v59, v58, v20
    v_sub_f32_e64 v61, v60, v20
    v_pk_fma_f32 v[80:81], v[64:65], v[56:57], v[60:61] op_sel:[0,1,0] op_sel_hi:[1,1,0] neg_lo:[1,0,0] neg_hi:[1,0,0]
    v_pk_fma_f32 v[64:65], v[64:65], v[56:57], v[58:59] op_sel:[0,1,0] op_sel_hi:[1,1,0] neg_lo:[0,0,1] neg_hi:[0,0,1]
    v_pk_fma_f32 v[82:83], v[66:67], v[56:57], v[60:61] op_sel:[0,1,0] op_sel_hi:[1,1,0] neg_lo:[1,0,0] neg_hi:[1,0,0]
    v_pk_fma_f32 v[66:67], v[66:67], v[56:57], v[58:59] op_sel:[0,1,0] op_sel_hi:[1,1,0] neg_lo:[0,0,1] neg_hi:[0,0,1]
    v_pk_fma_f32 v[84:85], v[68:69], v[56:57], v[60:61] op_sel:[0,1,0] op_sel_hi:[1,1,0] neg_lo:[1,0,0] neg_hi:[1,0,0]
    v_pk_fma_f32 v[68:69], v[68:69], v[56:57], v[58:59] op_sel:[0,1,0] op_sel_hi:[1,1,0] neg_lo:[0,0,1] neg_hi:[0,0,1]
    v_pk_fma_f32 v[86:87], v[70:71], v[56:57], v[60:61] op_sel:[0,1,0] op_sel_hi:[1,1,0] neg_lo:[1,0,0] neg_hi:[1,0,0]
    v_pk_fma_f32 v[70:71], v[70:71], v[56:57], v[58:59] op_sel:[0,1,0] op_sel_hi:[1,1,0] neg_lo:[0,0,1] neg_hi:[0,0,1]
    v_pk_fma_f32 v[88:89], v[72:73], v[56:57], v[60:61] op_sel:[0,1,0] op_sel_hi:[1,1,0] neg_lo:[1,0,0] neg_hi:[1,0,0]
    v_pk_fma_f32 v[72:73], v[72:73], v[56:57], v[58:59] op_sel:[0,1,0] op_sel_hi:[1,1,0] neg_lo:[0,0,1] neg_hi:[0,0,1]
    v_pk_fma_f32 v[90:91], v[74:75], v[56:57], v[60:61] op_sel:[0,1,0] op_sel_hi:[1,1,0] neg_lo:[1,0,0] neg_hi:[1,0,0]
    v_pk_fma_f32 v[74:75], v[74:75], v[56:57], v[58:59] op_sel:[0,1,0] op_sel_hi:[1,1,0] neg_lo:[0,0,1] neg_hi:[0,0,1]
    v_pk_fma_f32 v[92:93], v[76:77], v[56:57], v[60:61] op_sel:[0,1,1] op_sel_hi:[1,1,1] neg_lo:[1,0,0] neg_hi:[1,0,0]
    v_pk_fma_f32 v[76:77], v[76:77], v[56:57], v[58:59] op_sel:[0,1,1] op_sel_hi:[1,1,1] neg_lo:[0,0,1] neg_hi:[0,0,1]
    v_pk_fma_f32 v[94:95], v[78:79], v[56:57], v[60:61] op_sel:[0,1,1] op_sel_hi:[1,1,1] neg_lo:[1,0,0] neg_hi:[1,0,0]
    v_pk_fma_f32 v[78:79], v[78:79], v[56:57], v[58:59] op_sel:[0,1,1] op_sel_hi:[1,1,1] neg_lo:[0,0,1] neg_hi:[0,0,1]
    v_exp_f32 v80, v80
    v_exp_f32 v64, v64
    v_exp_f32 v81, v81
    buffer_load_dwordx4 a[116:119], v3, s[8:11], s81 offen offset:1024 sc1
    v_exp_f32 v65, v65
    v_exp_f32 v82, v82
    v_exp_f32 v66, v66
    v_exp_f32 v83, v83
    v_exp_f32 v67, v67
    buffer_load_dwordx4 a[120:123], v3, s[8:11], s81 offen offset:2048 sc1
    v_exp_f32 v84, v84
    v_exp_f32 v68, v68
    v_exp_f32 v85, v85
    v_exp_f32 v69, v69
    v_exp_f32 v86, v86
    buffer_load_dwordx4 v3, s[8:11], s80 offen offset:2048 sc1 lds
    v_exp_f32 v70, v70
    v_exp_f32 v87, v87
    v_exp_f32 v71, v71
    v_exp_f32 v88, v88
    v_exp_f32 v72, v72
    buffer_load_dwordx4 a[124:127], v3, s[8:11], s81 offen offset:3072 sc1
    v_exp_f32 v89, v89
    v_exp_f32 v73, v73
    v_exp_f32 v90, v90
    v_exp_f32 v74, v74
    v_exp_f32_e64 v91, v91
    s_add_u32 m0, s47, 0
    s_add_u32 s80, s47, s78
    s_add_u32 s80, s80, 27590656
    buffer_load_dwordx4 v3, s[8:11], s80 offen offset:0 sc1 lds
    v_exp_f32 v75, v75
    v_exp_f32 v92, v92
    v_exp_f32 v76, v76
    v_exp_f32 v93, v93
    v_exp_f32 v77, v77
    buffer_load_dwordx4 v3, s[8:11], s80 offen offset:1024 sc1 lds
    v_exp_f32 v94, v94
    v_exp_f32 v78, v78
    v_exp_f32 v95, v95
    v_exp_f32_e64 v79, v79
    v_pk_add_f32 v[58:59], v[64:65], v[66:67]
    v_pk_add_f32 v[58:59], v[58:59], v[68:69]
    buffer_load_dwordx4 v3, s[8:11], s80 offen offset:2048 sc1 lds
    v_pk_add_f32 v[58:59], v[58:59], v[70:71]
    v_pk_add_f32 v[58:59], v[58:59], v[72:73]
    v_pk_add_f32 v[58:59], v[58:59], v[74:75]
    v_pk_add_f32 v[58:59], v[58:59], v[76:77]
    v_pk_add_f32 v[58:59], v[58:59], v[78:79]
    v_add_f32_e64 v58, v58, v59
    v_pk_add_f32 v[60:61], v[80:81], v[82:83]
    v_pk_add_f32 v[60:61], v[60:61], v[84:85]
    v_pk_add_f32 v[60:61], v[60:61], v[86:87]
    v_pk_add_f32 v[60:61], v[60:61], v[88:89]
    buffer_load_dwordx4 v3, s[8:11], s80 offen offset:3072 sc1 lds
    v_pk_add_f32 v[60:61], v[60:61], v[90:91]
    v_pk_add_f32 v[60:61], v[60:61], v[92:93]
    v_pk_add_f32 v[60:61], v[60:61], v[94:95]
    v_add_f32 v60, v60, v61
    v_mov_b32 v62, v58
    v_mov_b32 v63, v60
    s_nop 0
    v_permlane32_swap_b32 v58, v62
    v_permlane32_swap_b32 v60, v63
    v_add_f32 v58, v58, v62
    v_add_f32 v60, v60, v63
    s_add_u32 m0, s47, 4096
    s_add_u32 s80, s47, s78
    s_add_u32 s80, s80, 27594752
    buffer_load_dwordx4 v3, s[8:11], s80 offen offset:0 sc1 lds
    v_rcp_f32 v58, v58
    v_rcp_f32_e64 v60, v60
    v_pk_mul_f32 v[64:65], v[64:65], v[58:59] op_sel_hi:[1,0]
    v_pk_mul_f32 v[66:67], v[66:67], v[58:59] op_sel_hi:[1,0]
    v_pk_mul_f32 v[68:69], v[68:69], v[58:59] op_sel_hi:[1,0]
    v_pk_mul_f32 v[70:71], v[70:71], v[58:59] op_sel_hi:[1,0]
    v_pk_mul_f32 v[72:73], v[72:73], v[58:59] op_sel_hi:[1,0]
    v_pk_mul_f32 v[74:75], v[74:75], v[58:59] op_sel_hi:[1,0]
    buffer_load_dwordx4 v3, s[8:11], s80 offen offset:1024 sc1 lds
    v_pk_mul_f32 v[76:77], v[76:77], v[58:59] op_sel_hi:[1,0]
    v_pk_mul_f32 v[78:79], v[78:79], v[58:59] op_sel_hi:[1,0]
    v_cvt_pk_bf16_f32 v64, v64, v65
    v_cvt_pk_bf16_f32 v65, v66, v67
    v_cvt_pk_bf16_f32 v66, v68, v69
    v_cvt_pk_bf16_f32 v67, v70, v71
    v_cvt_pk_bf16_f32 v68, v72, v73
    v_cvt_pk_bf16_f32 v69, v74, v75
    v_cvt_pk_bf16_f32 v70, v76, v77
    v_cvt_pk_bf16_f32 v71, v78, v79
    buffer_load_dwordx4 v3, s[8:11], s80 offen offset:2048 sc1 lds
    v_pk_mul_f32 v[80:81], v[80:81], v[60:61] op_sel_hi:[1,0]
    v_pk_mul_f32 v[82:83], v[82:83], v[60:61] op_sel_hi:[1,0]
    v_pk_mul_f32 v[84:85], v[84:85], v[60:61] op_sel_hi:[1,0]
    v_pk_mul_f32 v[86:87], v[86:87], v[60:61] op_sel_hi:[1,0]
    v_pk_mul_f32 v[88:89], v[88:89], v[60:61] op_sel_hi:[1,0]
    v_pk_mul_f32 v[90:91], v[90:91], v[60:61] op_sel_hi:[1,0]
    v_pk_mul_f32 v[92:93], v[92:93], v[60:61] op_sel_hi:[1,0]
    v_pk_mul_f32 v[94:95], v[94:95], v[60:61] op_sel_hi:[1,0]
    v_cvt_pk_bf16_f32 v80, v80, v81
    v_cvt_pk_bf16_f32 v81, v82, v83
    s_add_u32 m0, s76, 0
    s_add_u32 s80, s76, s78
    s_add_u32 s80, s80, 27590656
    buffer_load_dwordx4 v3, s[8:11], s80 offen offset:0 sc1 lds
    v_cvt_pk_bf16_f32 v82, v84, v85
    v_cvt_pk_bf16_f32 v83, v86, v87
    v_cvt_pk_bf16_f32 v84, v88, v89
    v_cvt_pk_bf16_f32 v85, v90, v91
    v_cvt_pk_bf16_f32 v86, v92, v93
    v_cvt_pk_bf16_f32 v87, v94, v95
Lpf_32:
    s_add_u32 s6, s70, Lpf_32-Lstart+512
    s_min_u32 s6, s6, Lcode_end-Lstart-4
    s_load_dword s72, s[44:45], s6
    v_lshlrev_b32_e64 v168, 5, v0
    s_mov_b32 s3, 25956352
    buffer_load_dwordx4 v[160:163], v168, s[8:11], s3 offen sc1
    buffer_load_dwordx4 v[164:167], v168, s[8:11], s3 offen offset:16 sc1
    s_mov_b32 s55, 0
    s_branch Lp3_36
Lp2_35:
    s_sleep 1
Lp3_36:
    s_nop 0
    buffer_load_dwordx4 v[128:131], v1, s[8:11], s65 offen offset:0 sc1
    buffer_load_dwordx4 v[132:135], v1, s[8:11], s65 offen offset:1024 sc1
    buffer_load_dwordx4 v[136:139], v1, s[8:11], s65 offen offset:2048 sc1
    buffer_load_dwordx4 v[140:143], v1, s[8:11], s65 offen offset:3072 sc1
    s_add_u32 s55, s55, 1
    s_cmp_ge_u32 s55, 200000
    s_cselect_b32 s88, 2, 0
    s_or_b32 s79, s79, s88
    s_waitcnt vmcnt(0)
    v_max3_u32 v62, v128, v129, v130
    v_max3_u32 v62, v131, v132, v62
    v_max3_u32 v62, v133, v134, v62
    v_max3_u32 v62, v135, v136, v62
    v_max3_u32 v62, v137, v138, v62
    v_max3_u32 v62, v139, v140, v62
    v_max3_u32 v62, v141, v142, v62
    v_max_u32_e64 v62, v143, v62
    v_cmp_eq_u32 vcc, -1, v62
    s_nop 0
    s_cmp_eq_u64 vcc, 0
    s_cselect_b32 s89, 1, s88
    s_cmp_eq_u32 s89, 0
    s_cbranch_scc1 Lp2_35
    v_mfma_f32_32x32x16_bf16 v[96:111], v[128:131], v[64:67], 0
    v_mfma_f32_32x32x16_bf16 v[96:111], v[132:135], v[68:71], v[96:111]
    v_mfma_f32_32x32x16_bf16 v[96:111], v[136:139], v[80:83], v[96:111]
    v_mfma_f32_32x32x16_bf16 v[96:111], v[140:143], v[84:87], v[96:111]
    s_nop 11
    v_mov_b32 v58, v108
    v_mov_b32 v60, v108
    s_add_u32 s65, s57, 6291456
    s_nop 0
    v_permlane32_swap_b32 v58, v60
    v_add_f32 v60, 0x358637bd, v60
    v_rcp_f32 v60, v60
    s_nop 0
    s_nop 0
    v_pk_mul_f32 v[96:97], v[96:97], v[60:61] op_sel_hi:[1,0]
    v_pk_mul_f32 v[98:99], v[98:99], v[60:61] op_sel_hi:[1,0]
    v_pk_mul_f32 v[100:101], v[100:101], v[60:61] op_sel_hi:[1,0]
    v_pk_mul_f32 v[102:103], v[102:103], v[60:61] op_sel_hi:[1,0]
    v_pk_mul_f32 v[104:105], v[104:105], v[60:61] op_sel_hi:[1,0]
    v_pk_mul_f32 v[106:107], v[106:107], v[60:61] op_sel_hi:[1,0]
    v_pk_mul_f32 v[108:109], v[108:109], v[60:61] op_sel_hi:[1,0]
    v_pk_mul_f32 v[110:111], v[110:111], v[60:61] op_sel_hi:[1,0]
    v_cvt_pk_bf16_f32 v96, v96, v97
    v_cvt_pk_bf16_f32 v97, v98, v99
    v_cvt_pk_bf16_f32 v98, v100, v101
    v_cvt_pk_bf16_f32 v99, v102, v103
    v_cvt_pk_bf16_f32 v100, v104, v105
    v_cvt_pk_bf16_f32 v101, v106, v107
    v_cvt_pk_bf16_f32 v102, v108, v109
    v_cvt_pk_bf16_f32 v103, v110, v111
    s_cmp_eq_u32 s53, 0
    s_cbranch_scc1 Lslow_37
    buffer_store_dwordx4 v[96:99], v1, s[8:11], s65 offen offset:0
    buffer_store_dwordx4 v[100:103], v1, s[8:11], s65 offen offset:1024
Ldone_38:
    s_mov_b32 s55, 0
Lfp_39:
    v_xor_b32 v160, s4, v160
    v_xor_b32 v161, s5, v161
    v_xor_b32 v162, s4, v162
    v_xor_b32 v163, s5, v163
    v_xor_b32 v164, s4, v164
    v_xor_b32 v165, s5, v165
    v_xor_b32 v166, s4, v166
    v_xor_b32 v167, s5, v167
    v_or3_b32 v160, v160, v162, v164
    v_or_b32 v160, v160, v166
    v_or3_b32 v161, v161, v163, v165
    v_or_b32 v161, v161, v167
    v_and_b32 v162, -16, v160
    v_or_b32 v162, v162, v161
    v_cmp_ne_u32 vcc, 0, v162
    s_nop 0
    s_cmp_eq_u64 vcc, 0
    s_nop 1
    s_cbranch_scc0 Lfr_40
Lgo_41:
Lpf_42:
    s_add_u32 s6, s70, Lpf_42-Lstart+1024
    s_min_u32 s6, s6, Lcode_end-Lstart-4
    s_load_dword s72, s[44:45], s6
    s_add_u32 s65, s58, 6291456
    s_add_u32 s66, s65, 4096
    s_mov_b32 s55, 0
Lop_43:
    s_nop 0
    buffer_load_dwordx4 v[144:147], v1, s[8:11], s65 offen offset:0 sc1
    buffer_load_dwordx4 v[148:151], v1, s[8:11], s65 offen offset:1024 sc1
    buffer_load_dwordx4 v[152:155], v1, s[8:11], s65 offen offset:2048 sc1
    buffer_load_dwordx4 v[156:159], v1, s[8:11], s65 offen offset:3072 sc1
    buffer_load_dwordx4 v[160:163], v1, s[8:11], s66 offen offset:0 sc1
    buffer_load_dwordx4 v[164:167], v1, s[8:11], s66 offen offset:1024 sc1
    buffer_load_dwordx4 v[168:171], v1, s[8:11], s66 offen offset:2048 sc1
    buffer_load_dwordx4 v[172:175], v1, s[8:11], s66 offen offset:3072 sc1
    s_add_u32 s55, s55, 1
    s_cmp_ge_u32 s55, 200000
    s_cselect_b32 s88, 4, 0
    s_or_b32 s79, s79, s88
    s_waitcnt vmcnt(6)
    v_max3_u32 v62, v144, v145, v146
    v_max_u32_e64 v62, v147, v62
    v_max3_u32 v62, v148, v149, v62
    v_max3_u32 v62, v150, v151, v62
    s_waitcnt vmcnt(4)
    s_nop 0
    v_max3_u32 v62, v152, v153, v62
    v_max3_u32 v62, v154, v155, v62
    v_max3_u32 v62, v156, v157, v62
    v_max3_u32 v62, v158, v159, v62
    s_waitcnt vmcnt(2)
    s_nop 0
    v_max3_u32 v62, v160, v161, v62
    v_max3_u32 v62, v162, v163, v62
    v_max3_u32 v62, v164, v165, v62
    v_max3_u32 v62, v166, v167, v62
    s_waitcnt vmcnt(0)
    s_nop 0
    v_max3_u32 v62, v168, v169, v62
    v_max3_u32 v62, v170, v171, v62
    v_max3_u32 v62, v172, v173, v62
    v_max3_u32 v62, v174, v175, v62
    v_cmp_eq_u32 vcc, -1, v62
    s_nop 0
    s_cmp_eq_u64 vcc, 0
    s_cselect_b32 s89, 1, s88
    s_cmp_eq_u32 s89, 0
    s_cbranch_scc1 Lop_43
    ds_write_b128 v23, v[144:147] offset:0
    v_mfma_f32_32x32x16_bf16 v[32:47], a[0:3], v[144:147], v[32:47]
    ds_write_b128 v23, v[148:151] offset:1024
    v_mfma_f32_32x32x16_bf16 v[32:47], a[4:7], v[148:151], v[32:47]
    ds_write_b128 v23, v[152:155] offset:2048
    v_mfma_f32_32x32x16_bf16 v[32:47], a[8:11], v[152:155], v[32:47]
    ds_write_b128 v23, v[156:159] offset:3072
    v_mfma_f32_32x32x16_bf16 v[32:47], a[12:15], v[156:159], v[32:47]
    ds_write_b128 v23, v[160:163] offset:4096
    v_mfma_f32_32x32x16_bf16 v[32:47], a[16:19], v[160:163], v[32:47]
    ds_write_b128 v23, v[164:167] offset:5120
    v_mfma_f32_32x32x16_bf16 v[32:47], a[20:23], v[164:167], v[32:47]
    ds_write_b128 v23, v[168:171] offset:6144
    ds_write_b128 v23, v[172:175] offset:7168
    s_waitcnt lgkmcnt(0)
    s_barrier
    ds_read_b128 v[64:67], v16 offset:0
    ds_read_b128 v[68:71], v16 offset:1024
    ds_read_b128 v[72:75], v16 offset:2048
    ds_read_b128 v[76:79], v16 offset:3072
    v_mfma_f32_32x32x16_bf16 v[32:47], a[24:27], v[168:171], v[32:47]
    v_mfma_f32_32x32x16_bf16 v[32:47], a[28:31], v[172:175], v[32:47]
    ds_read_b128 v[80:83], v16 offset:4096
    ds_read_b128 v[84:87], v16 offset:5120
    ds_read_b128 v[88:91], v16 offset:6144
    ds_read_b128 v[92:95], v16 offset:7168
    s_lshl_b32 s80, s94, 2
    s_add_u32 s80, s80, s50
    s_lshl_b32 s80, s80, 12
    s_add_u32 s80, s80, 29884416
    v_lshlrev_b32 v59, 7, v0
    s_mov_b64 exec, 2139062143
    buffer_load_dword a255, v59, s[8:11], s80 offen sc1
    s_mov_b64 exec, -1
    s_add_u32 m0, s76, 0
    s_add_u32 s80, s76, s78
    s_nop 0
    s_add_u32 s80, s80, 27590656
    buffer_load_dwordx4 v3, s[8:11], s80 offen offset:1024 sc1 lds
    buffer_load_dwordx4 v3, s[8:11], s80 offen offset:2048 sc1 lds
    buffer_load_dwordx4 v3, s[8:11], s80 offen offset:3072 sc1 lds
    s_waitcnt lgkmcnt(7)
    v_mfma_f32_32x32x16_bf16 v[32:47], a[32:35], v[64:67], v[32:47]
    s_add_u32 m0, s77, 0
    s_add_u32 s80, s77, s78
    s_add_u32 s80, s80, 27590656
    buffer_load_dwordx4 v3, s[8:11], s80 offen offset:0 sc1 lds
    ds_read_b128 v[176:179], v17 offset:0
    v_lshlrev_b32 v55, 2, v0
    v_add_u32 v55, 86016, v55
    ds_read_b32 v240, v55 offset:0
    ds_read_b32 v241, v55 offset:256
    ds_read_b32 v242, v55 offset:512
    ds_read_b32 v243, v55 offset:768
    ds_read_b32 v244, v55 offset:1024
    ds_read_b32 v245, v55 offset:1280
    ds_read_b32 v246, v55 offset:1536
    s_waitcnt lgkmcnt(14)
    s_nop 0
    v_mfma_f32_32x32x16_bf16 v[32:47], a[36:39], v[68:71], v[32:47]
    ds_read_b128 v[180:183], v17 offset:1024
    ds_read_b32 v247, v55 offset:1792
    ds_read_b32 v248, v55 offset:2048
    ds_read_b32 v249, v55 offset:2304
    ds_read_b32 v250, v55 offset:2560
    ds_read_b32 v251, v55 offset:2816
    ds_read_b32 v252, v55 offset:3072
    ds_read_b32 v253, v55 offset:3328
    s_waitcnt lgkmcnt(15)
    v_mfma_f32_32x32x16_bf16 v[32:47], a[40:43], v[72:75], v[32:47]
    buffer_load_dwordx4 v3, s[8:11], s80 offen offset:1024 sc1 lds
    ds_read_b128 v[184:187], v17 offset:2048
    s_waitcnt lgkmcnt(1)
    v_mfma_f32_32x32x16_bf16 v[32:47], a[44:47], v[76:79], v[32:47]
    ds_read_b128 v[188:191], v17 offset:3072
    v_add_f32 v240, v240, v241
    v_add_f32 v240, v240, v242
    v_add_f32 v240, v240, v243
    v_add_f32 v240, v240, v244
    v_add_f32_e64 v240, v240, v245
    v_mfma_f32_32x32x16_bf16 v[32:47], a[48:51], v[80:83], v[32:47]
    ds_read_b128 v[192:195], v17 offset:4096
    v_add_f32 v240, v240, v246
    v_add_f32 v240, v240, v247
    v_add_f32 v240, v240, v248
    v_add_f32 v240, v240, v249
    v_add_f32_e64 v240, v240, v250
    v_mfma_f32_32x32x16_bf16 v[32:47], a[52:55], v[84:87], v[32:47]
    buffer_load_dwordx4 v3, s[8:11], s80 offen offset:2048 sc1 lds
    ds_read_b128 v[196:199], v17 offset:5120
    v_add_f32 v240, v240, v251
    v_add_f32 v240, v240, v252
    v_add_f32 v240, v240, v253
    v_mov_b32 v241, v240
    s_nop 1
    v_permlane32_swap_b32 v240, v241
    v_mfma_f32_32x32x16_bf16 v[32:47], a[56:59], v[88:91], v[32:47]
    ds_read_b128 v[200:203], v17 offset:6144
    v_add_f32 v240, v240, v241
    v_cmp_gt_u32 vcc, 448, v3
    v_sub_f32 v240, 0, v240
    s_nop 0
    v_cndmask_b32 v240, 0, v240, vcc
    v_cvt_pk_bf16_f32 v241, v240, v240
    v_and_b32 v241, 0xffff0000, v241
    v_mfma_f32_32x32x16_bf16 v[32:47], a[60:63], v[92:95], v[32:47]
    ds_read_b128 v[204:207], v17 offset:7168
    v_sub_f32_e64 v242, v240, v241
    v_cvt_pk_bf16_f32 v52, v241, v242
    ds_read_b32 v240, v55 offset:3584
    ds_read_b32 v241, v55 offset:3840
    ds_read_b32 v242, v55 offset:4096
    ds_read_b32 v243, v55 offset:4352
    ds_read_b32 v244, v55 offset:4608
    ds_read_b32 v245, v55 offset:4864
    ds_read_b32 v246, v55 offset:5120
    v_mfma_f32_32x32x16_bf16 v[32:47], a[64:67], v[176:179], v[32:47]
    buffer_load_dwordx4 v3, s[8:11], s80 offen offset:3072 sc1 lds
    ds_read_b128 v[208:211], v18 offset:0
    ds_read_b32 v247, v55 offset:5376
    ds_read_b32 v248, v55 offset:5632
    ds_read_b32 v249, v55 offset:5888
    ds_read_b32 v250, v55 offset:6144
    ds_read_b32 v251, v55 offset:6400
    ds_read_b32 v252, v55 offset:6656
    ds_read_b32 v253, v55 offset:6912
    v_mfma_f32_32x32x16_bf16 v[32:47], a[68:71], v[180:183], v[32:47]
    ds_read_b128 v[212:215], v18 offset:1024
    s_waitcnt lgkmcnt(1)
    v_mfma_f32_32x32x16_bf16 v[32:47], a[72:75], v[184:187], v[32:47]
    ds_read_b128 v[216:219], v18 offset:2048
    v_add_f32 v240, v240, v241
    v_add_f32 v240, v240, v242
    v_add_f32 v240, v240, v243
    v_add_f32 v240, v240, v244
    v_add_f32 v240, v240, v245
    v_mfma_f32_32x32x16_bf16 v[32:47], a[76:79], v[188:191], v[32:47]
    ds_read_b128 v[220:223], v18 offset:3072
    v_add_f32 v240, v240, v246
    v_add_f32 v240, v240, v247
    v_add_f32 v240, v240, v248
    v_add_f32 v240, v240, v249
    v_add_f32_e64 v240, v240, v250
    v_mfma_f32_32x32x16_bf16 v[32:47], a[80:83], v[192:195], v[32:47]
    ds_read_b128 v[224:227], v18 offset:4096
    v_add_f32 v240, v240, v251
    v_add_f32 v240, v240, v252
    v_add_f32 v240, v240, v253
    v_mov_b32 v241, v240
    s_nop 1
    v_permlane32_swap_b32 v240, v241
    v_mfma_f32_32x32x16_bf16 v[32:47], a[84:87], v[196:199], v[32:47]
    ds_read_b128 v[228:231], v18 offset:5120
    v_add_f32 v240, v240, v241
    v_cmp_gt_u32 vcc, 448, v3
    v_sub_f32 v240, 0, v240
    s_nop 0
    v_cndmask_b32 v240, 0, v240, vcc
    v_cvt_pk_bf16_f32 v241, v240, v240
    v_and_b32 v241, 0xffff0000, v241
    v_mfma_f32_32x32x16_bf16 v[32:47], a[88:91], v[200:203], v[32:47]
    ds_read_b128 v[232:235], v18 offset:6144
    v_sub_f32_e64 v242, v240, v241
    v_cvt_pk_bf16_f32 v53, v241, v242
    ds_read_b32 v240, v55 offset:7168
    ds_read_b32 v241, v55 offset:7424
    ds_read_b32 v242, v55 offset:7680
    ds_read_b32 v243, v55 offset:7936
    ds_read_b32 v244, v55 offset:8192
    ds_read_b32 v245, v55 offset:8448
    ds_read_b32 v246, v55 offset:8704
    v_mfma_f32_32x32x16_bf16 v[32:47], a[92:95], v[204:207], v[32:47]
    ds_read_b128 v[236:239], v18 offset:7168
    ds_read_b32 v247, v55 offset:8960
    ds_read_b32 v248, v55 offset:9216
    ds_read_b32 v249, v55 offset:9472
    ds_read_b32 v250, v55 offset:9728
    ds_read_b32 v251, v55 offset:9984
    ds_read_b32 v252, v55 offset:10240
    ds_read_b32 v253, v55 offset:10496
    v_mfma_f32_32x32x16_bf16 v[32:47], a[96:99], v[208:211], v[32:47]
    s_waitcnt lgkmcnt(0)
    v_mfma_f32_32x32x16_bf16 v[32:47], a[100:103], v[212:215], v[32:47]
    v_add_f32 v240, v240, v241
    v_add_f32 v240, v240, v242
    v_add_f32 v240, v240, v243
    v_add_f32 v240, v240, v244
    v_add_f32 v240, v240, v245
    v_mfma_f32_32x32x16_bf16 v[32:47], a[104:107], v[216:219], v[32:47]
    v_add_f32 v240, v240, v246
    v_add_f32 v240, v240, v247
    v_add_f32 v240, v240, v248
    v_add_f32 v240, v240, v249
    v_add_f32 v240, v240, v250
    v_mfma_f32_32x32x16_bf16 v[32:47], a[108:111], v[220:223], v[32:47]
    v_add_f32 v240, v240, v251
    v_add_f32 v240, v240, v252
    v_add_f32 v240, v240, v253
    v_mov_b32 v241, v240
    s_nop 1
    v_permlane32_swap_b32 v240, v241
    v_mfma_f32_32x32x16_bf16 v[32:47], a[112:115], v[224:227], v[32:47]
    v_add_f32 v240, v240, v241
    v_cmp_gt_u32 vcc, 448, v3
    v_sub_f32 v240, 0, v240
    s_nop 0
    v_cndmask_b32_e64 v240, 0, v240, vcc
    v_cvt_pk_bf16_f32 v241, v240, v240
    v_and_b32 v241, 0xffff0000, v241
    v_mfma_f32_32x32x16_bf16 v[32:47], a[116:119], v[228:231], v[32:47]
    v_sub_f32_e64 v242, v240, v241
    v_cvt_pk_bf16_f32 v51, v241, v242
    v_mfma_f32_32x32x16_bf16 v[32:47], a[120:123], v[232:235], v[32:47]
    v_mfma_f32_32x32x16_bf16 v[32:47], a[124:127], v[236:239], v[32:47]
    s_add_u32 s65, s59, 0
    v_mov_b32 v122, 0x3f803f80
    v_mov_b32 v120, 0
    v_mov_b32 v121, 0
    s_nop 7
    v_cvt_pk_bf16_f32 v112, v32, v33
    v_cvt_pk_bf16_f32 v113, v34, v35
    v_cvt_pk_bf16_f32 v114, v36, v37
    v_cvt_pk_bf16_f32 v115, v38, v39
    v_cvt_pk_bf16_f32 v116, v40, v41
    v_cvt_pk_bf16_f32 v117, v42, v43
    v_cvt_pk_bf16_f32 v118, v44, v45
    v_cvt_pk_bf16_f32 v119, v46, v47
    s_cmp_eq_u32 s53, 0
    s_cbranch_scc1 Lslow_44
    buffer_store_dwordx2 v[112:113], v7, s[8:11], s65 offen offset:0
    buffer_store_dwordx2 v[114:115], v7, s[8:11], s65 offen offset:512
    buffer_store_dwordx2 v[116:117], v7, s[8:11], s65 offen offset:1024
    s_mov_b32 exec_hi, 0
    buffer_store_dwordx2 v[118:119], v7, s[8:11], s65 offen offset:1536
    s_mov_b32 exec_hi, -1
Ldone_45:
    v_dot2_f32_bf16 v120, v112, v122, v120
    v_dot2_f32_bf16 v121, v112, v112, v121
    v_dot2_f32_bf16 v120, v113, v122, v120
    v_dot2_f32_bf16 v121, v113, v113, v121
    v_dot2_f32_bf16 v120, v114, v122, v120
    v_dot2_f32_bf16 v121, v114, v114, v121
    v_dot2_f32_bf16 v120, v115, v122, v120
    v_dot2_f32_bf16 v121, v115, v115, v121
    v_dot2_f32_bf16 v120, v116, v122, v120
    v_dot2_f32_bf16 v121, v116, v116, v121
    v_dot2_f32_bf16 v120, v117, v122, v120
    v_dot2_f32_bf16 v121, v117, v117, v121
    v_dot2_f32_bf16 v120, v118, v122, v120
    v_dot2_f32_bf16 v121, v118, v118, v121
    v_dot2_f32_bf16 v120, v119, v122, v120
    v_dot2_f32_bf16 v121, v119, v119, v121
    s_lshl_b32 s66, s50, 9
    s_add_u32 s66, s66, 119808
    v_lshl_add_u32 v124, v0, 3, s66
    ds_write_b64 v124, v[120:121]
    v_lshlrev_b32 v32, 16, v112
    v_and_b32 v33, 0xffff0000, v112
    v_lshlrev_b32 v34, 16, v113
    v_and_b32 v35, 0xffff0000, v113
    v_lshlrev_b32 v36, 16, v114
    v_and_b32 v37, 0xffff0000, v114
    v_lshlrev_b32 v38, 16, v115
    v_and_b32 v39, 0xffff0000, v115
    v_lshlrev_b32 v40, 16, v116
    v_and_b32 v41, 0xffff0000, v116
    v_lshlrev_b32 v42, 16, v117
    v_and_b32 v43, 0xffff0000, v117
    v_lshlrev_b32 v44, 16, v118
    v_and_b32 v45, 0xffff0000, v118
    v_lshlrev_b32 v46, 16, v119
    v_and_b32 v47, 0xffff0000, v119
    s_add_u32 s65, s56, 0
    v_mov_b32_e64 v60, 0
    v_mov_b32 v61, 0
    s_mov_b32 s55, 0
    s_waitcnt vmcnt(4) lgkmcnt(0)
    s_barrier
    s_cmp_lg_u32 s50, 0
    s_cbranch_scc1 Lst_46
    ds_read_b64 v[126:127], v124 offset:512
    ds_read_b64 v[128:129], v124 offset:1024
    ds_read_b64 v[130:131], v124 offset:1536
    s_add_u32 s66, s59, 0
    s_waitcnt lgkmcnt(0)
    v_pk_add_f32 v[120:121], v[120:121], v[126:127]
    v_pk_add_f32 v[128:129], v[128:129], v[130:131]
    v_pk_add_f32 v[120:121], v[120:121], v[128:129]
    v_mov_b32 v124, v120
    v_mov_b32 v125, v121
    s_nop 0
    v_permlane32_swap_b32 v120, v124
    v_permlane32_swap_b32 v121, v125
    v_pk_add_f32 v[120:121], v[120:121], v[124:125]
    v_min_u32 v120, -2, v120
    v_min_u32 v121, -2, v121
    s_cmp_eq_u32 s53, 0
    s_cbranch_scc1 Lslow_47
    s_mov_b32 exec_hi, 0
    buffer_store_dwordx2 v[120:121], v8, s[8:11], s66 offen offset:0
    s_mov_b32 exec_hi, -1
Ldone_48:
Lst_46:
Lpf_49:
    s_nop 0
    s_add_u32 s6, s70, Lpf_49-Lstart+1024
    s_min_u32 s6, s6, Lcode_end-Lstart-4
    s_load_dword s72, s[44:45], s6
Lg_50:
    s_mov_b64 exec, 65535
    buffer_load_dwordx2 v[60:61], v9, s[8:11], s65 offen offset:0 sc1
    s_mov_b64 exec, -1
    s_nop 0
    buffer_load_dwordx4 v[144:147], v1, s[8:11], s65 offen offset:0 sc1
    buffer_load_dwordx4 v[148:151], v1, s[8:11], s65 offen offset:1024 sc1
    buffer_load_dwordx4 v[152:155], v1, s[8:11], s65 offen offset:2048 sc1
    buffer_load_dwordx4 v[156:159], v1, s[8:11], s65 offen offset:3072 sc1
    s_add_u32 s55, s55, 1
    s_cmp_ge_u32 s55, 200000
    s_cselect_b32 s88, 16, 0
    s_or_b32 s79, s79, s88
    s_waitcnt vmcnt(4)
    v_max_u32_e64 v62, v60, v61
    v_cmp_eq_u32 vcc, -1, v62
    s_nop 0
    s_cmp_eq_u64 vcc, 0
    s_cselect_b32 s89, 1, s88
    s_cmp_eq_u32 s89, 0
    s_cbranch_scc1 Lg_50
    s_add_u32 s69, s65, 4096
    buffer_load_dwordx4 v[160:163], v1, s[8:11], s69 offen offset:0 sc1
    buffer_load_dwordx4 v[164:167], v1, s[8:11], s69 offen offset:1024 sc1
    buffer_load_dwordx4 v[168:171], v1, s[8:11], s69 offen offset:2048 sc1
    buffer_load_dwordx4 v[172:175], v1, s[8:11], s69 offen offset:3072 sc1
    s_add_u32 s69, s65, 8192
    buffer_load_dwordx4 v[176:179], v1, s[8:11], s69 offen offset:0 sc1
    buffer_load_dwordx4 v[180:183], v1, s[8:11], s69 offen offset:1024 sc1
    ds_read_b128 v[112:115], v1 offset:0
    ds_read_b128 v[116:119], v1 offset:28672
    ds_read_b128 v[120:123], v1 offset:1024
    ds_read_b128 v[124:127], v1 offset:29696
    ds_read_b128 v[128:131], v1 offset:2048
    ds_read_b128 v[132:135], v1 offset:30720
    s_waitcnt vmcnt(6)
    s_nop 0
    v_max3_u32 v62, v144, v145, v146
    v_max3_u32 v62, v147, v148, v62
    v_max3_u32 v62, v149, v150, v62
    v_max3_u32 v62, v151, v152, v62
    v_max3_u32 v62, v153, v154, v62
    v_max3_u32 v62, v155, v156, v62
    v_max3_u32 v62, v157, v158, v62
    v_max_u32_e64 v62, v159, v62
    v_cmp_eq_u32 vcc, -1, v62
    s_nop 0
    s_cmp_eq_u64 vcc, 0
    s_cselect_b32 s89, 1, s88
    s_cmp_eq_u32 s89, 0
    s_cbranch_scc1 Lg_50
    v_mov_b32 v63, 0
    s_waitcnt lgkmcnt(4)
    v_mfma_f32_32x32x16_bf16 v[64:79], v[112:115], v[144:147], 0
    v_mfma_f32_32x32x16_bf16 v[80:95], v[144:147], v[116:119], 0
    ds_read_b128 v[136:139], v1 offset:3072
    ds_read_b128 v[140:143], v1 offset:31744
    buffer_load_dwordx4 v[184:187], v1, s[8:11], s69 offen offset:2048 sc1
    buffer_load_dwordx4 v[188:191], v1, s[8:11], s69 offen offset:3072 sc1
    s_waitcnt lgkmcnt(4)
    s_nop 0
    v_mfma_f32_32x32x16_bf16 v[64:79], v[120:123], v[148:151], v[64:79]
    v_mfma_f32_32x32x16_bf16 v[80:95], v[148:151], v[124:127], v[80:95]
    ds_read_b128 v[112:115], v1 offset:4096
    ds_read_b128 v[116:119], v1 offset:32768
    s_add_u32 s69, s65, 12288
    buffer_load_dwordx4 v[192:195], v1, s[8:11], s69 offen offset:0 sc1
    buffer_load_dwordx4 v[196:199], v1, s[8:11], s69 offen offset:1024 sc1
    s_waitcnt lgkmcnt(4)
    s_nop 0
    v_mfma_f32_32x32x16_bf16 v[64:79], v[128:131], v[152:155], v[64:79]
    v_mfma_f32_32x32x16_bf16 v[80:95], v[152:155], v[132:135], v[80:95]
    ds_read_b128 v[120:123], v1 offset:5120
    ds_read_b128 v[124:127], v1 offset:33792
    buffer_load_dwordx4 v[200:203], v1, s[8:11], s69 offen offset:2048 sc1
    buffer_load_dwordx4 v[204:207], v1, s[8:11], s69 offen offset:3072 sc1
    s_waitcnt lgkmcnt(4)
    s_nop 0
    v_mfma_f32_32x32x16_bf16 v[64:79], v[136:139], v[156:159], v[64:79]
    v_mfma_f32_32x32x16_bf16 v[80:95], v[156:159], v[140:143], v[80:95]
    ds_read_b128 v[128:131], v1 offset:6144
    ds_read_b128 v[132:135], v1 offset:34816
    s_add_u32 s69, s65, 16384
    buffer_load_dwordx4 v[208:211], v1, s[8:11], s69 offen offset:0 sc1
    s_add_u32 s69, s65, 28672
    buffer_load_dwordx4 v[96:99], v1, s[8:11], s69 offen offset:0 sc1
    s_waitcnt vmcnt(13)
    s_waitcnt lgkmcnt(4)
    v_mfma_f32_32x32x16_bf16 v[64:79], v[112:115], v[160:163], v[64:79]
    v_max3_u32 v63, v160, v161, v63
    v_max3_u32 v63, v162, v163, v63
    v_mfma_f32_32x32x16_bf16 v[80:95], v[160:163], v[116:119], v[80:95]
    ds_read_b128 v[136:139], v1 offset:7168
    ds_read_b128 v[140:143], v1 offset:35840
    s_add_u32 s69, s65, 16384
    buffer_load_dwordx4 v[212:215], v1, s[8:11], s69 offen offset:1024 sc1
    buffer_load_dwordx4 v[216:219], v1, s[8:11], s69 offen offset:2048 sc1
    s_waitcnt vmcnt(14)
    s_waitcnt lgkmcnt(4)
    v_mfma_f32_32x32x16_bf16 v[64:79], v[120:123], v[164:167], v[64:79]
    v_max3_u32 v63, v164, v165, v63
    v_max3_u32 v63, v166, v167, v63
    v_mfma_f32_32x32x16_bf16 v[80:95], v[164:167], v[124:127], v[80:95]
    ds_read_b128 v[112:115], v1 offset:8192
    ds_read_b128 v[116:119], v1 offset:36864
    buffer_load_dwordx4 v[220:223], v1, s[8:11], s69 offen offset:3072 sc1
    s_add_u32 s69, s65, 20480
    buffer_load_dwordx4 v[224:227], v1, s[8:11], s69 offen offset:0 sc1
    s_waitcnt vmcnt(15)
    s_waitcnt lgkmcnt(4)
    v_mfma_f32_32x32x16_bf16 v[64:79], v[128:131], v[168:171], v[64:79]
    v_max3_u32 v63, v168, v169, v63
    v_max3_u32 v63, v170, v171, v63
    v_mfma_f32_32x32x16_bf16 v[80:95], v[168:171], v[132:135], v[80:95]
    ds_read_b128 v[120:123], v1 offset:9216
    ds_read_b128 v[124:127], v1 offset:37888
    buffer_load_dwordx4 v[228:231], v1, s[8:11], s69 offen offset:1024 sc1
    buffer_load_dwordx4 v[232:235], v1, s[8:11], s69 offen offset:2048 sc1
    s_waitcnt vmcnt(16)
    s_waitcnt lgkmcnt(4)
    v_mfma_f32_32x32x16_bf16 v[64:79], v[136:139], v[172:175], v[64:79]
    v_max3_u32 v63, v172, v173, v63
    v_max3_u32 v63, v174, v175, v63
    v_mfma_f32_32x32x16_bf16 v[80:95], v[172:175], v[140:143], v[80:95]
    ds_read_b128 v[128:131], v1 offset:10240
    ds_read_b128 v[132:135], v1 offset:38912
    buffer_load_dwordx4 v[236:239], v1, s[8:11], s69 offen offset:3072 sc1
    s_add_u32 s69, s65, 24576
    buffer_load_dwordx4 v[240:243], v1, s[8:11], s69 offen offset:0 sc1
    s_waitcnt vmcnt(17)
    s_waitcnt lgkmcnt(4)
    v_mfma_f32_32x32x16_bf16 v[64:79], v[112:115], v[176:179], v[64:79]
    v_max3_u32 v63, v176, v177, v63
    v_max3_u32 v63, v178, v179, v63
    v_mfma_f32_32x32x16_bf16 v[80:95], v[176:179], v[116:119], v[80:95]
    ds_read_b128 v[136:139], v1 offset:11264
    ds_read_b128 v[140:143], v1 offset:39936
    buffer_load_dwordx4 v[244:247], v1, s[8:11], s69 offen offset:1024 sc1
    s_waitcnt vmcnt(17)
    s_waitcnt lgkmcnt(4)
    v_mfma_f32_32x32x16_bf16 v[64:79], v[120:123], v[180:183], v[64:79]
    v_max3_u32 v63, v180, v181, v63
    v_max3_u32 v63, v182, v183, v63
    v_mfma_f32_32x32x16_bf16 v[80:95], v[180:183], v[124:127], v[80:95]
    ds_read_b128 v[112:115], v1 offset:12288
    ds_read_b128 v[116:119], v1 offset:40960
    buffer_load_dwordx4 v[248:251], v1, s[8:11], s69 offen offset:2048 sc1
    s_waitcnt vmcnt(17)
    s_waitcnt lgkmcnt(4)
    v_mfma_f32_32x32x16_bf16 v[64:79], v[128:131], v[184:187], v[64:79]
    v_max3_u32 v63, v184, v185, v63
    v_max3_u32 v63, v186, v187, v63
    v_mfma_f32_32x32x16_bf16 v[80:95], v[184:187], v[132:135], v[80:95]
    ds_read_b128 v[120:123], v1 offset:13312
    ds_read_b128 v[124:127], v1 offset:41984
    buffer_load_dwordx4 v[252:255], v1, s[8:11], s69 offen offset:3072 sc1
    s_waitcnt vmcnt(17)
    s_waitcnt lgkmcnt(4)
    v_mfma_f32_32x32x16_bf16 v[64:79], v[136:139], v[188:191], v[64:79]
    v_max3_u32 v63, v188, v189, v63
    v_max3_u32 v63, v190, v191, v63
    v_mfma_f32_32x32x16_bf16 v[80:95], v[188:191], v[140:143], v[80:95]
    ds_read_b128 v[128:131], v1 offset:14336
    ds_read_b128 v[132:135], v1 offset:43008
    s_waitcnt vmcnt(16)
    s_waitcnt lgkmcnt(4)
    v_mfma_f32_32x32x16_bf16 v[64:79], v[112:115], v[192:195], v[64:79]
    v_max3_u32 v63, v192, v193, v63
    v_max3_u32 v63, v194, v195, v63
    v_mfma_f32_32x32x16_bf16 v[80:95], v[192:195], v[116:119], v[80:95]
    ds_read_b128 v[136:139], v1 offset:15360
    ds_read_b128 v[140:143], v1 offset:44032
    s_waitcnt vmcnt(15)
    s_waitcnt lgkmcnt(4)
    v_mfma_f32_32x32x16_bf16 v[64:79], v[120:123], v[196:199], v[64:79]
    v_max3_u32 v63, v196, v197, v63
    v_max3_u32 v63, v198, v199, v63
    v_mfma_f32_32x32x16_bf16 v[80:95], v[196:199], v[124:127], v[80:95]
    ds_read_b128 v[112:115], v1 offset:16384
    ds_read_b128 v[116:119], v1 offset:45056
    s_waitcnt vmcnt(14)
    s_waitcnt lgkmcnt(4)
    v_mfma_f32_32x32x16_bf16 v[64:79], v[128:131], v[200:203], v[64:79]
    v_max3_u32 v63, v200, v201, v63
    v_max3_u32 v63, v202, v203, v63
    v_mfma_f32_32x32x16_bf16 v[80:95], v[200:203], v[132:135], v[80:95]
    ds_read_b128 v[120:123], v1 offset:17408
    ds_read_b128 v[124:127], v1 offset:46080
    s_waitcnt vmcnt(13)
    s_waitcnt lgkmcnt(4)
    v_mfma_f32_32x32x16_bf16 v[64:79], v[136:139], v[204:207], v[64:79]
    v_max3_u32 v63, v204, v205, v63
    v_max3_u32 v63, v206, v207, v63
    v_mfma_f32_32x32x16_bf16 v[80:95], v[204:207], v[140:143], v[80:95]
    ds_read_b128 v[128:131], v1 offset:18432
    ds_read_b128 v[132:135], v1 offset:47104
    s_waitcnt vmcnt(12)
    s_waitcnt lgkmcnt(4)
    v_mfma_f32_32x32x16_bf16 v[64:79], v[112:115], v[208:211], v[64:79]
    v_max3_u32 v63, v208, v209, v63
    v_max3_u32 v63, v210, v211, v63
    v_mfma_f32_32x32x16_bf16 v[80:95], v[208:211], v[116:119], v[80:95]
    ds_read_b128 v[136:139], v1 offset:19456
    ds_read_b128 v[140:143], v1 offset:48128
    s_waitcnt vmcnt(10)
    s_waitcnt lgkmcnt(4)
    v_mfma_f32_32x32x16_bf16 v[64:79], v[120:123], v[212:215], v[64:79]
    v_max3_u32 v63, v212, v213, v63
    v_max3_u32 v63, v214, v215, v63
    v_mfma_f32_32x32x16_bf16 v[80:95], v[212:215], v[124:127], v[80:95]
    ds_read_b128 v[112:115], v1 offset:20480
    ds_read_b128 v[116:119], v1 offset:49152
    v_max3_u32 v62, v96, v97, v98
    v_max_u32_e64 v62, v99, v62
    v_cmp_eq_u32 vcc, -1, v62
    s_nop 0
    s_cmp_eq_u64 vcc, 0
    s_cbranch_scc0 Lsr_52
Lsb_53:
    s_waitcnt vmcnt(9)
    s_waitcnt lgkmcnt(4)
    v_mfma_f32_32x32x16_bf16 v[64:79], v[128:131], v[216:219], v[64:79]
    v_max3_u32 v63, v216, v217, v63
    v_max3_u32 v63, v218, v219, v63
    v_pk_add_f32 v[60:61], v[96:97], v[98:99]
    v_mov_b32_e64 v58, v60
    v_mfma_f32_32x32x16_bf16 v[80:95], v[216:219], v[132:135], v[80:95]
    ds_read_b128 v[120:123], v1 offset:21504
    ds_read_b128 v[124:127], v1 offset:50176
    v_mov_b32 v59, v61
    v_permlane32_swap_b32 v60, v58
    s_nop 0
    v_permlane32_swap_b32 v61, v59
    s_waitcnt vmcnt(8)
    s_waitcnt lgkmcnt(4)
    v_mfma_f32_32x32x16_bf16 v[64:79], v[136:139], v[220:223], v[64:79]
    v_max3_u32 v63, v220, v221, v63
    v_max3_u32 v63, v222, v223, v63
    v_add_f32 v60, v60, v58
    v_add_f32 v61, v61, v59
    v_mfma_f32_32x32x16_bf16 v[80:95], v[220:223], v[140:143], v[80:95]
    ds_read_b128 v[128:131], v1 offset:22528
    ds_read_b128 v[132:135], v1 offset:51200
    v_mul_f32 v60, 0x3b124925, v60
    v_mul_f32 v61, 0x3b124925, v61
    v_fma_f32 v61, -v60, v60, v61
    s_waitcnt vmcnt(7)
    s_waitcnt lgkmcnt(4)
    v_mfma_f32_32x32x16_bf16 v[64:79], v[112:115], v[224:227], v[64:79]
    v_max3_u32 v63, v224, v225, v63
    v_max3_u32 v63, v226, v227, v63
    v_max_f32_e64 v61, 0, v61
    v_cvt_pk_bf16_f32 v54, v60, v60
    v_mfma_f32_32x32x16_bf16 v[80:95], v[224:227], v[116:119], v[80:95]
    ds_read_b128 v[136:139], v1 offset:23552
    ds_read_b128 v[140:143], v1 offset:52224
    v_cvt_pk_bf16_f32 v61, v61, v61
    v_and_b32 v61, 0xffff0000, v61
    v_add_f32 v61, 0x3727c5ac, v61
    v_cvt_pk_bf16_f32 v61, v61, v61
    v_and_b32 v61, 0xffff0000, v61
    s_waitcnt vmcnt(6)
    s_waitcnt lgkmcnt(4)
    v_mfma_f32_32x32x16_bf16 v[64:79], v[120:123], v[228:231], v[64:79]
    v_max3_u32 v63, v228, v229, v63
    v_max3_u32 v63, v230, v231, v63
    v_sqrt_f32 v61, v61
    s_nop 0
    v_cvt_pk_bf16_f32 v61, v61, v61
    v_and_b32 v61, 0xffff0000, v61
    v_mfma_f32_32x32x16_bf16 v[80:95], v[228:231], v[124:127], v[80:95]
    ds_read_b128 v[112:115], v1 offset:24576
    ds_read_b128 v[116:119], v1 offset:53248
    v_rcp_f32 v56, v61
    s_nop 0
    ds_write_b32 v12, v56
    v_mov_b32_e64 v96, v54
    s_waitcnt vmcnt(5)
    s_waitcnt lgkmcnt(5)
    v_mfma_f32_32x32x16_bf16 v[64:79], v[128:131], v[232:235], v[64:79]
    v_max3_u32 v63, v232, v233, v63
    v_max3_u32 v63, v234, v235, v63
    v_mov_b32 v100, v52
    v_mov_b32 v104, v53
    v_mfma_f32_32x32x16_bf16 v[80:95], v[232:235], v[132:135], v[80:95]
    ds_read_b128 v[120:123], v1 offset:25600
    ds_read_b128 v[124:127], v1 offset:54272
    v_mov_b32 v97, 0
    v_mov_b32 v101, 0
    v_mov_b32_e64 v105, 0
    s_waitcnt vmcnt(4)
    s_waitcnt lgkmcnt(5)
    v_mfma_f32_32x32x16_bf16 v[64:79], v[136:139], v[236:239], v[64:79]
    v_max3_u32 v63, v236, v237, v63
    v_max3_u32 v63, v238, v239, v63
    v_mov_b32 v98, 0
    v_mov_b32 v102, 0
    v_mfma_f32_32x32x16_bf16 v[80:95], v[236:239], v[140:143], v[80:95]
    ds_read_b128 v[128:131], v1 offset:26624
    ds_read_b128 v[132:135], v1 offset:55296
    v_mov_b32 v106, 0
    v_mov_b32 v99, 0
    v_mov_b32_e64 v103, 0
    s_waitcnt vmcnt(3)
    s_waitcnt lgkmcnt(5)
    v_mfma_f32_32x32x16_bf16 v[64:79], v[112:115], v[240:243], v[64:79]
    v_max3_u32 v63, v240, v241, v63
    v_max3_u32 v63, v242, v243, v63
    v_mov_b32_e64 v107, 0
    v_mfma_f32_32x32x16_bf16 v[80:95], v[240:243], v[116:119], v[80:95]
    ds_read_b128 v[136:139], v1 offset:27648
    ds_read_b128 v[140:143], v1 offset:56320
    s_waitcnt vmcnt(2)
    s_waitcnt lgkmcnt(4)
    v_mfma_f32_32x32x16_bf16 v[64:79], v[120:123], v[244:247], v[64:79]
    v_max3_u32 v63, v244, v245, v63
    v_max3_u32 v63, v246, v247, v63
    v_mfma_f32_32x32x16_bf16 v[80:95], v[244:247], v[124:127], v[80:95]
    v_mfma_f32_32x32x16_bf16 v[64:79], v[100:103], v[96:99], v[64:79]
    v_mfma_f32_32x32x16_bf16 v[80:95], v[96:99], v[104:107], v[80:95]
    ds_read_b128 v[96:99], v13 offset:0
    ds_read_b128 v[100:103], v13 offset:32
    ds_read_b128 v[104:107], v13 offset:64
    ds_read_b128 v[108:111], v13 offset:96
    s_waitcnt vmcnt(1)
    s_waitcnt lgkmcnt(6)
    v_mfma_f32_32x32x16_bf16 v[64:79], v[128:131], v[248:251], v[64:79]
    v_max3_u32 v63, v248, v249, v63
    v_max3_u32 v63, v250, v251, v63
    v_mfma_f32_32x32x16_bf16 v[80:95], v[248:251], v[132:135], v[80:95]
    s_waitcnt vmcnt(0)
    s_waitcnt lgkmcnt(4)
    v_mfma_f32_32x32x16_bf16 v[64:79], v[136:139], v[252:255], v[64:79]
    v_max3_u32 v63, v252, v253, v63
    v_max3_u32 v63, v254, v255, v63
    v_mfma_f32_32x32x16_bf16 v[80:95], v[252:255], v[140:143], v[80:95]
    v_cmp_eq_u32 vcc, -1, v63
    s_nop 0
    s_cmp_eq_u64 vcc, 0
    s_cbranch_scc0 Lgbad_54
Lgok_51:
    s_add_u32 s65, s62, 16777216
    s_nop 3
    s_nop 0
    v_pk_mul_f32 v[64:65], v[64:65], v[56:57] op_sel_hi:[1,0]
    v_pk_mul_f32 v[66:67], v[66:67], v[56:57] op_sel_hi:[1,0]
    v_pk_mul_f32 v[68:69], v[68:69], v[56:57] op_sel_hi:[1,0]
    v_pk_mul_f32 v[70:71], v[70:71], v[56:57] op_sel_hi:[1,0]
    v_pk_mul_f32 v[72:73], v[72:73], v[56:57] op_sel_hi:[1,0]
    v_pk_mul_f32 v[74:75], v[74:75], v[56:57] op_sel_hi:[1,0]
    v_pk_mul_f32 v[76:77], v[76:77], v[56:57] op_sel_hi:[1,0]
    v_pk_mul_f32 v[78:79], v[78:79], v[56:57] op_sel_hi:[1,0]
    v_cvt_pk_bf16_f32 v64, v64, v65
    v_cvt_pk_bf16_f32 v65, v66, v67
    v_cvt_pk_bf16_f32 v66, v68, v69
    v_cvt_pk_bf16_f32 v67, v70, v71
    v_cvt_pk_bf16_f32 v68, v72, v73
    v_cvt_pk_bf16_f32 v69, v74, v75
    v_cvt_pk_bf16_f32 v70, v76, v77
    v_cvt_pk_bf16_f32 v71, v78, v79
    buffer_store_dwordx4 v[64:67], v1, s[8:11], s65 offen offset:0 sc1
    buffer_store_dwordx4 v[68:71], v1, s[8:11], s65 offen offset:1024 sc1
    s_waitcnt lgkmcnt(0)
    s_nop 0
    v_pk_fma_f32 v[80:81], v[80:81], v[96:97], v[2:3] op_sel_hi:[1,1,0]
    v_pk_fma_f32 v[82:83], v[82:83], v[98:99], v[2:3] op_sel_hi:[1,1,0]
    v_pk_fma_f32 v[84:85], v[84:85], v[100:101], v[2:3] op_sel_hi:[1,1,0]
    v_pk_fma_f32 v[86:87], v[86:87], v[102:103], v[2:3] op_sel_hi:[1,1,0]
    v_pk_fma_f32 v[88:89], v[88:89], v[104:105], v[2:3] op_sel_hi:[1,1,0]
    v_pk_fma_f32 v[90:91], v[90:91], v[106:107], v[2:3] op_sel_hi:[1,1,0]
    v_pk_fma_f32 v[92:93], v[92:93], v[108:109], v[2:3] op_sel_hi:[1,1,0]
    v_pk_fma_f32 v[94:95], v[94:95], v[110:111], v[2:3] op_sel_hi:[1,1,0]
    v_cvt_pk_bf16_f32 v80, v80, v81
    v_cvt_pk_bf16_f32 v81, v82, v83
    v_cvt_pk_bf16_f32 v82, v84, v85
    v_cvt_pk_bf16_f32 v83, v86, v87
    v_cvt_pk_bf16_f32 v84, v88, v89
    v_cvt_pk_bf16_f32 v85, v90, v91
    v_cvt_pk_bf16_f32 v86, v92, v93
    v_cvt_pk_bf16_f32 v87, v94, v95
    buffer_store_dwordx4 v[80:83], v1, s[8:11], s65 offen offset:2048 sc1
    buffer_store_dwordx4 v[84:87], v1, s[8:11], s65 offen offset:3072 sc1
    ds_write_b128 v14, v[64:67] offset:32768
    ds_write_b128 v14, v[68:71] offset:33792
    ds_write_b128 v14, v[80:83] offset:34816
    ds_write_b128 v14, v[84:87] offset:35840
    s_lshl_b32 s65, s48, 1
    s_add_u32 s65, s65, s50
    s_add_u32 s66, s63, 16777216
    s_cmp_lt_u32 s65, 4
    s_cselect_b32 s65, 117440512, s66
    s_add_u32 s66, s65, 4096
    s_lshl_b32 s67, s50, 13
    s_add_u32 s67, s67, 86016
    ds_read_b128 v[112:115], v4 offset:0
    ds_read_b128 v[116:119], v4 offset:1024
    ds_read_b128 v[120:123], v4 offset:2048
    ds_read_b128 v[124:127], v4 offset:3072
    ds_read_b128 v[128:131], v4 offset:4096
    ds_read_b128 v[132:135], v4 offset:5120
    s_waitcnt lgkmcnt(5)
    v_mfma_f32_32x32x16_bf16 v[96:111], v[112:115], v[144:147], 0
    ds_read_b128 v[136:139], v4 offset:6144
    s_waitcnt lgkmcnt(5)
    v_mfma_f32_32x32x16_bf16 v[96:111], v[116:119], v[148:151], v[96:111]
    ds_read_b128 v[140:143], v4 offset:7168
    s_add_u32 s81, s50, 0
    s_and_b32 s81, s81, 3
    s_lshl_b32 s81, s81, 13
    s_add_u32 s81, s81, s86
    s_add_u32 s81, s81, 29884416
    buffer_load_dwordx4 a[128:131], v3, s[8:11], s81 offen offset:0 sc1
    s_waitcnt lgkmcnt(5)
    v_mfma_f32_32x32x16_bf16 v[96:111], v[120:123], v[152:155], v[96:111]
    ds_read_b128 v[112:115], v4 offset:8192
    buffer_load_dwordx4 a[132:135], v3, s[8:11], s81 offen offset:1024 sc1
    s_waitcnt lgkmcnt(5)
    v_mfma_f32_32x32x16_bf16 v[96:111], v[124:127], v[156:159], v[96:111]
    ds_read_b128 v[116:119], v4 offset:9216
    buffer_load_dwordx4 a[136:139], v3, s[8:11], s81 offen offset:2048 sc1
    s_waitcnt lgkmcnt(5)
    v_mfma_f32_32x32x16_bf16 v[96:111], v[128:131], v[160:163], v[96:111]
    ds_read_b128 v[120:123], v4 offset:10240
    buffer_load_dwordx4 a[140:143], v3, s[8:11], s81 offen offset:3072 sc1
    s_waitcnt lgkmcnt(5)
    v_mfma_f32_32x32x16_bf16 v[96:111], v[132:135], v[164:167], v[96:111]
    ds_read_b128 v[124:127], v4 offset:11264
    s_add_u32 s81, s81, 4096
    buffer_load_dwordx4 a[144:147], v3, s[8:11], s81 offen offset:0 sc1
    s_waitcnt lgkmcnt(5)
    v_mfma_f32_32x32x16_bf16 v[96:111], v[136:139], v[168:171], v[96:111]
    ds_read_b128 v[128:131], v4 offset:12288
    buffer_load_dwordx4 a[148:151], v3, s[8:11], s81 offen offset:1024 sc1
    s_waitcnt lgkmcnt(5)
    v_mfma_f32_32x32x16_bf16 v[96:111], v[140:143], v[172:175], v[96:111]
    ds_read_b128 v[132:135], v4 offset:13312
    buffer_load_dwordx4 a[152:155], v3, s[8:11], s81 offen offset:2048 sc1
    s_waitcnt lgkmcnt(5)
    s_nop 0
    v_mfma_f32_32x32x16_bf16 v[96:111], v[112:115], v[176:179], v[96:111]
    ds_read_b128 v[136:139], v4 offset:14336
    buffer_load_dwordx4 a[156:159], v3, s[8:11], s81 offen offset:3072 sc1
    v_mov_b32 v57, 0xff61b1e6
    v_mov_b32 v60, 65535
    v_mov_b32 v61, 0xffff0000
    v_cmp_le_i32 s[82:83], 0, v21
    s_waitcnt lgkmcnt(5)
    v_mfma_f32_32x32x16_bf16 v[96:111], v[116:119], v[180:183], v[96:111]
    ds_read_b128 v[140:143], v4 offset:15360
    s_add_u32 s81, s50, 1
    s_and_b32 s81, s81, 3
    s_lshl_b32 s81, s81, 13
    s_add_u32 s81, s81, s86
    s_nop 0
    s_add_u32 s81, s81, 29884416
    buffer_load_dwordx4 a[160:163], v3, s[8:11], s81 offen offset:0 sc1
    v_cmp_le_i32 s[84:85], 1, v21
    v_mov_b32 v58, 0xff61b1e6
    v_cndmask_b32 v160, v57, 0, s[82:83]
    v_cndmask_b32 v161, v57, 0, s[84:85]
    s_waitcnt lgkmcnt(5)
    s_nop 0
    v_mfma_f32_32x32x16_bf16 v[96:111], v[120:123], v[184:187], v[96:111]
    ds_read_b128 v[112:115], v4 offset:16384
    buffer_load_dwordx4 a[164:167], v3, s[8:11], s81 offen offset:1024 sc1
    v_cndmask_b32 v144, 0, v57, s[82:83]
    v_cndmask_b32 v145, 0, v57, s[84:85]
    v_cndmask_b32 v62, 0, v60, s[82:83]
    v_cndmask_b32 v63, 0, v61, s[84:85]
    s_waitcnt lgkmcnt(5)
    s_nop 0
    v_mfma_f32_32x32x16_bf16 v[96:111], v[124:127], v[188:191], v[96:111]
    ds_read_b128 v[116:119], v4 offset:17408
    buffer_load_dwordx4 a[168:171], v3, s[8:11], s81 offen offset:2048 sc1
    v_cmp_le_i32 s[82:83], 2, v21
    v_cmp_le_i32 s[84:85], 3, v21
    v_or_b32 v88, v62, v63
    v_cndmask_b32 v162, v57, 0, s[82:83]
    s_waitcnt lgkmcnt(5)
    v_mfma_f32_32x32x16_bf16 v[96:111], v[128:131], v[192:195], v[96:111]
    ds_read_b128 v[120:123], v4 offset:18432
    buffer_load_dwordx4 a[172:175], v3, s[8:11], s81 offen offset:3072 sc1
    v_cndmask_b32 v163, v57, 0, s[84:85]
    v_cndmask_b32 v146, 0, v57, s[82:83]
    v_cndmask_b32 v147, 0, v57, s[84:85]
    v_cndmask_b32 v62, 0, v60, s[82:83]
    s_waitcnt lgkmcnt(5)
    s_nop 0
    v_mfma_f32_32x32x16_bf16 v[96:111], v[132:135], v[196:199], v[96:111]
    ds_read_b128 v[124:127], v4 offset:19456
    s_add_u32 s81, s81, 4096
    buffer_load_dwordx4 a[176:179], v3, s[8:11], s81 offen offset:0 sc1
    v_cndmask_b32 v63, 0, v61, s[84:85]
    v_cmp_le_i32 s[82:83], 8, v21
    v_cmp_le_i32 s[84:85], 9, v21
    v_or_b32 v89, v62, v63
    s_waitcnt lgkmcnt(5)
    v_mfma_f32_32x32x16_bf16 v[96:111], v[136:139], v[200:203], v[96:111]
    ds_read_b128 v[128:131], v4 offset:20480
    buffer_load_dwordx4 a[180:183], v3, s[8:11], s81 offen offset:1024 sc1
    v_cndmask_b32 v164, v57, 0, s[82:83]
    v_cndmask_b32 v165, v57, 0, s[84:85]
    v_cndmask_b32 v148, 0, v57, s[82:83]
    v_cndmask_b32 v149, 0, v57, s[84:85]
    s_waitcnt lgkmcnt(5)
    s_nop 0
    v_mfma_f32_32x32x16_bf16 v[96:111], v[140:143], v[204:207], v[96:111]
    ds_read_b128 v[132:135], v4 offset:21504
    buffer_load_dwordx4 a[184:187], v3, s[8:11], s81 offen offset:2048 sc1
    v_cndmask_b32 v62, 0, v60, s[82:83]
    v_cndmask_b32 v63, 0, v61, s[84:85]
    v_cmp_le_i32 s[82:83], 10, v21
    v_cmp_le_i32 s[84:85], 11, v21
    s_waitcnt lgkmcnt(5)
    v_mfma_f32_32x32x16_bf16 v[96:111], v[112:115], v[208:211], v[96:111]
    ds_read_b128 v[136:139], v4 offset:22528
    buffer_load_dwordx4 a[188:191], v3, s[8:11], s81 offen offset:3072 sc1
    v_or_b32 v90, v62, v63
    v_cndmask_b32 v166, v57, 0, s[82:83]
    v_cndmask_b32 v167, v57, 0, s[84:85]
    v_cndmask_b32 v150, 0, v57, s[82:83]
    s_waitcnt lgkmcnt(5)
    s_nop 0
    v_mfma_f32_32x32x16_bf16 v[96:111], v[116:119], v[212:215], v[96:111]
    ds_read_b128 v[140:143], v4 offset:23552
    v_cndmask_b32 v151, 0, v57, s[84:85]
    v_cndmask_b32 v62, 0, v60, s[82:83]
    v_cndmask_b32 v63, 0, v61, s[84:85]
    v_cmp_le_i32 s[82:83], 16, v21
    s_waitcnt lgkmcnt(5)
    v_mfma_f32_32x32x16_bf16 v[96:111], v[120:123], v[216:219], v[96:111]
    ds_read_b128 v[112:115], v4 offset:24576
    v_cmp_le_i32 s[84:85], 17, v21
    v_or_b32 v91, v62, v63
    v_cndmask_b32 v168, v57, 0, s[82:83]
    v_cndmask_b32 v169, v57, 0, s[84:85]
    s_waitcnt lgkmcnt(5)
    s_nop 0
    v_mfma_f32_32x32x16_bf16 v[96:111], v[124:127], v[220:223], v[96:111]
    ds_read_b128 v[116:119], v4 offset:25600
    v_cndmask_b32 v152, 0, v57, s[82:83]
    v_cndmask_b32 v153, 0, v57, s[84:85]
    v_cndmask_b32 v62, 0, v60, s[82:83]
    v_cndmask_b32 v63, 0, v61, s[84:85]
    s_waitcnt lgkmcnt(5)
    v_mfma_f32_32x32x16_bf16 v[96:111], v[128:131], v[224:227], v[96:111]
    ds_read_b128 v[120:123], v4 offset:26624
    s_add_u32 m0, s67, 0
    s_nop 0
    buffer_load_dwordx4 v1, s[8:11], s65 offen offset:0 sc1 lds
    buffer_load_dwordx4 v1, s[8:11], s65 offen offset:1024 sc1 lds
    s_add_u32 m0, s67, 4096
    s_nop 0
    buffer_load_dwordx4 v1, s[8:11], s66 offen offset:0 sc1 lds
    buffer_load_dwordx4 v1, s[8:11], s66 offen offset:1024 sc1 lds
    v_cmp_le_i32 s[82:83], 18, v21
    v_cmp_le_i32 s[84:85], 19, v21
    v_or_b32 v92, v62, v63
    v_cndmask_b32 v170, v57, 0, s[82:83]
    s_waitcnt lgkmcnt(5)
    v_mfma_f32_32x32x16_bf16 v[96:111], v[132:135], v[228:231], v[96:111]
    ds_read_b128 v[124:127], v4 offset:27648
    v_cndmask_b32 v171, v57, 0, s[84:85]
    v_cndmask_b32 v154, 0, v57, s[82:83]
    v_cndmask_b32 v155, 0, v57, s[84:85]
    v_cndmask_b32 v62, 0, v60, s[82:83]
    s_waitcnt lgkmcnt(5)
    s_nop 0
    v_mfma_f32_32x32x16_bf16 v[96:111], v[136:139], v[232:235], v[96:111]
    v_cndmask_b32 v63, 0, v61, s[84:85]
    v_cmp_le_i32 s[82:83], 24, v21
    v_cmp_le_i32 s[84:85], 25, v21
    v_or_b32 v93, v62, v63
    s_waitcnt lgkmcnt(4)
    v_mfma_f32_32x32x16_bf16 v[96:111], v[140:143], v[236:239], v[96:111]
    v_cndmask_b32 v172, v57, 0, s[82:83]
    v_cndmask_b32 v173, v57, 0, s[84:85]
    v_cndmask_b32 v156, 0, v57, s[82:83]
    v_cndmask_b32 v157, 0, v57, s[84:85]
    s_waitcnt lgkmcnt(3)
    s_nop 0
    v_mfma_f32_32x32x16_bf16 v[96:111], v[112:115], v[240:243], v[96:111]
    v_cndmask_b32 v62, 0, v60, s[82:83]
    v_cndmask_b32 v63, 0, v61, s[84:85]
    v_cmp_le_i32 s[82:83], 26, v21
    v_cmp_le_i32 s[84:85], 27, v21
    v_mov_b32 v128, v54
    v_mov_b32 v132, v51
    s_waitcnt lgkmcnt(2)
    v_mfma_f32_32x32x16_bf16 v[96:111], v[116:119], v[244:247], v[96:111]
    v_or_b32 v94, v62, v63
    v_cndmask_b32 v174, v57, 0, s[82:83]
    v_cndmask_b32 v175, v57, 0, s[84:85]
    v_cndmask_b32 v158, 0, v57, s[82:83]
    v_mov_b32_e64 v129, 0
    v_mov_b32 v133, 0
    s_waitcnt lgkmcnt(1)
    v_mfma_f32_32x32x16_bf16 v[96:111], v[120:123], v[248:251], v[96:111]
    v_cndmask_b32 v159, 0, v57, s[84:85]
    v_cndmask_b32 v62, 0, v60, s[82:83]
    v_cndmask_b32 v63, 0, v61, s[84:85]
    v_or_b32 v95, v62, v63
    v_mov_b32 v130, 0
    v_mov_b32 v134, 0
    s_waitcnt lgkmcnt(0)
    v_mfma_f32_32x32x16_bf16 v[96:111], v[124:127], v[252:255], v[96:111]
    s_add_u32 m0, s67, 0
    s_nop 0
    buffer_load_dwordx4 v1, s[8:11], s65 offen offset:2048 sc1 lds
    buffer_load_dwordx4 v1, s[8:11], s65 offen offset:3072 sc1 lds
    s_add_u32 m0, s67, 4096
    s_nop 0
    s_nop 0
    buffer_load_dwordx4 v1, s[8:11], s66 offen offset:2048 sc1 lds
    buffer_load_dwordx4 v1, s[8:11], s66 offen offset:3072 sc1 lds
    v_mov_b32 v59, 0xff61b1e6
    v_mul_f32 v62, 0x3e8b97f6, v56
    v_mov_b32 v131, 0
    v_mov_b32 v135, 0
    s_nop 1
    v_mfma_f32_32x32x16_bf16 v[96:111], v[132:135], v[128:131], v[96:111]
    s_nop 11
    v_pk_mul_f32 v[96:97], v[96:97], v[62:63] op_sel_hi:[1,0]
    v_pk_mul_f32 v[98:99], v[98:99], v[62:63] op_sel_hi:[1,0]
    v_pk_mul_f32 v[100:101], v[100:101], v[62:63] op_sel_hi:[1,0]
    v_pk_mul_f32 v[102:103], v[102:103], v[62:63] op_sel_hi:[1,0]
    v_pk_mul_f32 v[104:105], v[104:105], v[62:63] op_sel_hi:[1,0]
    v_pk_mul_f32 v[106:107], v[106:107], v[62:63] op_sel_hi:[1,0]
    v_pk_mul_f32 v[108:109], v[108:109], v[62:63] op_sel_hi:[1,0]
    v_pk_mul_f32 v[110:111], v[110:111], v[62:63] op_sel_hi:[1,0]
    v_cvt_pk_bf16_f32 v96, v96, v97
    v_cvt_pk_bf16_f32 v97, v98, v99
    v_cvt_pk_bf16_f32 v98, v100, v101
    v_cvt_pk_bf16_f32 v99, v102, v103
    v_cvt_pk_bf16_f32 v100, v104, v105
    v_cvt_pk_bf16_f32 v101, v106, v107
    v_cvt_pk_bf16_f32 v102, v108, v109
    v_cvt_pk_bf16_f32 v103, v110, v111
    s_mov_b32 exec_lo, 0
    v_mov_b32 v102, 16256
    s_mov_b32 exec_lo, -1
    v_mfma_f32_32x32x16_bf16 v[160:175], v[64:67], v[96:99], v[160:175]
    v_mfma_f32_32x32x16_bf16 v[160:175], v[68:71], v[100:103], v[160:175]
    s_mov_b32 s55, 0
    s_waitcnt vmcnt(4)
    ds_read_b128 v[176:179], v6 offset:0
    ds_read_b128 v[180:183], v6 offset:1024
    ds_read_b128 v[184:187], v6 offset:4096
    ds_read_b128 v[188:191], v6 offset:5120
Lhp_55:
    s_waitcnt lgkmcnt(0)
    s_nop 0
    v_max3_u32 v62, v176, v177, v178
    v_max3_u32 v62, v179, v180, v62
    v_max3_u32 v62, v181, v182, v62
    v_max3_u32 v62, v183, v184, v62
    v_max3_u32 v62, v185, v186, v62
    v_max3_u32 v62, v187, v188, v62
    v_max3_u32 v62, v189, v190, v62
    v_max_u32 v62, v191, v62
    v_cmp_eq_u32 vcc, -1, v62
    s_nop 0
    s_cmp_eq_u64 vcc, 0
    s_nop 1
    s_cbranch_scc1 Lho_56
    s_add_u32 s55, s55, 1
    s_cmp_ge_u32 s55, 200000
    s_cselect_b32 s88, 32, 0
    s_or_b32 s79, s79, s88
    s_cmp_lg_u32 s88, 0
    s_cbranch_scc1 Lho_56
    s_sleep 1
    s_add_u32 m0, s67, 0
    s_nop 0
    buffer_load_dwordx4 v1, s[8:11], s65 offen offset:0 sc1 lds
    buffer_load_dwordx4 v1, s[8:11], s65 offen offset:1024 sc1 lds
    s_add_u32 m0, s67, 4096
    s_nop 0
    buffer_load_dwordx4 v1, s[8:11], s66 offen offset:0 sc1 lds
    buffer_load_dwordx4 v1, s[8:11], s66 offen offset:1024 sc1 lds
    s_add_u32 m0, s67, 0
    s_nop 0
    buffer_load_dwordx4 v1, s[8:11], s65 offen offset:2048 sc1 lds
    buffer_load_dwordx4 v1, s[8:11], s65 offen offset:3072 sc1 lds
    s_add_u32 m0, s67, 4096
    s_nop 0
    buffer_load_dwordx4 v1, s[8:11], s66 offen offset:2048 sc1 lds
    buffer_load_dwordx4 v1, s[8:11], s66 offen offset:3072 sc1 lds
    s_waitcnt vmcnt(4)
    s_nop 0
    ds_read_b128 v[176:179], v6 offset:0
    ds_read_b128 v[180:183], v6 offset:1024
    ds_read_b128 v[184:187], v6 offset:4096
    ds_read_b128 v[188:191], v6 offset:5120
    s_branch Lhp_55
Lho_56:
    s_cmp_lg_u32 s65, 117440512
    s_cbranch_scc1 Lmk_58
    v_mov_b32 v62, 65377
    s_mov_b32 exec_lo, 0
    ds_write_b32 v6, v62 offset:1032
    ds_write_b32 v6, v62 offset:5128
    s_mov_b32 exec_lo, -1
    s_waitcnt lgkmcnt(0)
Lmk_58:
    s_barrier
    ds_read_b128 v[64:67], v14 offset:0
    ds_read_b128 v[68:71], v14 offset:1024
    ds_read_b128 v[72:75], v14 offset:4096
    ds_read_b128 v[76:79], v14 offset:5120
    ds_read_b128 v[80:83], v14 offset:8192
    ds_read_b128 v[84:87], v14 offset:9216
    v_mov_b32 v104, -1
    v_mov_b32 v105, -1
    v_mov_b32 v106, -1
    v_mov_b32 v107, -1
    s_cmp_eq_u32 s53, 0
    s_cbranch_scc1 Lslow_59
    s_add_u32 s68, s57, 6291456
    buffer_store_dwordx4 v[104:107], v1, s[8:11], s68 offen offset:0
    buffer_store_dwordx4 v[104:107], v1, s[8:11], s68 offen offset:1024
Ldone_60:
    s_waitcnt lgkmcnt(4)
    v_mfma_f32_32x32x16_bf16 v[144:159], v[64:67], v[96:99], v[144:159]
    s_add_u32 m0, s46, 0
    s_add_u32 s80, s46, s78
    s_nop 0
    s_add_u32 s80, s80, 26214400
    buffer_load_dwordx4 v3, s[8:11], s80 offen offset:0 sc1 lds
    v_mfma_f32_32x32x16_bf16 v[144:159], v[68:71], v[100:103], v[144:159]
    ds_read_b128 v[64:67], v14 offset:12288
    ds_read_b128 v[68:71], v14 offset:13312
    s_waitcnt lgkmcnt(4)
    s_nop 0
    v_mfma_f32_32x32x16_bf16 v[112:127], v[72:75], v[96:99], 0
    v_mfma_f32_32x32x16_bf16 v[112:127], v[76:79], v[100:103], v[112:127]
    ds_read_b128 v[72:75], v14 offset:16384
    ds_read_b128 v[76:79], v14 offset:17408
    s_waitcnt lgkmcnt(4)
    v_mfma_f32_32x32x16_bf16 v[128:143], v[80:83], v[96:99], 0
    s_nop 2
    v_max_f32 v144, v144, v160
    v_max_f32 v145, v145, v161
    v_max_f32 v146, v146, v162
    v_max_f32 v147, v147, v163
    v_max_f32 v148, v148, v164
    v_max_f32 v149, v149, v165
    v_mfma_f32_32x32x16_bf16 v[128:143], v[84:87], v[100:103], v[128:143]
    ds_read_b128 v[80:83], v14 offset:20480
    ds_read_b128 v[84:87], v14 offset:21504
    v_max_f32 v150, v150, v166
    v_max_f32 v151, v151, v167
    v_max_f32 v152, v152, v168
    v_max_f32 v153, v153, v169
    v_max_f32 v154, v154, v170
    s_waitcnt lgkmcnt(4)
    v_mfma_f32_32x32x16_bf16 v[176:191], v[64:67], v[96:99], 0
    v_max_f32 v155, v155, v171
    v_max_f32 v156, v156, v172
    v_max_f32 v157, v157, v173
    v_max_f32 v158, v158, v174
    v_max_f32_e64 v159, v159, v175
    v_max3_f32 v58, v144, v145, v58
    v_mfma_f32_32x32x16_bf16 v[176:191], v[68:71], v[100:103], v[176:191]
    ds_read_b128 v[64:67], v14 offset:24576
    ds_read_b128 v[68:71], v14 offset:25600
    v_max3_f32 v59, v146, v147, v59
    v_max3_f32 v58, v148, v149, v58
    v_max3_f32 v59, v150, v151, v59
    v_max3_f32 v58, v152, v153, v58
    v_max3_f32 v59, v154, v155, v59
    s_waitcnt lgkmcnt(4)
    s_nop 0
    v_mfma_f32_32x32x16_bf16 v[192:207], v[72:75], v[96:99], 0
    buffer_load_dwordx4 v3, s[8:11], s80 offen offset:1024 sc1 lds
    v_max3_f32 v58, v156, v157, v58
    v_max3_f32 v59, v158, v159, v59
    v_max3_f32 v58, v112, v113, v58
    v_max3_f32 v59, v114, v115, v59
    v_max3_f32 v58, v116, v117, v58
    v_max3_f32 v59, v118, v119, v59
    v_mfma_f32_32x32x16_bf16 v[192:207], v[76:79], v[100:103], v[192:207]
    ds_read_b128 v[72:75], v14 offset:28672
    ds_read_b128 v[76:79], v14 offset:29696
    v_max3_f32 v58, v120, v121, v58
    v_max3_f32 v59, v122, v123, v59
    v_max3_f32 v58, v124, v125, v58
    v_max3_f32 v59, v126, v127, v59
    v_max3_f32 v58, v128, v129, v58
    s_waitcnt lgkmcnt(4)
    s_nop 0
    v_mfma_f32_32x32x16_bf16 v[208:223], v[80:83], v[96:99], 0
    v_max3_f32 v59, v130, v131, v59
    v_max3_f32 v58, v132, v133, v58
    v_max3_f32 v59, v134, v135, v59
    v_max3_f32 v58, v136, v137, v58
    v_max3_f32 v59, v138, v139, v59
    v_max3_f32 v58, v140, v141, v58
    v_mfma_f32_32x32x16_bf16 v[208:223], v[84:87], v[100:103], v[208:223]
    v_max3_f32 v59, v142, v143, v59
    v_max3_f32 v58, v176, v177, v58
    v_max3_f32 v59, v178, v179, v59
    v_max3_f32 v58, v180, v181, v58
    v_max3_f32 v59, v182, v183, v59
    s_waitcnt lgkmcnt(2)
    s_nop 0
    v_mfma_f32_32x32x16_bf16 v[224:239], v[64:67], v[96:99], 0
    v_max3_f32 v58, v184, v185, v58
    v_max3_f32 v59, v186, v187, v59
    v_max3_f32 v58, v188, v189, v58
    v_max3_f32 v59, v190, v191, v59
    v_max3_f32 v58, v192, v193, v58
    v_max3_f32 v59, v194, v195, v59
    v_mfma_f32_32x32x16_bf16 v[224:239], v[68:71], v[100:103], v[224:239]
    v_max3_f32 v58, v196, v197, v58
    v_max3_f32 v59, v198, v199, v59
    v_max3_f32 v58, v200, v201, v58
    v_max3_f32 v59, v202, v203, v59
    v_max3_f32 v58, v204, v205, v58
    s_waitcnt lgkmcnt(0)
    s_nop 0
    v_mfma_f32_32x32x16_bf16 v[240:255], v[72:75], v[96:99], 0
    v_max3_f32 v59, v206, v207, v59
    v_max3_f32 v58, v208, v209, v58
    v_max3_f32 v59, v210, v211, v59
    v_max3_f32 v58, v212, v213, v58
    v_max3_f32 v59, v214, v215, v59
    v_max3_f32 v58, v216, v217, v58
    v_mfma_f32_32x32x16_bf16 v[240:255], v[76:79], v[100:103], v[240:255]
    v_max3_f32 v59, v218, v219, v59
    v_max3_f32 v58, v220, v221, v58
    v_max3_f32 v59, v222, v223, v59
    v_max3_f32 v58, v224, v225, v58
    v_max3_f32 v59, v226, v227, v59
    buffer_load_dwordx4 v3, s[8:11], s80 offen offset:2048 sc1 lds
    v_max3_f32 v58, v228, v229, v58
    v_max3_f32 v59, v230, v231, v59
    v_max3_f32 v58, v232, v233, v58
    v_max3_f32 v59, v234, v235, v59
    v_max3_f32 v58, v236, v237, v58
    v_max3_f32 v59, v238, v239, v59
    v_max3_f32 v58, v240, v241, v58
    v_max3_f32 v59, v242, v243, v59
    v_max3_f32 v58, v244, v245, v58
    v_max3_f32 v59, v246, v247, v59
    v_max3_f32 v58, v248, v249, v58
    v_max3_f32 v59, v250, v251, v59
    v_max3_f32 v58, v252, v253, v58
    v_max3_f32 v59, v254, v255, v59
    v_max_f32 v58, v58, v59
    v_mov_b32 v60, v58
    s_nop 1
    v_permlane32_swap_b32 v58, v60
    v_max_f32 v58, v58, v60
    v_sub_f32 v58, 0, v58
    v_pk_add_f32 v[144:145], v[144:145], v[58:59] op_sel_hi:[1,0]
    v_pk_add_f32 v[146:147], v[146:147], v[58:59] op_sel_hi:[1,0]
    v_pk_add_f32 v[148:149], v[148:149], v[58:59] op_sel_hi:[1,0]
    v_pk_add_f32 v[150:151], v[150:151], v[58:59] op_sel_hi:[1,0]
    v_pk_add_f32 v[152:153], v[152:153], v[58:59] op_sel_hi:[1,0]
    v_pk_add_f32 v[154:155], v[154:155], v[58:59] op_sel_hi:[1,0]
    v_pk_add_f32 v[156:157], v[156:157], v[58:59] op_sel_hi:[1,0]
    v_pk_add_f32 v[158:159], v[158:159], v[58:59] op_sel_hi:[1,0]
    v_exp_f32 v144, v144
    v_exp_f32 v145, v145
    v_exp_f32 v146, v146
    v_exp_f32 v147, v147
    v_exp_f32 v148, v148
    v_exp_f32 v149, v149
    v_exp_f32 v150, v150
    v_exp_f32 v151, v151
    v_exp_f32 v152, v152
    v_exp_f32 v153, v153
    v_exp_f32 v154, v154
    v_exp_f32 v155, v155
    v_exp_f32 v156, v156
    v_exp_f32 v157, v157
    v_exp_f32_e64 v158, v158
    v_exp_f32 v159, v159
    s_waitcnt vmcnt(3)
    ds_read_b128 v[64:67], v6 offset:2048
    ds_read_b128 v[68:71], v6 offset:3072
    ds_read_b128 v[72:75], v6 offset:6144
    ds_read_b128 v[76:79], v6 offset:7168
    v_cvt_pk_bf16_f32 v144, v144, v145
    v_cvt_pk_bf16_f32 v145, v146, v147
    v_cvt_pk_bf16_f32 v146, v148, v149
    v_cvt_pk_bf16_f32 v147, v150, v151
    v_cvt_pk_bf16_f32 v148, v152, v153
    v_cvt_pk_bf16_f32 v149, v154, v155
    v_cvt_pk_bf16_f32 v150, v156, v157
    v_cvt_pk_bf16_f32 v151, v158, v159
    v_and_b32 v160, v144, v88
    v_xor_b32 v144, v144, v160
    v_and_b32 v161, v145, v89
    v_xor_b32 v145, v145, v161
    v_and_b32 v162, v146, v90
    v_xor_b32 v146, v146, v162
    v_and_b32 v163, v147, v91
    v_xor_b32 v147, v147, v163
    v_and_b32 v164, v148, v92
    v_xor_b32 v148, v148, v164
    v_and_b32 v165, v149, v93
    v_xor_b32 v149, v149, v165
    v_and_b32 v166, v150, v94
    v_xor_b32 v150, v150, v166
    v_and_b32 v167, v151, v95
    v_xor_b32 v151, v151, v167
    s_mov_b32 s55, 0
Lhp_61:
    s_waitcnt lgkmcnt(0)
    v_max3_u32 v62, v64, v65, v66
    v_max3_u32 v62, v67, v68, v62
    v_max3_u32 v62, v69, v70, v62
    v_max3_u32 v62, v71, v72, v62
    v_max3_u32 v62, v73, v74, v62
    v_max3_u32 v62, v75, v76, v62
    v_max3_u32 v62, v77, v78, v62
    v_max_u32 v62, v79, v62
    v_cmp_eq_u32 vcc, -1, v62
    s_nop 0
    s_cmp_eq_u64 vcc, 0
    s_nop 1
    s_cbranch_scc1 Lho_62
    s_add_u32 s55, s55, 1
    s_cmp_ge_u32 s55, 200000
    s_cselect_b32 s88, 32, 0
    s_or_b32 s79, s79, s88
    s_cmp_lg_u32 s88, 0
    s_cbranch_scc1 Lho_62
    s_sleep 1
    s_add_u32 m0, s67, 0
    s_nop 0
    buffer_load_dwordx4 v1, s[8:11], s65 offen offset:2048 sc1 lds
    buffer_load_dwordx4 v1, s[8:11], s65 offen offset:3072 sc1 lds
    s_add_u32 m0, s67, 4096
    s_nop 0
    buffer_load_dwordx4 v1, s[8:11], s66 offen offset:2048 sc1 lds
    buffer_load_dwordx4 v1, s[8:11], s66 offen offset:3072 sc1 lds
    s_waitcnt vmcnt(0)
    ds_read_b128 v[64:67], v6 offset:2048
    ds_read_b128 v[68:71], v6 offset:3072
    ds_read_b128 v[72:75], v6 offset:6144
    ds_read_b128 v[76:79], v6 offset:7168
    s_branch Lhp_61
Lho_62:
    s_barrier
    s_add_u32 m0, s46, 0
    s_add_u32 s80, s46, s78
    s_add_u32 s80, s80, 26214400
    buffer_load_dwordx4 v3, s[8:11], s80 offen offset:3072 sc1 lds
    s_add_u32 m0, s46, 4096
    s_add_u32 s80, s46, s78
    s_add_u32 s80, s80, 26218496
    buffer_load_dwordx4 v3, s[8:11], s80 offen offset:0 sc1 lds
    s_add_u32 s81, s50, 2
    s_and_b32 s81, s81, 3
    s_lshl_b32 s81, s81, 13
    s_add_u32 s81, s81, s86
    s_nop 0
    s_add_u32 s81, s81, 29884416
    buffer_load_dwordx4 a[192:195], v3, s[8:11], s81 offen offset:0 sc1
    buffer_load_dwordx4 a[196:199], v3, s[8:11], s81 offen offset:1024 sc1
    ds_read_b128 v[64:67], v14 offset:2048
    ds_read_b128 v[68:71], v14 offset:3072
    ds_read_b128 v[72:75], v14 offset:6144
    ds_read_b128 v[76:79], v14 offset:7168
    ds_read_b128 v[80:83], v14 offset:10240
    ds_read_b128 v[84:87], v14 offset:11264
    ds_read_b128 v[168:171], v14 offset:34816
    ds_read_b128 v[172:175], v14 offset:35840
    v_pk_add_f32 v[112:113], v[112:113], v[58:59] op_sel_hi:[1,0]
    v_pk_add_f32 v[114:115], v[114:115], v[58:59] op_sel_hi:[1,0]
    v_pk_add_f32 v[116:117], v[116:117], v[58:59] op_sel_hi:[1,0]
    v_pk_add_f32 v[118:119], v[118:119], v[58:59] op_sel_hi:[1,0]
    v_pk_add_f32 v[120:121], v[120:121], v[58:59] op_sel_hi:[1,0]
    v_pk_add_f32 v[122:123], v[122:123], v[58:59] op_sel_hi:[1,0]
    v_pk_add_f32 v[124:125], v[124:125], v[58:59] op_sel_hi:[1,0]
    v_pk_add_f32 v[126:127], v[126:127], v[58:59] op_sel_hi:[1,0]
    v_exp_f32 v112, v112
    v_exp_f32 v113, v113
    s_waitcnt lgkmcnt(6)
    v_mfma_f32_32x32x16_bf16 v[96:111], v[64:67], v[144:147], 0
    v_exp_f32 v114, v114
    v_exp_f32 v115, v115
    v_exp_f32 v116, v116
    v_exp_f32_e64 v117, v117
    v_mfma_f32_32x32x16_bf16 v[96:111], v[68:71], v[148:151], v[96:111]
    ds_read_b128 v[64:67], v14 offset:14336
    ds_read_b128 v[68:71], v14 offset:15360
    v_exp_f32 v118, v118
    v_exp_f32 v119, v119
    v_exp_f32 v120, v120
    v_exp_f32 v121, v121
    s_waitcnt lgkmcnt(2)
    v_mfma_f32_32x32x16_bf16 v[96:111], v[168:171], v[160:163], v[96:111]
    v_exp_f32 v122, v122
    v_exp_f32 v123, v123
    buffer_load_dwordx4 a[200:203], v3, s[8:11], s81 offen offset:2048 sc1
    v_exp_f32 v124, v124
    v_exp_f32 v125, v125
    v_mfma_f32_32x32x16_bf16 v[96:111], v[172:175], v[164:167], v[96:111]
    v_exp_f32 v126, v126
    v_exp_f32_e64 v127, v127
    v_cvt_pk_bf16_f32 v112, v112, v113
    v_cvt_pk_bf16_f32 v113, v114, v115
    v_cvt_pk_bf16_f32 v114, v116, v117
    v_cvt_pk_bf16_f32 v115, v118, v119
    v_cvt_pk_bf16_f32 v116, v120, v121
    v_cvt_pk_bf16_f32 v117, v122, v123
    v_cvt_pk_bf16_f32 v118, v124, v125
    v_cvt_pk_bf16_f32 v119, v126, v127
    v_pk_add_f32 v[128:129], v[128:129], v[58:59] op_sel_hi:[1,0]
    v_pk_add_f32 v[130:131], v[130:131], v[58:59] op_sel_hi:[1,0]
    v_pk_add_f32 v[132:133], v[132:133], v[58:59] op_sel_hi:[1,0]
    v_pk_add_f32 v[134:135], v[134:135], v[58:59] op_sel_hi:[1,0]
    v_pk_add_f32 v[136:137], v[136:137], v[58:59] op_sel_hi:[1,0]
    buffer_load_dwordx4 a[204:207], v3, s[8:11], s81 offen offset:3072 sc1
    v_pk_add_f32 v[138:139], v[138:139], v[58:59] op_sel_hi:[1,0]
    v_pk_add_f32 v[140:141], v[140:141], v[58:59] op_sel_hi:[1,0]
    v_pk_add_f32 v[142:143], v[142:143], v[58:59] op_sel_hi:[1,0]
    v_exp_f32 v128, v128
    v_exp_f32 v129, v129
    v_mfma_f32_32x32x16_bf16 v[96:111], v[72:75], v[112:115], v[96:111]
    v_exp_f32 v130, v130
    v_exp_f32 v131, v131
    v_exp_f32 v132, v132
    v_exp_f32 v133, v133
    v_mfma_f32_32x32x16_bf16 v[96:111], v[76:79], v[116:119], v[96:111]
    ds_read_b128 v[72:75], v14 offset:18432
    ds_read_b128 v[76:79], v14 offset:19456
    v_exp_f32_e64 v134, v134
    s_add_u32 s81, s81, 4096
    buffer_load_dwordx4 a[208:211], v3, s[8:11], s81 offen offset:0 sc1
    v_exp_f32 v135, v135
    v_exp_f32 v136, v136
    v_exp_f32 v137, v137
    v_exp_f32 v138, v138
    v_exp_f32 v139, v139
    v_exp_f32 v140, v140
    v_exp_f32 v141, v141
    v_exp_f32 v142, v142
    v_exp_f32_e64 v143, v143
    v_cvt_pk_bf16_f32 v128, v128, v129
    v_cvt_pk_bf16_f32 v129, v130, v131
    v_cvt_pk_bf16_f32 v130, v132, v133
    v_cvt_pk_bf16_f32 v131, v134, v135
    v_cvt_pk_bf16_f32 v132, v136, v137
    buffer_load_dwordx4 a[212:215], v3, s[8:11], s81 offen offset:1024 sc1
    v_cvt_pk_bf16_f32 v133, v138, v139
    v_cvt_pk_bf16_f32 v134, v140, v141
    v_cvt_pk_bf16_f32 v135, v142, v143
    v_pk_add_f32 v[176:177], v[176:177], v[58:59] op_sel_hi:[1,0]
    v_pk_add_f32 v[178:179], v[178:179], v[58:59] op_sel_hi:[1,0]
    v_pk_add_f32 v[180:181], v[180:181], v[58:59] op_sel_hi:[1,0]
    v_pk_add_f32 v[182:183], v[182:183], v[58:59] op_sel_hi:[1,0]
    v_pk_add_f32 v[184:185], v[184:185], v[58:59] op_sel_hi:[1,0]
    v_pk_add_f32 v[186:187], v[186:187], v[58:59] op_sel_hi:[1,0]
    v_pk_add_f32 v[188:189], v[188:189], v[58:59] op_sel_hi:[1,0]
    v_pk_add_f32 v[190:191], v[190:191], v[58:59] op_sel_hi:[1,0]
    v_exp_f32 v176, v176
    v_exp_f32 v177, v177
    v_mfma_f32_32x32x16_bf16 v[96:111], v[80:83], v[128:131], v[96:111]
    v_exp_f32 v178, v178
    v_exp_f32 v179, v179
    v_exp_f32 v180, v180
    buffer_load_dwordx4 a[216:219], v3, s[8:11], s81 offen offset:2048 sc1
    v_exp_f32 v181, v181
    v_mfma_f32_32x32x16_bf16 v[96:111], v[84:87], v[132:135], v[96:111]
    ds_read_b128 v[80:83], v14 offset:22528
    ds_read_b128 v[84:87], v14 offset:23552
    v_exp_f32 v182, v182
    v_exp_f32 v183, v183
    v_exp_f32 v184, v184
    v_exp_f32 v185, v185
    v_exp_f32 v186, v186
    v_exp_f32 v187, v187
    v_exp_f32 v188, v188
    v_exp_f32 v189, v189
    v_exp_f32 v190, v190
    buffer_load_dwordx4 a[220:223], v3, s[8:11], s81 offen offset:3072 sc1
    v_exp_f32 v191, v191
    v_cvt_pk_bf16_f32 v176, v176, v177
    v_cvt_pk_bf16_f32 v177, v178, v179
    v_cvt_pk_bf16_f32 v178, v180, v181
    v_cvt_pk_bf16_f32 v179, v182, v183
    v_cvt_pk_bf16_f32 v180, v184, v185
    v_cvt_pk_bf16_f32 v181, v186, v187
    v_cvt_pk_bf16_f32 v182, v188, v189
    v_cvt_pk_bf16_f32 v183, v190, v191
    v_pk_add_f32 v[192:193], v[192:193], v[58:59] op_sel_hi:[1,0]
    v_pk_add_f32 v[194:195], v[194:195], v[58:59] op_sel_hi:[1,0]
    v_pk_add_f32 v[196:197], v[196:197], v[58:59] op_sel_hi:[1,0]
    v_pk_add_f32 v[198:199], v[198:199], v[58:59] op_sel_hi:[1,0]
    v_pk_add_f32 v[200:201], v[200:201], v[58:59] op_sel_hi:[1,0]
    v_pk_add_f32 v[202:203], v[202:203], v[58:59] op_sel_hi:[1,0]
    v_pk_add_f32 v[204:205], v[204:205], v[58:59] op_sel_hi:[1,0]
    v_pk_add_f32 v[206:207], v[206:207], v[58:59] op_sel_hi:[1,0]
    v_exp_f32 v192, v192
    v_exp_f32 v193, v193
    s_waitcnt lgkmcnt(4)
    v_mfma_f32_32x32x16_bf16 v[96:111], v[64:67], v[176:179], v[96:111]
    s_add_u32 s81, s50, 3
    s_and_b32 s81, s81, 3
    s_lshl_b32 s81, s81, 13
    s_add_u32 s81, s81, s86
    s_add_u32 s81, s81, 29884416
    buffer_load_dwordx4 a[224:227], v3, s[8:11], s81 offen offset:0 sc1
    v_exp_f32 v194, v194
    v_exp_f32 v195, v195
    v_exp_f32 v196, v196
    v_exp_f32_e64 v197, v197
    v_mfma_f32_32x32x16_bf16 v[96:111], v[68:71], v[180:183], v[96:111]
    ds_read_b128 v[64:67], v14 offset:26624
    ds_read_b128 v[68:71], v14 offset:27648
    v_exp_f32 v198, v198
    v_exp_f32 v199, v199
    v_exp_f32 v200, v200
    v_exp_f32 v201, v201
    v_exp_f32 v202, v202
    v_exp_f32 v203, v203
    buffer_load_dwordx4 a[228:231], v3, s[8:11], s81 offen offset:1024 sc1
    v_exp_f32 v204, v204
    v_exp_f32 v205, v205
    v_exp_f32 v206, v206
    v_exp_f32 v207, v207
    v_cvt_pk_bf16_f32 v192, v192, v193
    v_cvt_pk_bf16_f32 v193, v194, v195
    v_cvt_pk_bf16_f32 v194, v196, v197
    v_cvt_pk_bf16_f32 v195, v198, v199
    v_cvt_pk_bf16_f32 v196, v200, v201
    v_cvt_pk_bf16_f32 v197, v202, v203
    v_cvt_pk_bf16_f32 v198, v204, v205
    v_cvt_pk_bf16_f32 v199, v206, v207
    v_pk_add_f32 v[208:209], v[208:209], v[58:59] op_sel_hi:[1,0]
    v_pk_add_f32 v[210:211], v[210:211], v[58:59] op_sel_hi:[1,0]
    v_pk_add_f32 v[212:213], v[212:213], v[58:59] op_sel_hi:[1,0]
    v_pk_add_f32 v[214:215], v[214:215], v[58:59] op_sel_hi:[1,0]
    v_pk_add_f32 v[216:217], v[216:217], v[58:59] op_sel_hi:[1,0]
    v_pk_add_f32 v[218:219], v[218:219], v[58:59] op_sel_hi:[1,0]
    v_pk_add_f32 v[220:221], v[220:221], v[58:59] op_sel_hi:[1,0]
    buffer_load_dwordx4 a[232:235], v3, s[8:11], s81 offen offset:2048 sc1
    v_pk_add_f32 v[222:223], v[222:223], v[58:59] op_sel_hi:[1,0]
    v_exp_f32 v208, v208
    v_exp_f32 v209, v209
    s_waitcnt lgkmcnt(4)
    v_mfma_f32_32x32x16_bf16 v[96:111], v[72:75], v[192:195], v[96:111]
    v_exp_f32 v210, v210
    v_exp_f32 v211, v211
    v_exp_f32 v212, v212
    v_exp_f32_e64 v213, v213
    v_mfma_f32_32x32x16_bf16 v[96:111], v[76:79], v[196:199], v[96:111]
    ds_read_b128 v[72:75], v14 offset:30720
    ds_read_b128 v[76:79], v14 offset:31744
    v_exp_f32 v214, v214
    v_exp_f32 v215, v215
    buffer_load_dwordx4 a[236:239], v3, s[8:11], s81 offen offset:3072 sc1
    v_exp_f32 v216, v216
    v_exp_f32 v217, v217
    v_exp_f32 v218, v218
    v_exp_f32 v219, v219
    v_exp_f32 v220, v220
    v_exp_f32 v221, v221
    v_exp_f32 v222, v222
    v_exp_f32 v223, v223
    v_cvt_pk_bf16_f32 v208, v208, v209
    v_cvt_pk_bf16_f32 v209, v210, v211
    v_cvt_pk_bf16_f32 v210, v212, v213
    v_cvt_pk_bf16_f32 v211, v214, v215
    v_cvt_pk_bf16_f32 v212, v216, v217
    v_cvt_pk_bf16_f32 v213, v218, v219
    v_cvt_pk_bf16_f32 v214, v220, v221
    s_add_u32 s81, s81, 4096
    buffer_load_dwordx4 a[240:243], v3, s[8:11], s81 offen offset:0 sc1
    v_cvt_pk_bf16_f32 v215, v222, v223
    v_pk_add_f32 v[224:225], v[224:225], v[58:59] op_sel_hi:[1,0]
    v_pk_add_f32 v[226:227], v[226:227], v[58:59] op_sel_hi:[1,0]
    v_pk_add_f32 v[228:229], v[228:229], v[58:59] op_sel_hi:[1,0]
    v_pk_add_f32 v[230:231], v[230:231], v[58:59] op_sel_hi:[1,0]
    v_pk_add_f32 v[232:233], v[232:233], v[58:59] op_sel_hi:[1,0]
    v_pk_add_f32 v[234:235], v[234:235], v[58:59] op_sel_hi:[1,0]
    v_pk_add_f32 v[236:237], v[236:237], v[58:59] op_sel_hi:[1,0]
    v_pk_add_f32 v[238:239], v[238:239], v[58:59] op_sel_hi:[1,0]
    v_exp_f32 v224, v224
    v_exp_f32 v225, v225
    s_waitcnt lgkmcnt(4)
    v_mfma_f32_32x32x16_bf16 v[96:111], v[80:83], v[208:211], v[96:111]
    v_exp_f32 v226, v226
    v_exp_f32 v227, v227
    v_exp_f32 v228, v228
    v_exp_f32_e64 v229, v229
    buffer_load_dwordx4 a[244:247], v3, s[8:11], s81 offen offset:1024 sc1
    v_mfma_f32_32x32x16_bf16 v[96:111], v[84:87], v[212:215], v[96:111]
    v_exp_f32 v230, v230
    v_exp_f32 v231, v231
    v_exp_f32 v232, v232
    v_exp_f32 v233, v233
    v_exp_f32 v234, v234
    v_exp_f32 v235, v235
    v_exp_f32 v236, v236
    v_exp_f32 v237, v237
    v_exp_f32 v238, v238
    v_exp_f32 v239, v239
    v_cvt_pk_bf16_f32 v224, v224, v225
    buffer_load_dwordx4 a[248:251], v3, s[8:11], s81 offen offset:2048 sc1
    v_cvt_pk_bf16_f32 v225, v226, v227
    v_cvt_pk_bf16_f32 v226, v228, v229
    v_cvt_pk_bf16_f32 v227, v230, v231
    v_cvt_pk_bf16_f32 v228, v232, v233
    v_cvt_pk_bf16_f32 v229, v234, v235
    v_cvt_pk_bf16_f32 v230, v236, v237
    v_cvt_pk_bf16_f32 v231, v238, v239
    v_pk_add_f32 v[240:241], v[240:241], v[58:59] op_sel_hi:[1,0]
    v_pk_add_f32 v[242:243], v[242:243], v[58:59] op_sel_hi:[1,0]
    v_pk_add_f32 v[244:245], v[244:245], v[58:59] op_sel_hi:[1,0]
    v_pk_add_f32 v[246:247], v[246:247], v[58:59] op_sel_hi:[1,0]
    v_pk_add_f32 v[248:249], v[248:249], v[58:59] op_sel_hi:[1,0]
    v_pk_add_f32 v[250:251], v[250:251], v[58:59] op_sel_hi:[1,0]
    v_pk_add_f32 v[252:253], v[252:253], v[58:59] op_sel_hi:[1,0]
    v_pk_add_f32 v[254:255], v[254:255], v[58:59] op_sel_hi:[1,0]
    v_exp_f32 v240, v240
    v_exp_f32 v241, v241
    s_waitcnt lgkmcnt(2)
    v_mfma_f32_32x32x16_bf16 v[96:111], v[64:67], v[224:227], v[96:111]
    v_exp_f32 v242, v242
    buffer_load_dwordx4 a[252:255], v3, s[8:11], s81 offen offset:3072 sc1
    v_exp_f32 v243, v243
    v_exp_f32 v244, v244
    v_exp_f32 v245, v245
    v_mfma_f32_32x32x16_bf16 v[96:111], v[68:71], v[228:231], v[96:111]
    v_exp_f32 v246, v246
    v_exp_f32 v247, v247
    v_exp_f32 v248, v248
    v_exp_f32 v249, v249
    v_exp_f32 v250, v250
    v_exp_f32 v251, v251
    v_exp_f32 v252, v252
    v_exp_f32 v253, v253
    buffer_load_dwordx4 v3, s[8:11], s80 offen offset:1024 sc1 lds
    v_exp_f32 v254, v254
    v_exp_f32_e64 v255, v255
    v_cvt_pk_bf16_f32 v240, v240, v241
    v_cvt_pk_bf16_f32 v241, v242, v243
    v_cvt_pk_bf16_f32 v242, v244, v245
    v_cvt_pk_bf16_f32 v243, v246, v247
    v_cvt_pk_bf16_f32 v244, v248, v249
    v_cvt_pk_bf16_f32 v245, v250, v251
    v_cvt_pk_bf16_f32 v246, v252, v253
    v_cvt_pk_bf16_f32 v247, v254, v255
    s_waitcnt lgkmcnt(0)
    v_mfma_f32_32x32x16_bf16 v[96:111], v[72:75], v[240:243], v[96:111]
    v_mfma_f32_32x32x16_bf16 v[96:111], v[76:79], v[244:247], v[96:111]
    s_nop 11
    v_mov_b32 v58, v108
    v_mov_b32 v60, v108
    s_add_u32 s65, s57, 8388608
    s_nop 0
    v_permlane32_swap_b32 v58, v60
    v_rcp_f32 v60, v60
    s_nop 0
    v_pk_mul_f32 v[96:97], v[96:97], v[60:61] op_sel_hi:[1,0]
    v_pk_mul_f32 v[98:99], v[98:99], v[60:61] op_sel_hi:[1,0]
    v_pk_mul_f32 v[100:101], v[100:101], v[60:61] op_sel_hi:[1,0]
    v_pk_mul_f32 v[102:103], v[102:103], v[60:61] op_sel_hi:[1,0]
    v_pk_mul_f32 v[104:105], v[104:105], v[60:61] op_sel_hi:[1,0]
    v_pk_mul_f32 v[106:107], v[106:107], v[60:61] op_sel_hi:[1,0]
    v_pk_mul_f32 v[108:109], v[108:109], v[60:61] op_sel_hi:[1,0]
    v_pk_mul_f32 v[110:111], v[110:111], v[60:61] op_sel_hi:[1,0]
    v_cvt_pk_bf16_f32 v96, v96, v97
    v_cvt_pk_bf16_f32 v97, v98, v99
    v_cvt_pk_bf16_f32 v98, v100, v101
    v_cvt_pk_bf16_f32 v99, v102, v103
    v_cvt_pk_bf16_f32 v100, v104, v105
    v_cvt_pk_bf16_f32 v101, v106, v107
    v_cvt_pk_bf16_f32 v102, v108, v109
    v_cvt_pk_bf16_f32 v103, v110, v111
    s_cmp_eq_u32 s53, 0
    s_cbranch_scc1 Lslow_64
    buffer_store_dwordx4 v[96:99], v1, s[8:11], s65 offen offset:0
    buffer_store_dwordx4 v[100:103], v1, s[8:11], s65 offen offset:1024
Ldone_65:
Lpf_66:
    s_add_u32 s6, s70, Lpf_66-Lstart+1024
    s_min_u32 s6, s6, Lcode_end-Lstart-4
    s_load_dword s72, s[44:45], s6
    s_add_u32 s65, s58, 8388608
    s_add_u32 s66, s65, 4096
    s_mov_b32 s55, 0
Lop_67:
    s_nop 0
    buffer_load_dwordx4 v[144:147], v1, s[8:11], s65 offen offset:0 sc1
    buffer_load_dwordx4 v[148:151], v1, s[8:11], s65 offen offset:1024 sc1
    buffer_load_dwordx4 v[152:155], v1, s[8:11], s65 offen offset:2048 sc1
    buffer_load_dwordx4 v[156:159], v1, s[8:11], s65 offen offset:3072 sc1
    buffer_load_dwordx4 v[160:163], v1, s[8:11], s66 offen offset:0 sc1
    buffer_load_dwordx4 v[164:167], v1, s[8:11], s66 offen offset:1024 sc1
    buffer_load_dwordx4 v[168:171], v1, s[8:11], s66 offen offset:2048 sc1
    buffer_load_dwordx4 v[172:175], v1, s[8:11], s66 offen offset:3072 sc1
    s_add_u32 s55, s55, 1
    s_cmp_ge_u32 s55, 200000
    s_cselect_b32 s88, 64, 0
    s_or_b32 s79, s79, s88
    s_waitcnt vmcnt(6)
    v_max3_u32 v62, v144, v145, v146
    v_max_u32_e64 v62, v147, v62
    v_max3_u32 v62, v148, v149, v62
    v_max3_u32 v62, v150, v151, v62
    s_waitcnt vmcnt(4)
    s_nop 0
    v_max3_u32 v62, v152, v153, v62
    v_max3_u32 v62, v154, v155, v62
    v_max3_u32 v62, v156, v157, v62
    v_max3_u32 v62, v158, v159, v62
    s_waitcnt vmcnt(2)
    s_nop 0
    v_max3_u32 v62, v160, v161, v62
    v_max3_u32 v62, v162, v163, v62
    v_max3_u32 v62, v164, v165, v62
    v_max3_u32 v62, v166, v167, v62
    s_waitcnt vmcnt(0)
    s_nop 0
    v_max3_u32 v62, v168, v169, v62
    v_max3_u32 v62, v170, v171, v62
    v_max3_u32 v62, v172, v173, v62
    v_max3_u32 v62, v174, v175, v62
    v_cmp_eq_u32 vcc, -1, v62
    s_nop 0
    s_cmp_eq_u64 vcc, 0
    s_cselect_b32 s89, 1, s88
    s_cmp_eq_u32 s89, 0
    s_cbranch_scc1 Lop_67
    ds_write_b128 v23, v[144:147] offset:0
    v_mfma_f32_32x32x16_bf16 v[32:47], a[128:131], v[144:147], v[32:47]
    ds_write_b128 v23, v[148:151] offset:1024
    v_mfma_f32_32x32x16_bf16 v[32:47], a[132:135], v[148:151], v[32:47]
    ds_write_b128 v23, v[152:155] offset:2048
    v_mfma_f32_32x32x16_bf16 v[32:47], a[136:139], v[152:155], v[32:47]
    ds_write_b128 v23, v[156:159] offset:3072
    v_mfma_f32_32x32x16_bf16 v[32:47], a[140:143], v[156:159], v[32:47]
    ds_write_b128 v23, v[160:163] offset:4096
    v_mfma_f32_32x32x16_bf16 v[32:47], a[144:147], v[160:163], v[32:47]
    ds_write_b128 v23, v[164:167] offset:5120
    v_mfma_f32_32x32x16_bf16 v[32:47], a[148:151], v[164:167], v[32:47]
    ds_write_b128 v23, v[168:171] offset:6144
    ds_write_b128 v23, v[172:175] offset:7168
    s_waitcnt lgkmcnt(0)
    s_barrier
    ds_read_b128 v[64:67], v16 offset:0
    ds_read_b128 v[68:71], v16 offset:1024
    ds_read_b128 v[72:75], v16 offset:2048
    ds_read_b128 v[76:79], v16 offset:3072
    v_mfma_f32_32x32x16_bf16 v[32:47], a[152:155], v[168:171], v[32:47]
    v_mfma_f32_32x32x16_bf16 v[32:47], a[156:159], v[172:175], v[32:47]
    ds_read_b128 v[80:83], v16 offset:4096
    ds_read_b128 v[84:87], v16 offset:5120
    ds_read_b128 v[88:91], v16 offset:6144
    ds_read_b128 v[92:95], v16 offset:7168
    s_add_u32 m0, s46, 4096
    s_add_u32 s80, s46, s78
    s_add_u32 s80, s80, 26218496
    buffer_load_dwordx4 v3, s[8:11], s80 offen offset:2048 sc1 lds
    s_add_u32 m0, s47, 0
    s_add_u32 s80, s47, s78
    s_add_u32 s80, s80, 26214400
    buffer_load_dwordx4 v3, s[8:11], s80 offen offset:0 sc1 lds
    buffer_load_dwordx4 v3, s[8:11], s80 offen offset:1024 sc1 lds
    s_waitcnt lgkmcnt(7)
    v_mfma_f32_32x32x16_bf16 v[32:47], a[160:163], v[64:67], v[32:47]
    buffer_load_dwordx4 v3, s[8:11], s80 offen offset:2048 sc1 lds
    ds_read_b128 v[176:179], v17 offset:0
    s_waitcnt lgkmcnt(7)
    v_mfma_f32_32x32x16_bf16 v[32:47], a[164:167], v[68:71], v[32:47]
    ds_read_b128 v[180:183], v17 offset:1024
    s_waitcnt lgkmcnt(7)
    v_mfma_f32_32x32x16_bf16 v[32:47], a[168:171], v[72:75], v[32:47]
    ds_read_b128 v[184:187], v17 offset:2048
    s_waitcnt lgkmcnt(7)
    v_mfma_f32_32x32x16_bf16 v[32:47], a[172:175], v[76:79], v[32:47]
    buffer_load_dwordx4 v3, s[8:11], s80 offen offset:3072 sc1 lds
    ds_read_b128 v[188:191], v17 offset:3072
    s_waitcnt lgkmcnt(7)
    v_mfma_f32_32x32x16_bf16 v[32:47], a[176:179], v[80:83], v[32:47]
    ds_read_b128 v[192:195], v17 offset:4096
    s_waitcnt lgkmcnt(7)
    v_mfma_f32_32x32x16_bf16 v[32:47], a[180:183], v[84:87], v[32:47]
    ds_read_b128 v[196:199], v17 offset:5120
    s_waitcnt lgkmcnt(7)
    v_mfma_f32_32x32x16_bf16 v[32:47], a[184:187], v[88:91], v[32:47]
    s_add_u32 m0, s47, 4096
    s_add_u32 s80, s47, s78
    s_add_u32 s80, s80, 26218496
    buffer_load_dwordx4 v3, s[8:11], s80 offen offset:0 sc1 lds
    ds_read_b128 v[200:203], v17 offset:6144
    s_waitcnt lgkmcnt(7)
    v_mfma_f32_32x32x16_bf16 v[32:47], a[188:191], v[92:95], v[32:47]
    ds_read_b128 v[204:207], v17 offset:7168
    s_waitcnt lgkmcnt(7)
    v_mfma_f32_32x32x16_bf16 v[32:47], a[192:195], v[176:179], v[32:47]
    ds_read_b128 v[208:211], v18 offset:0
    s_waitcnt lgkmcnt(7)
    v_mfma_f32_32x32x16_bf16 v[32:47], a[196:199], v[180:183], v[32:47]
    ds_read_b128 v[212:215], v18 offset:1024
    s_waitcnt lgkmcnt(7)
    v_mfma_f32_32x32x16_bf16 v[32:47], a[200:203], v[184:187], v[32:47]
    buffer_load_dwordx4 v3, s[8:11], s80 offen offset:1024 sc1 lds
    ds_read_b128 v[216:219], v18 offset:2048
    s_waitcnt lgkmcnt(7)
    v_mfma_f32_32x32x16_bf16 v[32:47], a[204:207], v[188:191], v[32:47]
    ds_read_b128 v[220:223], v18 offset:3072
    s_waitcnt lgkmcnt(7)
    v_mfma_f32_32x32x16_bf16 v[32:47], a[208:211], v[192:195], v[32:47]
    ds_read_b128 v[224:227], v18 offset:4096
    s_waitcnt lgkmcnt(7)
    v_mfma_f32_32x32x16_bf16 v[32:47], a[212:215], v[196:199], v[32:47]
    buffer_load_dwordx4 v3, s[8:11], s80 offen offset:2048 sc1 lds
    ds_read_b128 v[228:231], v18 offset:5120
    s_waitcnt lgkmcnt(7)
    v_mfma_f32_32x32x16_bf16 v[32:47], a[216:219], v[200:203], v[32:47]
    ds_read_b128 v[232:235], v18 offset:6144
    s_waitcnt lgkmcnt(7)
    v_mfma_f32_32x32x16_bf16 v[32:47], a[220:223], v[204:207], v[32:47]
    ds_read_b128 v[236:239], v18 offset:7168
    s_waitcnt lgkmcnt(7)
    v_mfma_f32_32x32x16_bf16 v[32:47], a[224:227], v[208:211], v[32:47]
    s_waitcnt lgkmcnt(6)
    v_mfma_f32_32x32x16_bf16 v[32:47], a[228:231], v[212:215], v[32:47]
    s_waitcnt lgkmcnt(5)
    v_mfma_f32_32x32x16_bf16 v[32:47], a[232:235], v[216:219], v[32:47]
    s_waitcnt lgkmcnt(4)
    v_mfma_f32_32x32x16_bf16 v[32:47], a[236:239], v[220:223], v[32:47]
    s_waitcnt lgkmcnt(3)
    v_mfma_f32_32x32x16_bf16 v[32:47], a[240:243], v[224:227], v[32:47]
    s_waitcnt lgkmcnt(2)
    v_mfma_f32_32x32x16_bf16 v[32:47], a[244:247], v[228:231], v[32:47]
    s_waitcnt lgkmcnt(1)
    v_mfma_f32_32x32x16_bf16 v[32:47], a[248:251], v[232:235], v[32:47]
    s_waitcnt lgkmcnt(0)
    v_mfma_f32_32x32x16_bf16 v[32:47], a[252:255], v[236:239], v[32:47]
    s_add_u32 s65, s59, 2097152
    v_mov_b32 v122, 0x3f803f80
    v_mov_b32_e64 v120, 0
    v_mov_b32 v121, 0
    s_nop 7
    v_cvt_pk_bf16_f32 v112, v32, v33
    v_cvt_pk_bf16_f32 v113, v34, v35
    v_cvt_pk_bf16_f32 v114, v36, v37
    v_cvt_pk_bf16_f32 v115, v38, v39
    v_cvt_pk_bf16_f32 v116, v40, v41
    v_cvt_pk_bf16_f32 v117, v42, v43
    v_cvt_pk_bf16_f32 v118, v44, v45
    v_cvt_pk_bf16_f32 v119, v46, v47
    s_cmp_eq_u32 s53, 0
    s_cbranch_scc1 Lslow_68
    buffer_store_dwordx2 v[112:113], v7, s[8:11], s65 offen offset:0
    buffer_store_dwordx2 v[114:115], v7, s[8:11], s65 offen offset:512
    buffer_store_dwordx2 v[116:117], v7, s[8:11], s65 offen offset:1024
    s_mov_b32 exec_hi, 0
    buffer_store_dwordx2 v[118:119], v7, s[8:11], s65 offen offset:1536
    s_mov_b32 exec_hi, -1
Ldone_69:
    v_dot2_f32_bf16 v120, v112, v122, v120
    v_dot2_f32_bf16 v121, v112, v112, v121
    v_dot2_f32_bf16 v120, v113, v122, v120
    v_dot2_f32_bf16 v121, v113, v113, v121
    v_dot2_f32_bf16 v120, v114, v122, v120
    v_dot2_f32_bf16 v121, v114, v114, v121
    v_dot2_f32_bf16 v120, v115, v122, v120
    v_dot2_f32_bf16 v121, v115, v115, v121
    v_dot2_f32_bf16 v120, v116, v122, v120
    v_dot2_f32_bf16 v121, v116, v116, v121
    v_dot2_f32_bf16 v120, v117, v122, v120
    v_dot2_f32_bf16 v121, v117, v117, v121
    v_dot2_f32_bf16 v120, v118, v122, v120
    v_dot2_f32_bf16 v121, v118, v118, v121
    v_dot2_f32_bf16 v120, v119, v122, v120
    v_dot2_f32_bf16 v121, v119, v119, v121
    s_lshl_b32 s66, s50, 9
    s_add_u32 s66, s66, 119808
    v_lshl_add_u32 v124, v0, 3, s66
    ds_write_b64 v124, v[120:121]
    v_lshlrev_b32 v32, 16, v112
    v_and_b32 v33, 0xffff0000, v112
    v_lshlrev_b32 v34, 16, v113
    v_and_b32 v35, 0xffff0000, v113
    v_lshlrev_b32 v36, 16, v114
    v_and_b32 v37, 0xffff0000, v114
    v_lshlrev_b32 v38, 16, v115
    v_and_b32 v39, 0xffff0000, v115
    v_lshlrev_b32 v40, 16, v116
    v_and_b32 v41, 0xffff0000, v116
    v_lshlrev_b32 v42, 16, v117
    v_and_b32 v43, 0xffff0000, v117
    v_lshlrev_b32 v44, 16, v118
    v_and_b32 v45, 0xffff0000, v118
    v_lshlrev_b32_e64 v46, 16, v119
    v_and_b32 v47, 0xffff0000, v119
    s_add_u32 s65, s56, 2097152
    v_mov_b32_e64 v60, 0
    v_mov_b32 v61, 0
    s_mov_b32 s55, 0
    s_waitcnt vmcnt(4) lgkmcnt(0)
    s_barrier
    s_cmp_lg_u32 s50, 0
    s_cbranch_scc1 Lst_70
    ds_read_b64 v[126:127], v124 offset:512
    ds_read_b64 v[128:129], v124 offset:1024
    ds_read_b64 v[130:131], v124 offset:1536
    s_add_u32 s66, s59, 2097152
    s_waitcnt lgkmcnt(0)
    v_pk_add_f32 v[120:121], v[120:121], v[126:127]
    v_pk_add_f32 v[128:129], v[128:129], v[130:131]
    v_pk_add_f32 v[120:121], v[120:121], v[128:129]
    v_mov_b32 v124, v120
    v_mov_b32 v125, v121
    s_nop 0
    v_permlane32_swap_b32 v120, v124
    v_permlane32_swap_b32 v121, v125
    v_pk_add_f32 v[120:121], v[120:121], v[124:125]
    v_min_u32 v120, -2, v120
    v_min_u32 v121, -2, v121
    s_cmp_eq_u32 s53, 0
    s_cbranch_scc1 Lslow_71
    s_mov_b32 exec_hi, 0
    buffer_store_dwordx2 v[120:121], v8, s[8:11], s66 offen offset:0
    s_mov_b32 exec_hi, -1
Ldone_72:
Lst_70:
Lpf_73:
    s_add_u32 s6, s70, Lpf_73-Lstart+1024
    s_min_u32 s6, s6, Lcode_end-Lstart-4
    s_load_dword s72, s[44:45], s6
Lg_74:
    s_mov_b64 exec, 65535
    buffer_load_dwordx2 v[60:61], v9, s[8:11], s65 offen offset:0 sc1
    s_mov_b64 exec, -1
    s_nop 0
    buffer_load_dwordx4 v[144:147], v1, s[8:11], s65 offen offset:0 sc1
    buffer_load_dwordx4 v[148:151], v1, s[8:11], s65 offen offset:1024 sc1
    buffer_load_dwordx4 v[152:155], v1, s[8:11], s65 offen offset:2048 sc1
    buffer_load_dwordx4 v[156:159], v1, s[8:11], s65 offen offset:3072 sc1
    s_add_u32 s55, s55, 1
    s_cmp_ge_u32 s55, 200000
    s_cselect_b32 s88, 256, 0
    s_or_b32 s79, s79, s88
    s_waitcnt vmcnt(4)
    v_max_u32 v62, v60, v61
    v_cmp_eq_u32 vcc, -1, v62
    s_nop 0
    s_cmp_eq_u64 vcc, 0
    s_cselect_b32 s89, 1, s88
    s_cmp_eq_u32 s89, 0
    s_cbranch_scc1 Lg_74
    s_add_u32 s69, s65, 4096
    buffer_load_dwordx4 v[160:163], v1, s[8:11], s69 offen offset:0 sc1
    buffer_load_dwordx4 v[164:167], v1, s[8:11], s69 offen offset:1024 sc1
    buffer_load_dwordx4 v[168:171], v1, s[8:11], s69 offen offset:2048 sc1
    buffer_load_dwordx4 v[172:175], v1, s[8:11], s69 offen offset:3072 sc1
    s_add_u32 s69, s65, 8192
    buffer_load_dwordx4 v[176:179], v1, s[8:11], s69 offen offset:0 sc1
    buffer_load_dwordx4 v[180:183], v1, s[8:11], s69 offen offset:1024 sc1
    ds_read_b128 v[112:115], v1 offset:0
    ds_read_b128 v[116:119], v1 offset:28672
    ds_read_b128 v[120:123], v1 offset:1024
    ds_read_b128 v[124:127], v1 offset:29696
    ds_read_b128 v[128:131], v1 offset:2048
    ds_read_b128 v[132:135], v1 offset:30720
    s_waitcnt vmcnt(6)
    s_nop 0
    v_max3_u32 v62, v144, v145, v146
    v_max3_u32 v62, v147, v148, v62
    v_max3_u32 v62, v149, v150, v62
    v_max3_u32 v62, v151, v152, v62
    v_max3_u32 v62, v153, v154, v62
    v_max3_u32 v62, v155, v156, v62
    v_max3_u32 v62, v157, v158, v62
    v_max_u32_e64 v62, v159, v62
    v_cmp_eq_u32 vcc, -1, v62
    s_nop 0
    s_cmp_eq_u64 vcc, 0
    s_cselect_b32 s89, 1, s88
    s_cmp_eq_u32 s89, 0
    s_cbranch_scc1 Lg_74
    v_mov_b32 v63, 0
    s_waitcnt lgkmcnt(4)
    v_mfma_f32_32x32x16_bf16 v[64:79], v[112:115], v[144:147], 0
    v_mfma_f32_32x32x16_bf16 v[80:95], v[144:147], v[116:119], 0
    ds_read_b128 v[136:139], v1 offset:3072
    ds_read_b128 v[140:143], v1 offset:31744
    buffer_load_dwordx4 v[184:187], v1, s[8:11], s69 offen offset:2048 sc1
    buffer_load_dwordx4 v[188:191], v1, s[8:11], s69 offen offset:3072 sc1
    s_waitcnt lgkmcnt(4)
    s_nop 0
    v_mfma_f32_32x32x16_bf16 v[64:79], v[120:123], v[148:151], v[64:79]
    v_mfma_f32_32x32x16_bf16 v[80:95], v[148:151], v[124:127], v[80:95]
    ds_read_b128 v[112:115], v1 offset:4096
    ds_read_b128 v[116:119], v1 offset:32768
    s_add_u32 s69, s65, 12288
    buffer_load_dwordx4 v[192:195], v1, s[8:11], s69 offen offset:0 sc1
    buffer_load_dwordx4 v[196:199], v1, s[8:11], s69 offen offset:1024 sc1
    s_waitcnt lgkmcnt(4)
    s_nop 0
    v_mfma_f32_32x32x16_bf16 v[64:79], v[128:131], v[152:155], v[64:79]
    v_mfma_f32_32x32x16_bf16 v[80:95], v[152:155], v[132:135], v[80:95]
    ds_read_b128 v[120:123], v1 offset:5120
    ds_read_b128 v[124:127], v1 offset:33792
    buffer_load_dwordx4 v[200:203], v1, s[8:11], s69 offen offset:2048 sc1
    buffer_load_dwordx4 v[204:207], v1, s[8:11], s69 offen offset:3072 sc1
    s_waitcnt lgkmcnt(4)
    s_nop 0
    v_mfma_f32_32x32x16_bf16 v[64:79], v[136:139], v[156:159], v[64:79]
    v_mfma_f32_32x32x16_bf16 v[80:95], v[156:159], v[140:143], v[80:95]
    ds_read_b128 v[128:131], v1 offset:6144
    ds_read_b128 v[132:135], v1 offset:34816
    s_add_u32 s69, s65, 16384
    buffer_load_dwordx4 v[208:211], v1, s[8:11], s69 offen offset:0 sc1
    s_add_u32 s69, s65, 28672
    buffer_load_dwordx4 v[96:99], v1, s[8:11], s69 offen offset:0 sc1
    s_waitcnt vmcnt(13)
    s_waitcnt lgkmcnt(4)
    v_mfma_f32_32x32x16_bf16 v[64:79], v[112:115], v[160:163], v[64:79]
    v_max3_u32 v63, v160, v161, v63
    v_max3_u32 v63, v162, v163, v63
    v_mfma_f32_32x32x16_bf16 v[80:95], v[160:163], v[116:119], v[80:95]
    ds_read_b128 v[136:139], v1 offset:7168
    ds_read_b128 v[140:143], v1 offset:35840
    s_add_u32 s69, s65, 16384
    buffer_load_dwordx4 v[212:215], v1, s[8:11], s69 offen offset:1024 sc1
    buffer_load_dwordx4 v[216:219], v1, s[8:11], s69 offen offset:2048 sc1
    s_waitcnt vmcnt(14)
    s_waitcnt lgkmcnt(4)
    v_mfma_f32_32x32x16_bf16 v[64:79], v[120:123], v[164:167], v[64:79]
    v_max3_u32 v63, v164, v165, v63
    v_max3_u32 v63, v166, v167, v63
    v_mfma_f32_32x32x16_bf16 v[80:95], v[164:167], v[124:127], v[80:95]
    ds_read_b128 v[112:115], v1 offset:8192
    ds_read_b128 v[116:119], v1 offset:36864
    buffer_load_dwordx4 v[220:223], v1, s[8:11], s69 offen offset:3072 sc1
    s_add_u32 s69, s65, 20480
    buffer_load_dwordx4 v[224:227], v1, s[8:11], s69 offen offset:0 sc1
    s_waitcnt vmcnt(15)
    s_waitcnt lgkmcnt(4)
    v_mfma_f32_32x32x16_bf16 v[64:79], v[128:131], v[168:171], v[64:79]
    v_max3_u32 v63, v168, v169, v63
    v_max3_u32 v63, v170, v171, v63
    v_mfma_f32_32x32x16_bf16 v[80:95], v[168:171], v[132:135], v[80:95]
    ds_read_b128 v[120:123], v1 offset:9216
    ds_read_b128 v[124:127], v1 offset:37888
    buffer_load_dwordx4 v[228:231], v1, s[8:11], s69 offen offset:1024 sc1
    buffer_load_dwordx4 v[232:235], v1, s[8:11], s69 offen offset:2048 sc1
    s_waitcnt vmcnt(16)
    s_waitcnt lgkmcnt(4)
    v_mfma_f32_32x32x16_bf16 v[64:79], v[136:139], v[172:175], v[64:79]
    v_max3_u32 v63, v172, v173, v63
    v_max3_u32 v63, v174, v175, v63
    v_mfma_f32_32x32x16_bf16 v[80:95], v[172:175], v[140:143], v[80:95]
    ds_read_b128 v[128:131], v1 offset:10240
    ds_read_b128 v[132:135], v1 offset:38912
    buffer_load_dwordx4 v[236:239], v1, s[8:11], s69 offen offset:3072 sc1
    s_add_u32 s69, s65, 24576
    buffer_load_dwordx4 v[240:243], v1, s[8:11], s69 offen offset:0 sc1
    s_waitcnt vmcnt(17)
    s_waitcnt lgkmcnt(4)
    v_mfma_f32_32x32x16_bf16 v[64:79], v[112:115], v[176:179], v[64:79]
    v_max3_u32 v63, v176, v177, v63
    v_max3_u32 v63, v178, v179, v63
    v_mfma_f32_32x32x16_bf16 v[80:95], v[176:179], v[116:119], v[80:95]
    ds_read_b128 v[136:139], v1 offset:11264
    ds_read_b128 v[140:143], v1 offset:39936
    buffer_load_dwordx4 v[244:247], v1, s[8:11], s69 offen offset:1024 sc1
    s_waitcnt vmcnt(17)
    s_waitcnt lgkmcnt(4)
    v_mfma_f32_32x32x16_bf16 v[64:79], v[120:123], v[180:183], v[64:79]
    v_max3_u32 v63, v180, v181, v63
    v_max3_u32 v63, v182, v183, v63
    v_mfma_f32_32x32x16_bf16 v[80:95], v[180:183], v[124:127], v[80:95]
    ds_read_b128 v[112:115], v1 offset:12288
    ds_read_b128 v[116:119], v1 offset:40960
    buffer_load_dwordx4 v[248:251], v1, s[8:11], s69 offen offset:2048 sc1
    s_waitcnt vmcnt(17)
    s_waitcnt lgkmcnt(4)
    v_mfma_f32_32x32x16_bf16 v[64:79], v[128:131], v[184:187], v[64:79]
    v_max3_u32 v63, v184, v185, v63
    v_max3_u32 v63, v186, v187, v63
    v_mfma_f32_32x32x16_bf16 v[80:95], v[184:187], v[132:135], v[80:95]
    ds_read_b128 v[120:123], v1 offset:13312
    ds_read_b128 v[124:127], v1 offset:41984
    buffer_load_dwordx4 v[252:255], v1, s[8:11], s69 offen offset:3072 sc1
    s_waitcnt vmcnt(17)
    s_waitcnt lgkmcnt(4)
    v_mfma_f32_32x32x16_bf16 v[64:79], v[136:139], v[188:191], v[64:79]
    v_max3_u32 v63, v188, v189, v63
    v_max3_u32 v63, v190, v191, v63
    v_mfma_f32_32x32x16_bf16 v[80:95], v[188:191], v[140:143], v[80:95]
    ds_read_b128 v[128:131], v1 offset:14336
    ds_read_b128 v[132:135], v1 offset:43008
    s_waitcnt vmcnt(16)
    s_waitcnt lgkmcnt(4)
    v_mfma_f32_32x32x16_bf16 v[64:79], v[112:115], v[192:195], v[64:79]
    v_max3_u32 v63, v192, v193, v63
    v_max3_u32 v63, v194, v195, v63
    v_mfma_f32_32x32x16_bf16 v[80:95], v[192:195], v[116:119], v[80:95]
    ds_read_b128 v[136:139], v1 offset:15360
    ds_read_b128 v[140:143], v1 offset:44032
    s_waitcnt vmcnt(15)
    s_waitcnt lgkmcnt(4)
    v_mfma_f32_32x32x16_bf16 v[64:79], v[120:123], v[196:199], v[64:79]
    v_max3_u32 v63, v196, v197, v63
    v_max3_u32 v63, v198, v199, v63
    v_mfma_f32_32x32x16_bf16 v[80:95], v[196:199], v[124:127], v[80:95]
    ds_read_b128 v[112:115], v1 offset:16384
    ds_read_b128 v[116:119], v1 offset:45056
    s_waitcnt vmcnt(14)
    s_waitcnt lgkmcnt(4)
    v_mfma_f32_32x32x16_bf16 v[64:79], v[128:131], v[200:203], v[64:79]
    v_max3_u32 v63, v200, v201, v63
    v_max3_u32 v63, v202, v203, v63
    v_mfma_f32_32x32x16_bf16 v[80:95], v[200:203], v[132:135], v[80:95]
    ds_read_b128 v[120:123], v1 offset:17408
    ds_read_b128 v[124:127], v1 offset:46080
    s_waitcnt vmcnt(13)
    s_waitcnt lgkmcnt(4)
    v_mfma_f32_32x32x16_bf16 v[64:79], v[136:139], v[204:207], v[64:79]
    v_max3_u32 v63, v204, v205, v63
    v_max3_u32 v63, v206, v207, v63
    v_mfma_f32_32x32x16_bf16 v[80:95], v[204:207], v[140:143], v[80:95]
    ds_read_b128 v[128:131], v1 offset:18432
    ds_read_b128 v[132:135], v1 offset:47104
    s_waitcnt vmcnt(12)
    s_waitcnt lgkmcnt(4)
    v_mfma_f32_32x32x16_bf16 v[64:79], v[112:115], v[208:211], v[64:79]
    v_max3_u32 v63, v208, v209, v63
    v_max3_u32 v63, v210, v211, v63
    v_mfma_f32_32x32x16_bf16 v[80:95], v[208:211], v[116:119], v[80:95]
    ds_read_b128 v[136:139], v1 offset:19456
    ds_read_b128 v[140:143], v1 offset:48128
    s_waitcnt vmcnt(10)
    s_waitcnt lgkmcnt(4)
    v_mfma_f32_32x32x16_bf16 v[64:79], v[120:123], v[212:215], v[64:79]
    v_max3_u32 v63, v212, v213, v63
    v_max3_u32 v63, v214, v215, v63
    v_mfma_f32_32x32x16_bf16 v[80:95], v[212:215], v[124:127], v[80:95]
    ds_read_b128 v[112:115], v1 offset:20480
    ds_read_b128 v[116:119], v1 offset:49152
    v_max3_u32 v62, v96, v97, v98
    v_max_u32_e64 v62, v99, v62
    v_cmp_eq_u32 vcc, -1, v62
    s_nop 0
    s_cmp_eq_u64 vcc, 0
    s_cbranch_scc0 Lsr_76
Lsb_77:
    s_waitcnt vmcnt(9)
    s_waitcnt lgkmcnt(4)
    v_mfma_f32_32x32x16_bf16 v[64:79], v[128:131], v[216:219], v[64:79]
    v_max3_u32 v63, v216, v217, v63
    v_max3_u32 v63, v218, v219, v63
    v_pk_add_f32 v[60:61], v[96:97], v[98:99]
    v_mov_b32_e64 v58, v60
    v_mfma_f32_32x32x16_bf16 v[80:95], v[216:219], v[132:135], v[80:95]
    ds_read_b128 v[120:123], v1 offset:21504
    ds_read_b128 v[124:127], v1 offset:50176
    v_mov_b32 v59, v61
    v_permlane32_swap_b32 v60, v58
    s_nop 0
    v_permlane32_swap_b32 v61, v59
    s_waitcnt vmcnt(8)
    s_waitcnt lgkmcnt(4)
    v_mfma_f32_32x32x16_bf16 v[64:79], v[136:139], v[220:223], v[64:79]
    v_max3_u32 v63, v220, v221, v63
    v_max3_u32 v63, v222, v223, v63
    v_add_f32 v60, v60, v58
    v_add_f32 v61, v61, v59
    v_mfma_f32_32x32x16_bf16 v[80:95], v[220:223], v[140:143], v[80:95]
    ds_read_b128 v[128:131], v1 offset:22528
    ds_read_b128 v[132:135], v1 offset:51200
    v_mul_f32 v60, 0x3b124925, v60
    v_mul_f32 v61, 0x3b124925, v61
    v_fma_f32 v61, -v60, v60, v61
    s_waitcnt vmcnt(7)
    s_waitcnt lgkmcnt(4)
    v_mfma_f32_32x32x16_bf16 v[64:79], v[112:115], v[224:227], v[64:79]
    v_max3_u32 v63, v224, v225, v63
    v_max3_u32 v63, v226, v227, v63
    v_max_f32_e64 v61, 0, v61
    v_cvt_pk_bf16_f32 v54, v60, v60
    v_mfma_f32_32x32x16_bf16 v[80:95], v[224:227], v[116:119], v[80:95]
    ds_read_b128 v[136:139], v1 offset:23552
    ds_read_b128 v[140:143], v1 offset:52224
    v_cvt_pk_bf16_f32 v61, v61, v61
    v_and_b32 v61, 0xffff0000, v61
    v_add_f32 v61, 0x3727c5ac, v61
    v_cvt_pk_bf16_f32 v61, v61, v61
    v_and_b32 v61, 0xffff0000, v61
    s_waitcnt vmcnt(6)
    s_waitcnt lgkmcnt(4)
    v_mfma_f32_32x32x16_bf16 v[64:79], v[120:123], v[228:231], v[64:79]
    v_max3_u32 v63, v228, v229, v63
    v_max3_u32 v63, v230, v231, v63
    v_sqrt_f32 v61, v61
    s_nop 0
    v_cvt_pk_bf16_f32 v61, v61, v61
    v_and_b32 v61, 0xffff0000, v61
    v_mfma_f32_32x32x16_bf16 v[80:95], v[228:231], v[124:127], v[80:95]
    ds_read_b128 v[112:115], v1 offset:24576
    ds_read_b128 v[116:119], v1 offset:53248
    v_rcp_f32 v56, v61
    s_nop 0
    ds_write_b32 v12, v56
    v_mov_b32_e64 v96, v54
    s_waitcnt vmcnt(5)
    s_waitcnt lgkmcnt(5)
    v_mfma_f32_32x32x16_bf16 v[64:79], v[128:131], v[232:235], v[64:79]
    v_max3_u32 v63, v232, v233, v63
    v_max3_u32 v63, v234, v235, v63
    v_mov_b32 v100, v49
    v_mov_b32 v104, v50
    v_mfma_f32_32x32x16_bf16 v[80:95], v[232:235], v[132:135], v[80:95]
    ds_read_b128 v[120:123], v1 offset:25600
    ds_read_b128 v[124:127], v1 offset:54272
    v_mov_b32 v97, 0
    v_mov_b32 v101, 0
    v_mov_b32_e64 v105, 0
    s_waitcnt vmcnt(4)
    s_waitcnt lgkmcnt(5)
    v_mfma_f32_32x32x16_bf16 v[64:79], v[136:139], v[236:239], v[64:79]
    v_max3_u32 v63, v236, v237, v63
    v_max3_u32 v63, v238, v239, v63
    v_mov_b32 v98, 0
    v_mov_b32 v102, 0
    v_mfma_f32_32x32x16_bf16 v[80:95], v[236:239], v[140:143], v[80:95]
    ds_read_b128 v[128:131], v1 offset:26624
    ds_read_b128 v[132:135], v1 offset:55296
    v_mov_b32 v106, 0
    v_mov_b32 v99, 0
    v_mov_b32_e64 v103, 0
    s_waitcnt vmcnt(3)
    s_waitcnt lgkmcnt(5)
    v_mfma_f32_32x32x16_bf16 v[64:79], v[112:115], v[240:243], v[64:79]
    v_max3_u32 v63, v240, v241, v63
    v_max3_u32 v63, v242, v243, v63
    v_mov_b32_e64 v107, 0
    v_mfma_f32_32x32x16_bf16 v[80:95], v[240:243], v[116:119], v[80:95]
    ds_read_b128 v[136:139], v1 offset:27648
    ds_read_b128 v[140:143], v1 offset:56320
    s_waitcnt vmcnt(2)
    s_waitcnt lgkmcnt(4)
    v_mfma_f32_32x32x16_bf16 v[64:79], v[120:123], v[244:247], v[64:79]
    v_max3_u32 v63, v244, v245, v63
    v_max3_u32 v63, v246, v247, v63
    v_mfma_f32_32x32x16_bf16 v[80:95], v[244:247], v[124:127], v[80:95]
    v_mfma_f32_32x32x16_bf16 v[64:79], v[100:103], v[96:99], v[64:79]
    v_mfma_f32_32x32x16_bf16 v[80:95], v[96:99], v[104:107], v[80:95]
    ds_read_b128 v[96:99], v13 offset:0
    ds_read_b128 v[100:103], v13 offset:32
    ds_read_b128 v[104:107], v13 offset:64
    ds_read_b128 v[108:111], v13 offset:96
    s_waitcnt vmcnt(1)
    s_waitcnt lgkmcnt(6)
    v_mfma_f32_32x32x16_bf16 v[64:79], v[128:131], v[248:251], v[64:79]
    v_max3_u32 v63, v248, v249, v63
    v_max3_u32 v63, v250, v251, v63
    v_mfma_f32_32x32x16_bf16 v[80:95], v[248:251], v[132:135], v[80:95]
    s_waitcnt vmcnt(0)
    s_waitcnt lgkmcnt(4)
    v_mfma_f32_32x32x16_bf16 v[64:79], v[136:139], v[252:255], v[64:79]
    v_max3_u32 v63, v252, v253, v63
    v_max3_u32 v63, v254, v255, v63
    v_mfma_f32_32x32x16_bf16 v[80:95], v[252:255], v[140:143], v[80:95]
    v_cmp_eq_u32 vcc, -1, v63
    s_nop 0
    s_cmp_eq_u64 vcc, 0
    s_cbranch_scc0 Lgbad_78
Lgok_75:
    s_add_u32 m0, s76, 0
    s_add_u32 s80, s76, s78
    s_add_u32 s80, s80, 26214400
    buffer_load_dwordx4 v3, s[8:11], s80 offen offset:0 sc1 lds
    buffer_load_dwordx4 v3, s[8:11], s80 offen offset:1024 sc1 lds
    buffer_load_dwordx4 v3, s[8:11], s80 offen offset:2048 sc1 lds
    buffer_load_dwordx4 v3, s[8:11], s80 offen offset:3072 sc1 lds
    s_add_u32 m0, s77, 0
    s_add_u32 s80, s77, s78
    s_add_u32 s80, s80, 26214400
    buffer_load_dwordx4 v3, s[8:11], s80 offen offset:0 sc1 lds
    v_cvt_pk_bf16_f32 v64, v64, v65
    v_cvt_pk_bf16_f32 v65, v66, v67
    v_cvt_pk_bf16_f32 v66, v68, v69
    v_cvt_pk_bf16_f32 v67, v70, v71
    v_cvt_pk_bf16_f32 v68, v72, v73
    v_cvt_pk_bf16_f32 v69, v74, v75
    v_cvt_pk_bf16_f32 v70, v76, v77
    v_cvt_pk_bf16_f32 v71, v78, v79
    v_mfma_f32_32x32x16_bf16 v[112:127], v[24:27], v[64:67], 0
    s_nop 0
    v_mfma_f32_32x32x16_bf16 v[112:127], v[28:31], v[68:71], v[112:127]
    v_mov_b32 v72, -1
    v_mov_b32 v73, -1
    v_mov_b32 v74, -1
    v_mov_b32 v75, -1
    s_waitcnt lgkmcnt(0)
    v_pk_fma_f32 v[80:81], v[80:81], v[96:97], v[2:3] op_sel_hi:[1,1,0]
    v_pk_fma_f32 v[82:83], v[82:83], v[98:99], v[2:3] op_sel_hi:[1,1,0]
    v_pk_fma_f32 v[84:85], v[84:85], v[100:101], v[2:3] op_sel_hi:[1,1,0]
    v_pk_fma_f32 v[86:87], v[86:87], v[102:103], v[2:3] op_sel_hi:[1,1,0]
    v_pk_fma_f32 v[88:89], v[88:89], v[104:105], v[2:3] op_sel_hi:[1,1,0]
    v_pk_fma_f32 v[90:91], v[90:91], v[106:107], v[2:3] op_sel_hi:[1,1,0]
    v_pk_fma_f32 v[92:93], v[92:93], v[108:109], v[2:3] op_sel_hi:[1,1,0]
    v_pk_fma_f32 v[94:95], v[94:95], v[110:111], v[2:3] op_sel_hi:[1,1,0]
    v_cvt_pk_bf16_f32 v80, v80, v81
    v_cvt_pk_bf16_f32 v81, v82, v83
    v_cvt_pk_bf16_f32 v82, v84, v85
    v_cvt_pk_bf16_f32 v83, v86, v87
    v_cvt_pk_bf16_f32 v84, v88, v89
    v_cvt_pk_bf16_f32 v85, v90, v91
    v_cvt_pk_bf16_f32 v86, v92, v93
    v_cvt_pk_bf16_f32 v87, v94, v95
    ds_write_b128 v22, v[80:83]
    ds_write_b128 v22, v[84:87] offset:1024
    v_mul_f32 v57, 0x3fb8aa3b, v56
    v_max3_f32 v58, v112, v113, v114
    v_min3_f32 v60, v112, v113, v114
    v_max3_f32 v58, v115, v116, v58
    v_min3_f32 v60, v115, v116, v60
    v_max3_f32 v58, v117, v118, v58
    v_min3_f32 v60, v117, v118, v60
    v_max3_f32 v58, v119, v120, v58
    v_min3_f32 v60, v119, v120, v60
    v_max3_f32 v58, v121, v122, v58
    v_min3_f32 v60, v121, v122, v60
    v_max3_f32 v62, v124, v125, v126
    v_min3_f32 v63, v124, v125, v126
    v_max_f32 v62, v62, v127
    v_min_f32 v63, v63, v127
    v_sub_f32 v62, v62, v20
    v_add_f32 v63, v63, v20
    v_max3_f32 v58, v123, v62, v58
    v_min3_f32 v60, v123, v63, v60
    v_mov_b32 v62, v58
    v_mov_b32 v63, v60
    s_nop 0
    v_permlane32_swap_b32 v58, v62
    v_permlane32_swap_b32 v60, v63
    v_max_f32 v58, v58, v62
    v_min_f32 v60, v60, v63
    v_mul_f32 v58, v57, v58
    v_mul_f32 v60, v57, v60
    v_add_f32 v59, v58, v20
    v_sub_f32_e64 v61, v60, v20
    v_pk_fma_f32 v[128:129], v[112:113], v[56:57], v[60:61] op_sel:[0,1,0] op_sel_hi:[1,1,0] neg_lo:[1,0,0] neg_hi:[1,0,0]
    v_pk_fma_f32 v[112:113], v[112:113], v[56:57], v[58:59] op_sel:[0,1,0] op_sel_hi:[1,1,0] neg_lo:[0,0,1] neg_hi:[0,0,1]
    v_pk_fma_f32 v[130:131], v[114:115], v[56:57], v[60:61] op_sel:[0,1,0] op_sel_hi:[1,1,0] neg_lo:[1,0,0] neg_hi:[1,0,0]
    v_pk_fma_f32 v[114:115], v[114:115], v[56:57], v[58:59] op_sel:[0,1,0] op_sel_hi:[1,1,0] neg_lo:[0,0,1] neg_hi:[0,0,1]
    v_pk_fma_f32 v[132:133], v[116:117], v[56:57], v[60:61] op_sel:[0,1,0] op_sel_hi:[1,1,0] neg_lo:[1,0,0] neg_hi:[1,0,0]
    v_pk_fma_f32 v[116:117], v[116:117], v[56:57], v[58:59] op_sel:[0,1,0] op_sel_hi:[1,1,0] neg_lo:[0,0,1] neg_hi:[0,0,1]
    v_pk_fma_f32 v[134:135], v[118:119], v[56:57], v[60:61] op_sel:[0,1,0] op_sel_hi:[1,1,0] neg_lo:[1,0,0] neg_hi:[1,0,0]
    v_pk_fma_f32 v[118:119], v[118:119], v[56:57], v[58:59] op_sel:[0,1,0] op_sel_hi:[1,1,0] neg_lo:[0,0,1] neg_hi:[0,0,1]
    v_pk_fma_f32 v[136:137], v[120:121], v[56:57], v[60:61] op_sel:[0,1,0] op_sel_hi:[1,1,0] neg_lo:[1,0,0] neg_hi:[1,0,0]
    v_pk_fma_f32 v[120:121], v[120:121], v[56:57], v[58:59] op_sel:[0,1,0] op_sel_hi:[1,1,0] neg_lo:[0,0,1] neg_hi:[0,0,1]
    v_pk_fma_f32 v[138:139], v[122:123], v[56:57], v[60:61] op_sel:[0,1,0] op_sel_hi:[1,1,0] neg_lo:[1,0,0] neg_hi:[1,0,0]
    v_pk_fma_f32 v[122:123], v[122:123], v[56:57], v[58:59] op_sel:[0,1,0] op_sel_hi:[1,1,0] neg_lo:[0,0,1] neg_hi:[0,0,1]
    v_pk_fma_f32 v[140:141], v[124:125], v[56:57], v[60:61] op_sel:[0,1,1] op_sel_hi:[1,1,1] neg_lo:[1,0,0] neg_hi:[1,0,0]
    v_pk_fma_f32 v[124:125], v[124:125], v[56:57], v[58:59] op_sel:[0,1,1] op_sel_hi:[1,1,1] neg_lo:[0,0,1] neg_hi:[0,0,1]
    v_pk_fma_f32 v[142:143], v[126:127], v[56:57], v[60:61] op_sel:[0,1,1] op_sel_hi:[1,1,1] neg_lo:[1,0,0] neg_hi:[1,0,0]
    v_pk_fma_f32 v[126:127], v[126:127], v[56:57], v[58:59] op_sel:[0,1,1] op_sel_hi:[1,1,1] neg_lo:[0,0,1] neg_hi:[0,0,1]
    v_exp_f32 v128, v128
    v_exp_f32 v112, v112
    v_exp_f32 v129, v129
    v_exp_f32 v113, v113
    v_exp_f32 v130, v130
    v_exp_f32 v114, v114
    v_exp_f32 v131, v131
    buffer_load_dwordx4 v3, s[8:11], s80 offen offset:1024 sc1 lds
    v_exp_f32 v115, v115
    v_exp_f32 v132, v132
    v_exp_f32 v116, v116
    v_exp_f32 v133, v133
    v_exp_f32 v117, v117
    v_exp_f32 v134, v134
    v_exp_f32 v118, v118
    v_exp_f32 v135, v135
    v_exp_f32 v119, v119
    v_exp_f32 v136, v136
    v_exp_f32 v120, v120
    v_exp_f32 v137, v137
    buffer_load_dwordx4 v3, s[8:11], s80 offen offset:2048 sc1 lds
    v_exp_f32 v121, v121
    v_exp_f32 v138, v138
    v_exp_f32 v122, v122
    v_exp_f32 v139, v139
    v_exp_f32 v123, v123
    v_exp_f32 v140, v140
    v_exp_f32 v124, v124
    v_exp_f32 v141, v141
    v_exp_f32 v125, v125
    v_exp_f32 v142, v142
    v_exp_f32 v126, v126
    v_exp_f32 v143, v143
    buffer_load_dwordx4 v3, s[8:11], s80 offen offset:3072 sc1 lds
    v_exp_f32 v127, v127
    v_pk_add_f32 v[58:59], v[112:113], v[114:115]
    v_pk_add_f32 v[58:59], v[58:59], v[116:117]
    v_pk_add_f32 v[58:59], v[58:59], v[118:119]
    v_pk_add_f32 v[58:59], v[58:59], v[120:121]
    v_pk_add_f32 v[58:59], v[58:59], v[122:123]
    v_pk_add_f32 v[58:59], v[58:59], v[124:125]
    v_pk_add_f32 v[58:59], v[58:59], v[126:127]
    v_add_f32_e64 v58, v58, v59
    v_pk_add_f32 v[60:61], v[128:129], v[130:131]
    v_pk_add_f32 v[60:61], v[60:61], v[132:133]
    v_pk_add_f32 v[60:61], v[60:61], v[134:135]
    v_pk_add_f32 v[60:61], v[60:61], v[136:137]
    v_pk_add_f32 v[60:61], v[60:61], v[138:139]
    v_pk_add_f32 v[60:61], v[60:61], v[140:141]
    v_pk_add_f32 v[60:61], v[60:61], v[142:143]
    v_add_f32 v60, v60, v61
    v_mov_b32 v62, v58
    v_mov_b32 v63, v60
    s_nop 0
    v_permlane32_swap_b32 v58, v62
    v_permlane32_swap_b32 v60, v63
    v_add_f32_e64 v58, v58, v62
    s_add_u32 s75, s62, 20971520
    buffer_store_dwordx4 v[72:75], v1, s[8:11], s75 offen offset:0 sc1
    v_add_f32 v60, v60, v63
    v_rcp_f32 v58, v58
    v_rcp_f32_e64 v60, v60
    v_pk_mul_f32 v[112:113], v[112:113], v[58:59] op_sel_hi:[1,0]
    v_pk_mul_f32 v[114:115], v[114:115], v[58:59] op_sel_hi:[1,0]
    v_pk_mul_f32 v[116:117], v[116:117], v[58:59] op_sel_hi:[1,0]
    v_pk_mul_f32 v[118:119], v[118:119], v[58:59] op_sel_hi:[1,0]
    v_pk_mul_f32 v[120:121], v[120:121], v[58:59] op_sel_hi:[1,0]
    v_pk_mul_f32 v[122:123], v[122:123], v[58:59] op_sel_hi:[1,0]
    v_pk_mul_f32 v[124:125], v[124:125], v[58:59] op_sel_hi:[1,0]
    v_pk_mul_f32 v[126:127], v[126:127], v[58:59] op_sel_hi:[1,0]
    v_cvt_pk_bf16_f32 v112, v112, v113
    v_cvt_pk_bf16_f32 v113, v114, v115
    v_cvt_pk_bf16_f32 v114, v116, v117
    v_cvt_pk_bf16_f32 v115, v118, v119
    v_cvt_pk_bf16_f32 v116, v120, v121
    v_cvt_pk_bf16_f32 v117, v122, v123
    v_cvt_pk_bf16_f32 v118, v124, v125
    v_cvt_pk_bf16_f32 v119, v126, v127
    ds_write_b64 v10, v[112:113] offset:0
    ds_write_b64 v10, v[114:115] offset:16
    ds_write_b64 v10, v[116:117] offset:32
    ds_write_b64 v10, v[118:119] offset:48
    v_pk_mul_f32 v[128:129], v[128:129], v[60:61] op_sel_hi:[1,0]
    v_pk_mul_f32 v[130:131], v[130:131], v[60:61] op_sel_hi:[1,0]
    v_pk_mul_f32 v[132:133], v[132:133], v[60:61] op_sel_hi:[1,0]
    v_pk_mul_f32 v[134:135], v[134:135], v[60:61] op_sel_hi:[1,0]
    v_pk_mul_f32 v[136:137], v[136:137], v[60:61] op_sel_hi:[1,0]
    buffer_store_dwordx4 v[72:75], v1, s[8:11], s75 offen offset:1024 sc1
    v_pk_mul_f32 v[138:139], v[138:139], v[60:61] op_sel_hi:[1,0]
    v_pk_mul_f32 v[140:141], v[140:141], v[60:61] op_sel_hi:[1,0]
    v_pk_mul_f32 v[142:143], v[142:143], v[60:61] op_sel_hi:[1,0]
    v_cvt_pk_bf16_f32 v128, v128, v129
    v_cvt_pk_bf16_f32 v129, v130, v131
    v_cvt_pk_bf16_f32 v130, v132, v133
    v_cvt_pk_bf16_f32 v131, v134, v135
    v_cvt_pk_bf16_f32 v132, v136, v137
    v_cvt_pk_bf16_f32 v133, v138, v139
    v_cvt_pk_bf16_f32 v134, v140, v141
    v_cvt_pk_bf16_f32 v135, v142, v143
    ds_write_b64 v10, v[128:129] offset:8448
    ds_write_b64 v10, v[130:131] offset:8464
    ds_write_b64 v10, v[132:133] offset:8480
    ds_write_b64 v10, v[134:135] offset:8496
    buffer_store_dwordx4 v[72:75], v1, s[8:11], s75 offen offset:2048 sc1
    buffer_store_dwordx4 v[72:75], v1, s[8:11], s75 offen offset:3072 sc1
    s_waitcnt vmcnt(4)
    s_waitcnt lgkmcnt(0)
    s_barrier
    s_cmp_ge_u32 s50, 2
    s_cbranch_scc1 Lq_79
    s_nop 0
    v_add_u32 v55, 103424, v1
    ds_read_b64_tr_b16 v[112:113], v11 offset:0
    ds_read_b64_tr_b16 v[114:115], v11 offset:528
    ds_read_b128 v[64:67], v55 offset:0
    ds_read_b64_tr_b16 v[116:117], v11 offset:1056
    ds_read_b64_tr_b16 v[118:119], v11 offset:1584
    ds_read_b128 v[68:71], v55 offset:1024
    ds_read_b64_tr_b16 v[120:121], v11 offset:2112
    ds_read_b64_tr_b16 v[122:123], v11 offset:2640
    ds_read_b128 v[72:75], v55 offset:2048
    ds_read_b64_tr_b16 v[124:125], v11 offset:3168
    ds_read_b64_tr_b16 v[126:127], v11 offset:3696
    ds_read_b128 v[76:79], v55 offset:3072
    ds_read_b64_tr_b16 v[128:129], v11 offset:4224
    ds_read_b64_tr_b16 v[130:131], v11 offset:4752
    ds_read_b128 v[80:83], v55 offset:4096
    s_add_u32 s65, s60, 15728640
    s_waitcnt lgkmcnt(12)
    s_nop 0
    v_mfma_f32_32x32x16_bf16 v[96:111], v[112:115], v[64:67], 0
    ds_read_b64_tr_b16 v[132:133], v11 offset:5280
    ds_read_b64_tr_b16 v[134:135], v11 offset:5808
    ds_read_b128 v[84:87], v55 offset:5120
    s_waitcnt lgkmcnt(12)
    s_nop 0
    v_mfma_f32_32x32x16_bf16 v[96:111], v[116:119], v[68:71], v[96:111]
    ds_read_b64_tr_b16 v[136:137], v11 offset:6336
    ds_read_b64_tr_b16 v[138:139], v11 offset:6864
    ds_read_b128 v[88:91], v55 offset:6144
    s_waitcnt lgkmcnt(12)
    s_nop 0
    v_mfma_f32_32x32x16_bf16 v[96:111], v[120:123], v[72:75], v[96:111]
    ds_read_b64_tr_b16 v[140:141], v11 offset:7392
    ds_read_b64_tr_b16 v[142:143], v11 offset:7920
    ds_read_b128 v[92:95], v55 offset:7168
    s_waitcnt lgkmcnt(12)
    v_mfma_f32_32x32x16_bf16 v[96:111], v[124:127], v[76:79], v[96:111]
    s_waitcnt lgkmcnt(9)
    v_mfma_f32_32x32x16_bf16 v[96:111], v[128:131], v[80:83], v[96:111]
    s_waitcnt lgkmcnt(6)
    v_mfma_f32_32x32x16_bf16 v[96:111], v[132:135], v[84:87], v[96:111]
    s_waitcnt lgkmcnt(3)
    v_mfma_f32_32x32x16_bf16 v[96:111], v[136:139], v[88:91], v[96:111]
    s_waitcnt lgkmcnt(0)
    v_mfma_f32_32x32x16_bf16 v[96:111], v[140:143], v[92:95], v[96:111]
    s_nop 11
    v_cvt_pk_bf16_f32 v64, v96, v97
    v_cvt_pk_bf16_f32 v65, v98, v99
    v_cvt_pk_bf16_f32 v66, v100, v101
    v_cvt_pk_bf16_f32 v67, v102, v103
    v_cvt_pk_bf16_f32 v68, v104, v105
    v_cvt_pk_bf16_f32 v69, v106, v107
    v_cvt_pk_bf16_f32 v70, v108, v109
    v_cvt_pk_bf16_f32 v71, v110, v111
    buffer_store_dwordx4 v[64:67], v1, s[8:11], s65 offen offset:0 sc1
    buffer_store_dwordx4 v[68:71], v1, s[8:11], s65 offen offset:1024 sc1
Lq_79:
    v_mov_b32 v124, -1
    v_mov_b32 v125, -1
    v_mov_b32_e64 v126, -1
    v_mov_b32 v127, -1
    s_cmp_eq_u32 s53, 0
    s_cbranch_scc1 Lslow_80
    s_add_u32 s65, s57, 0
    buffer_store_dwordx4 v[124:127], v1, s[8:11], s65 offen offset:0
    buffer_store_dwordx4 v[124:127], v1, s[8:11], s65 offen offset:1024
    s_add_u32 s65, s57, 8388608
    buffer_store_dwordx4 v[124:127], v1, s[8:11], s65 offen offset:0
    buffer_store_dwordx4 v[124:127], v1, s[8:11], s65 offen offset:1024
Ldone_81:
    s_add_u32 m0, s46, 0
    s_add_u32 s80, s46, s78
    s_add_u32 s80, s80, 27590656
    buffer_load_dwordx4 v3, s[8:11], s80 offen offset:0 sc1 lds
    buffer_load_dwordx4 v3, s[8:11], s80 offen offset:1024 sc1 lds
    buffer_load_dwordx4 v3, s[8:11], s80 offen offset:2048 sc1 lds
    s_lshl_b32 s65, s49, 16
    s_lshl_b32 s66, s87, 6
    s_add_u32 s65, s65, s66
    s_add_u32 s65, s65, 15728640
    v_lshrrev_b32 v59, 2, v0
    v_lshlrev_b32 v59, 12, v59
    v_and_b32 v58, 3, v0
    v_lshl_add_u32 v59, v58, 4, v59
    ds_read_b128 v[112:115], v4 offset:0
    ds_read_b128 v[116:119], v4 offset:1024
    ds_read_b128 v[120:123], v4 offset:2048
    ds_read_b128 v[124:127], v4 offset:3072
    ds_read_b128 v[128:131], v4 offset:4096
    ds_read_b128 v[132:135], v4 offset:5120
    s_waitcnt lgkmcnt(5)
    v_mfma_f32_32x32x16_bf16 v[96:111], v[112:115], v[144:147], 0
    ds_read_b128 v[136:139], v4 offset:6144
    s_waitcnt lgkmcnt(5)
    v_mfma_f32_32x32x16_bf16 v[96:111], v[116:119], v[148:151], v[96:111]
    ds_read_b128 v[140:143], v4 offset:7168
    s_waitcnt lgkmcnt(5)
    v_mfma_f32_32x32x16_bf16 v[96:111], v[120:123], v[152:155], v[96:111]
    ds_read_b128 v[112:115], v4 offset:8192
    s_waitcnt lgkmcnt(5)
    v_mfma_f32_32x32x16_bf16 v[96:111], v[124:127], v[156:159], v[96:111]
    ds_read_b128 v[116:119], v4 offset:9216
    s_waitcnt lgkmcnt(5)
    v_mfma_f32_32x32x16_bf16 v[96:111], v[128:131], v[160:163], v[96:111]
    ds_read_b128 v[120:123], v4 offset:10240
    s_waitcnt lgkmcnt(5)
    v_mfma_f32_32x32x16_bf16 v[96:111], v[132:135], v[164:167], v[96:111]
    buffer_load_dwordx4 v3, s[8:11], s80 offen offset:3072 sc1 lds
    ds_read_b128 v[124:127], v4 offset:11264
    s_waitcnt lgkmcnt(5)
    v_mfma_f32_32x32x16_bf16 v[96:111], v[136:139], v[168:171], v[96:111]
    ds_read_b128 v[128:131], v4 offset:12288
    s_waitcnt lgkmcnt(5)
    v_mfma_f32_32x32x16_bf16 v[96:111], v[140:143], v[172:175], v[96:111]
    ds_read_b128 v[132:135], v4 offset:13312
    s_waitcnt lgkmcnt(5)
    v_mfma_f32_32x32x16_bf16 v[96:111], v[112:115], v[176:179], v[96:111]
    ds_read_b128 v[136:139], v4 offset:14336
    s_waitcnt lgkmcnt(5)
    v_mfma_f32_32x32x16_bf16 v[96:111], v[116:119], v[180:183], v[96:111]
    ds_read_b128 v[140:143], v4 offset:15360
    s_waitcnt lgkmcnt(5)
    v_mfma_f32_32x32x16_bf16 v[96:111], v[120:123], v[184:187], v[96:111]
    ds_read_b128 v[112:115], v4 offset:16384
    s_waitcnt lgkmcnt(5)
    v_mfma_f32_32x32x16_bf16 v[96:111], v[124:127], v[188:191], v[96:111]
    ds_read_b128 v[116:119], v4 offset:17408
    s_waitcnt lgkmcnt(5)
    v_mfma_f32_32x32x16_bf16 v[96:111], v[128:131], v[192:195], v[96:111]
    ds_read_b128 v[120:123], v4 offset:18432
    s_waitcnt lgkmcnt(5)
    v_mfma_f32_32x32x16_bf16 v[96:111], v[132:135], v[196:199], v[96:111]
    s_add_u32 m0, s46, 4096
    s_add_u32 s80, s46, s78
    s_add_u32 s80, s80, 27594752
    buffer_load_dwordx4 v3, s[8:11], s80 offen offset:0 sc1 lds
    ds_read_b128 v[124:127], v4 offset:19456
    s_waitcnt lgkmcnt(5)
    v_mfma_f32_32x32x16_bf16 v[96:111], v[136:139], v[200:203], v[96:111]
    ds_read_b128 v[128:131], v4 offset:20480
    s_waitcnt lgkmcnt(5)
    v_mfma_f32_32x32x16_bf16 v[96:111], v[140:143], v[204:207], v[96:111]
    ds_read_b128 v[132:135], v4 offset:21504
    s_waitcnt lgkmcnt(5)
    v_mfma_f32_32x32x16_bf16 v[96:111], v[112:115], v[208:211], v[96:111]
    ds_read_b128 v[136:139], v4 offset:22528
    s_waitcnt lgkmcnt(5)
    v_mfma_f32_32x32x16_bf16 v[96:111], v[116:119], v[212:215], v[96:111]
    ds_read_b128 v[140:143], v4 offset:23552
    s_waitcnt lgkmcnt(5)
    v_mfma_f32_32x32x16_bf16 v[96:111], v[120:123], v[216:219], v[96:111]
    ds_read_b128 v[112:115], v4 offset:24576
    s_waitcnt lgkmcnt(5)
    v_mfma_f32_32x32x16_bf16 v[96:111], v[124:127], v[220:223], v[96:111]
    ds_read_b128 v[116:119], v4 offset:25600
    s_waitcnt lgkmcnt(5)
    v_mfma_f32_32x32x16_bf16 v[96:111], v[128:131], v[224:227], v[96:111]
    ds_read_b128 v[120:123], v4 offset:26624
    s_waitcnt lgkmcnt(5)
    v_mfma_f32_32x32x16_bf16 v[96:111], v[132:135], v[228:231], v[96:111]
    ds_read_b128 v[124:127], v4 offset:27648
    s_waitcnt lgkmcnt(5)
    v_mfma_f32_32x32x16_bf16 v[96:111], v[136:139], v[232:235], v[96:111]
    s_waitcnt lgkmcnt(4)
    v_mfma_f32_32x32x16_bf16 v[96:111], v[140:143], v[236:239], v[96:111]
    s_waitcnt lgkmcnt(3)
    v_mfma_f32_32x32x16_bf16 v[96:111], v[112:115], v[240:243], v[96:111]
    v_mov_b32 v128, v54
    v_mov_b32 v132, v48
    s_waitcnt lgkmcnt(2)
    v_mfma_f32_32x32x16_bf16 v[96:111], v[116:119], v[244:247], v[96:111]
    v_mov_b32 v129, 0
    v_mov_b32 v133, 0
    s_waitcnt lgkmcnt(1)
    v_mfma_f32_32x32x16_bf16 v[96:111], v[120:123], v[248:251], v[96:111]
    v_mov_b32_e64 v130, 0
    v_mov_b32 v134, 0
    s_waitcnt lgkmcnt(0)
    v_mfma_f32_32x32x16_bf16 v[96:111], v[124:127], v[252:255], v[96:111]
    buffer_load_dwordx4 v[144:147], v59, s[8:11], s65 offen offset:0 sc1
    v_mov_b32 v131, 0
    v_mov_b32 v135, 0
    s_nop 1
    v_mfma_f32_32x32x16_bf16 v[96:111], v[132:135], v[128:131], v[96:111]
    v_lshrrev_b32 v60, 4, v0
    v_lshlrev_b32_e64 v60, 2, v60
    v_lshl_add_u32 v152, v58, 4, v60
    v_mov_b32 v154, 0x3f80
    v_mov_b32 v155, 1.0
    v_mov_b32 v148, 0
    v_mov_b32 v149, 0
    s_nop 4
    v_cvt_pk_bf16_f32 v96, v96, v97
    v_cvt_pk_bf16_f32 v97, v98, v99
    v_cvt_pk_bf16_f32 v98, v100, v101
    v_cvt_pk_bf16_f32 v99, v102, v103
    v_cvt_pk_bf16_f32 v100, v104, v105
    v_cvt_pk_bf16_f32 v101, v106, v107
    v_cvt_pk_bf16_f32 v102, v108, v109
    v_cvt_pk_bf16_f32 v103, v110, v111
    v_mfma_f32_32x32x16_bf16 v[64:79], v[24:27], v[96:99], 0
    s_nop 0
    v_mfma_f32_32x32x16_bf16 v[64:79], v[28:31], v[100:103], v[64:79]
    s_mov_b32 s55, 0
    s_mov_b32 s88, 0
    s_nop 8
    s_branch Lp3_85
Lp2_84:
    s_sleep 1
    buffer_load_dwordx4 v[144:147], v59, s[8:11], s65 offen offset:0 sc1
    s_add_u32 s55, s55, 1
    s_cmp_ge_u32 s55, 200000
    s_cselect_b32 s88, 512, 0
    s_or_b32 s79, s79, s88
Lp3_85:
    s_waitcnt vmcnt(0)
    v_max3_u32 v62, v144, v145, v146
    v_max_u32 v62, v147, v62
    v_cmp_eq_u32_e64 vcc, -1, v62
    s_nop 0
    s_cmp_eq_u64 vcc, 0
    s_cselect_b32 s89, 1, s88
    s_cmp_eq_u32 s89, 0
    s_cbranch_scc1 Lp2_84
    v_permlane32_swap_b32 v144, v146
    v_permlane32_swap_b32 v145, v147
    s_nop 1
    v_permlane16_swap_b32 v144, v145
    v_permlane16_swap_b32 v146, v147
    v_dot2_f32_bf16 v148, v144, v154, v148
    v_dot2_f32_bf16 v149, v144, v155, v149
    v_dot2_f32_bf16 v148, v145, v154, v148
    v_dot2_f32_bf16 v149, v145, v155, v149
    v_dot2_f32_bf16 v148, v146, v154, v148
    v_dot2_f32_bf16 v149, v146, v155, v149
    v_dot2_f32_bf16 v148, v147, v154, v148
    v_dot2_f32_bf16 v149, v147, v155, v149
    s_lshl_b32 s65, s49, 12
    s_add_u32 s65, s65, 25755648
    s_add_u32 s66, s66, s65
    v_add_f32_dpp v148, v148, v148 row_ror:4 row_mask:0xf bank_mask:0xf
    v_add_f32_dpp v149, v149, v149 row_ror:4 row_mask:0xf bank_mask:0xf
    s_nop 0
    v_add_f32_dpp v148, v148, v148 row_ror:8 row_mask:0xf bank_mask:0xf
    v_add_f32_dpp v149, v149, v149 row_ror:8 row_mask:0xf bank_mask:0xf
    v_cvt_pk_bf16_f32 v148, v148, v149
    v_min_u32 v148, -2, v148
    s_mov_b32 exec_lo, 983055
    s_mov_b32 exec_hi, 983055
    buffer_store_dword v148, v152, s[8:11], s66 offen sc1
    s_mov_b64 exec, -1
    s_barrier
    s_add_u32 m0, s46, 4096
    s_add_u32 s80, s46, s78
    s_add_u32 s80, s80, 27594752
    buffer_load_dwordx4 v3, s[8:11], s80 offen offset:1024 sc1 lds
    buffer_load_dwordx4 v3, s[8:11], s80 offen offset:2048 sc1 lds
    s_add_u32 m0, s47, 0
    s_add_u32 s80, s47, s78
    s_nop 0
    s_add_u32 s80, s80, 27590656
    buffer_load_dwordx4 v3, s[8:11], s80 offen offset:0 sc1 lds
    buffer_load_dwordx4 v3, s[8:11], s80 offen offset:1024 sc1 lds
    buffer_load_dwordx4 v3, s[8:11], s80 offen offset:2048 sc1 lds
    v_mul_f32 v57, 0x3fb8aa3b, v56
    v_max3_f32 v58, v64, v65, v66
    v_min3_f32 v60, v64, v65, v66
    v_max3_f32 v58, v67, v68, v58
    v_min3_f32 v60, v67, v68, v60
    v_max3_f32 v58, v69, v70, v58
    v_min3_f32 v60, v69, v70, v60
    v_max3_f32 v58, v71, v72, v58
    v_min3_f32 v60, v71, v72, v60
    v_max3_f32 v58, v73, v74, v58
    v_min3_f32 v60, v73, v74, v60
    v_max3_f32 v62, v76, v77, v78
    v_min3_f32 v63, v76, v77, v78
    v_max_f32 v62, v62, v79
    v_min_f32 v63, v63, v79
    v_sub_f32 v62, v62, v20
    v_add_f32 v63, v63, v20
    v_max3_f32 v58, v75, v62, v58
    v_min3_f32 v60, v75, v63, v60
    v_mov_b32 v62, v58
    v_mov_b32 v63, v60
    s_nop 0
    v_permlane32_swap_b32 v58, v62
    v_permlane32_swap_b32 v60, v63
    v_max_f32 v58, v58, v62
    v_min_f32 v60, v60, v63
    v_mul_f32 v58, v57, v58
    v_mul_f32 v60, v57, v60
    v_add_f32 v59, v58, v20
    v_sub_f32_e64 v61, v60, v20
    v_pk_fma_f32 v[80:81], v[64:65], v[56:57], v[60:61] op_sel:[0,1,0] op_sel_hi:[1,1,0] neg_lo:[1,0,0] neg_hi:[1,0,0]
    v_pk_fma_f32 v[64:65], v[64:65], v[56:57], v[58:59] op_sel:[0,1,0] op_sel_hi:[1,1,0] neg_lo:[0,0,1] neg_hi:[0,0,1]
    v_pk_fma_f32 v[82:83], v[66:67], v[56:57], v[60:61] op_sel:[0,1,0] op_sel_hi:[1,1,0] neg_lo:[1,0,0] neg_hi:[1,0,0]
    v_pk_fma_f32 v[66:67], v[66:67], v[56:57], v[58:59] op_sel:[0,1,0] op_sel_hi:[1,1,0] neg_lo:[0,0,1] neg_hi:[0,0,1]
    v_pk_fma_f32 v[84:85], v[68:69], v[56:57], v[60:61] op_sel:[0,1,0] op_sel_hi:[1,1,0] neg_lo:[1,0,0] neg_hi:[1,0,0]
    v_pk_fma_f32 v[68:69], v[68:69], v[56:57], v[58:59] op_sel:[0,1,0] op_sel_hi:[1,1,0] neg_lo:[0,0,1] neg_hi:[0,0,1]
    v_pk_fma_f32 v[86:87], v[70:71], v[56:57], v[60:61] op_sel:[0,1,0] op_sel_hi:[1,1,0] neg_lo:[1,0,0] neg_hi:[1,0,0]
    v_pk_fma_f32 v[70:71], v[70:71], v[56:57], v[58:59] op_sel:[0,1,0] op_sel_hi:[1,1,0] neg_lo:[0,0,1] neg_hi:[0,0,1]
    v_pk_fma_f32 v[88:89], v[72:73], v[56:57], v[60:61] op_sel:[0,1,0] op_sel_hi:[1,1,0] neg_lo:[1,0,0] neg_hi:[1,0,0]
    v_pk_fma_f32 v[72:73], v[72:73], v[56:57], v[58:59] op_sel:[0,1,0] op_sel_hi:[1,1,0] neg_lo:[0,0,1] neg_hi:[0,0,1]
    v_pk_fma_f32 v[90:91], v[74:75], v[56:57], v[60:61] op_sel:[0,1,0] op_sel_hi:[1,1,0] neg_lo:[1,0,0] neg_hi:[1,0,0]
    v_pk_fma_f32 v[74:75], v[74:75], v[56:57], v[58:59] op_sel:[0,1,0] op_sel_hi:[1,1,0] neg_lo:[0,0,1] neg_hi:[0,0,1]
    v_pk_fma_f32 v[92:93], v[76:77], v[56:57], v[60:61] op_sel:[0,1,1] op_sel_hi:[1,1,1] neg_lo:[1,0,0] neg_hi:[1,0,0]
    v_pk_fma_f32 v[76:77], v[76:77], v[56:57], v[58:59] op_sel:[0,1,1] op_sel_hi:[1,1,1] neg_lo:[0,0,1] neg_hi:[0,0,1]
    v_pk_fma_f32 v[94:95], v[78:79], v[56:57], v[60:61] op_sel:[0,1,1] op_sel_hi:[1,1,1] neg_lo:[1,0,0] neg_hi:[1,0,0]
    v_pk_fma_f32 v[78:79], v[78:79], v[56:57], v[58:59] op_sel:[0,1,1] op_sel_hi:[1,1,1] neg_lo:[0,0,1] neg_hi:[0,0,1]
    v_exp_f32 v80, v80
    v_exp_f32 v64, v64
    v_exp_f32 v81, v81
    buffer_load_dwordx4 v3, s[8:11], s80 offen offset:3072 sc1 lds
    v_exp_f32 v65, v65
    v_exp_f32 v82, v82
    v_exp_f32 v66, v66
    v_exp_f32 v83, v83
    v_exp_f32 v67, v67
    v_exp_f32 v84, v84
    v_exp_f32 v68, v68
    v_exp_f32 v85, v85
    v_exp_f32 v69, v69
    v_exp_f32 v86, v86
    v_exp_f32 v70, v70
    v_exp_f32 v87, v87
    s_add_u32 m0, s47, 4096
    s_add_u32 s80, s47, s78
    s_add_u32 s80, s80, 27594752
    buffer_load_dwordx4 v3, s[8:11], s80 offen offset:0 sc1 lds
    v_exp_f32 v71, v71
    v_exp_f32 v88, v88
    v_exp_f32 v72, v72
    v_exp_f32 v89, v89
    v_exp_f32 v73, v73
    v_exp_f32 v90, v90
    v_exp_f32 v74, v74
    v_exp_f32 v91, v91
    v_exp_f32 v75, v75
    v_exp_f32 v92, v92
    v_exp_f32 v76, v76
    v_exp_f32 v93, v93
    buffer_load_dwordx4 v3, s[8:11], s80 offen offset:1024 sc1 lds
    v_exp_f32 v77, v77
    v_exp_f32 v94, v94
    v_exp_f32 v78, v78
    v_exp_f32 v95, v95
    v_exp_f32_e64 v79, v79
    v_pk_add_f32 v[58:59], v[64:65], v[66:67]
    v_pk_add_f32 v[58:59], v[58:59], v[68:69]
    v_pk_add_f32 v[58:59], v[58:59], v[70:71]
    v_pk_add_f32 v[58:59], v[58:59], v[72:73]
    v_pk_add_f32 v[58:59], v[58:59], v[74:75]
    v_pk_add_f32 v[58:59], v[58:59], v[76:77]
    v_pk_add_f32 v[58:59], v[58:59], v[78:79]
    v_add_f32_e64 v58, v58, v59
    v_pk_add_f32 v[60:61], v[80:81], v[82:83]
    v_pk_add_f32 v[60:61], v[60:61], v[84:85]
    v_pk_add_f32 v[60:61], v[60:61], v[86:87]
    v_pk_add_f32 v[60:61], v[60:61], v[88:89]
    v_pk_add_f32 v[60:61], v[60:61], v[90:91]
    buffer_load_dwordx4 v3, s[8:11], s80 offen offset:2048 sc1 lds
    v_pk_add_f32 v[60:61], v[60:61], v[92:93]
    v_pk_add_f32 v[60:61], v[60:61], v[94:95]
    v_add_f32 v60, v60, v61
    v_mov_b32 v62, v58
    v_mov_b32 v63, v60
    s_nop 0
    v_permlane32_swap_b32 v58, v62
    v_permlane32_swap_b32 v60, v63
    v_add_f32 v58, v58, v62
    v_add_f32 v60, v60, v63
    v_rcp_f32 v58, v58
    v_rcp_f32 v60, v60
    v_pk_mul_f32 v[64:65], v[64:65], v[58:59] op_sel_hi:[1,0]
    v_pk_mul_f32 v[66:67], v[66:67], v[58:59] op_sel_hi:[1,0]
    v_pk_mul_f32 v[68:69], v[68:69], v[58:59] op_sel_hi:[1,0]
    v_pk_mul_f32 v[70:71], v[70:71], v[58:59] op_sel_hi:[1,0]
    v_pk_mul_f32 v[72:73], v[72:73], v[58:59] op_sel_hi:[1,0]
    v_pk_mul_f32 v[74:75], v[74:75], v[58:59] op_sel_hi:[1,0]
    v_pk_mul_f32 v[76:77], v[76:77], v[58:59] op_sel_hi:[1,0]
    v_pk_mul_f32 v[78:79], v[78:79], v[58:59] op_sel_hi:[1,0]
    v_cvt_pk_bf16_f32 v64, v64, v65
    v_cvt_pk_bf16_f32 v65, v66, v67
    s_add_u32 m0, s76, 0
    s_add_u32 s80, s76, s78
    s_add_u32 s80, s80, 27590656
    buffer_load_dwordx4 v3, s[8:11], s80 offen offset:0 sc1 lds
    v_cvt_pk_bf16_f32 v66, v68, v69
    v_cvt_pk_bf16_f32 v67, v70, v71
    v_cvt_pk_bf16_f32 v68, v72, v73
    v_cvt_pk_bf16_f32 v69, v74, v75
    v_cvt_pk_bf16_f32 v70, v76, v77
    v_cvt_pk_bf16_f32 v71, v78, v79
    v_pk_mul_f32 v[80:81], v[80:81], v[60:61] op_sel_hi:[1,0]
    v_pk_mul_f32 v[82:83], v[82:83], v[60:61] op_sel_hi:[1,0]
    v_pk_mul_f32 v[84:85], v[84:85], v[60:61] op_sel_hi:[1,0]
    v_pk_mul_f32 v[86:87], v[86:87], v[60:61] op_sel_hi:[1,0]
    v_pk_mul_f32 v[88:89], v[88:89], v[60:61] op_sel_hi:[1,0]
    v_pk_mul_f32 v[90:91], v[90:91], v[60:61] op_sel_hi:[1,0]
    v_pk_mul_f32 v[92:93], v[92:93], v[60:61] op_sel_hi:[1,0]
    v_pk_mul_f32 v[94:95], v[94:95], v[60:61] op_sel_hi:[1,0]
    v_cvt_pk_bf16_f32 v80, v80, v81
    v_cvt_pk_bf16_f32 v81, v82, v83
    v_cvt_pk_bf16_f32 v82, v84, v85
    v_cvt_pk_bf16_f32 v83, v86, v87
    v_cvt_pk_bf16_f32 v84, v88, v89
    v_cvt_pk_bf16_f32 v85, v90, v91
    v_cvt_pk_bf16_f32 v86, v92, v93
    v_cvt_pk_bf16_f32 v87, v94, v95
Lpf_86:
    s_add_u32 s6, s70, Lpf_86-Lstart+512
    s_min_u32 s6, s6, Lcode_end-Lstart-4
    s_load_dword s72, s[44:45], s6
    s_mov_b32 s55, 0
    s_branch Lp3_90
Lp2_89:
    s_sleep 1
Lp3_90:
    s_nop 0
    buffer_load_dwordx4 v[128:131], v1, s[8:11], s65 offen offset:0 sc1
    buffer_load_dwordx4 v[132:135], v1, s[8:11], s65 offen offset:1024 sc1
    buffer_load_dwordx4 v[136:139], v1, s[8:11], s65 offen offset:2048 sc1
    buffer_load_dwordx4 v[140:143], v1, s[8:11], s65 offen offset:3072 sc1
    s_add_u32 s55, s55, 1
    s_cmp_ge_u32 s55, 200000
    s_cselect_b32 s88, 512, 0
    s_or_b32 s79, s79, s88
    s_waitcnt vmcnt(0)
    s_nop 0
    v_max3_u32 v62, v128, v129, v130
    v_max3_u32 v62, v131, v132, v62
    v_max3_u32 v62, v133, v134, v62
    v_max3_u32 v62, v135, v136, v62
    v_max3_u32 v62, v137, v138, v62
    v_max3_u32 v62, v139, v140, v62
    v_max3_u32 v62, v141, v142, v62
    v_max_u32_e64 v62, v143, v62
    v_cmp_eq_u32 vcc, -1, v62
    s_nop 0
    s_cmp_eq_u64 vcc, 0
    s_cselect_b32 s89, 1, s88
    s_cmp_eq_u32 s89, 0
    s_cbranch_scc1 Lp2_89
    v_mfma_f32_32x32x16_bf16 v[96:111], v[128:131], v[64:67], 0
    v_mfma_f32_32x32x16_bf16 v[96:111], v[132:135], v[68:71], v[96:111]
    v_mfma_f32_32x32x16_bf16 v[96:111], v[136:139], v[80:83], v[96:111]
    v_mfma_f32_32x32x16_bf16 v[96:111], v[140:143], v[84:87], v[96:111]
    s_nop 11
    v_mov_b32 v58, v108
    v_mov_b32 v60, v108
    s_add_u32 s65, s57, 6291456
    s_nop 0
    v_permlane32_swap_b32 v58, v60
    v_add_f32 v60, 0x358637bd, v60
    v_rcp_f32 v60, v60
    s_nop 0
    s_nop 0
    v_pk_mul_f32 v[96:97], v[96:97], v[60:61] op_sel_hi:[1,0]
    v_pk_mul_f32 v[98:99], v[98:99], v[60:61] op_sel_hi:[1,0]
    v_pk_mul_f32 v[100:101], v[100:101], v[60:61] op_sel_hi:[1,0]
    v_pk_mul_f32 v[102:103], v[102:103], v[60:61] op_sel_hi:[1,0]
    v_pk_mul_f32 v[104:105], v[104:105], v[60:61] op_sel_hi:[1,0]
    v_pk_mul_f32 v[106:107], v[106:107], v[60:61] op_sel_hi:[1,0]
    v_pk_mul_f32 v[108:109], v[108:109], v[60:61] op_sel_hi:[1,0]
    v_pk_mul_f32 v[110:111], v[110:111], v[60:61] op_sel_hi:[1,0]
    v_cvt_pk_bf16_f32 v96, v96, v97
    v_cvt_pk_bf16_f32 v97, v98, v99
    v_cvt_pk_bf16_f32 v98, v100, v101
    v_cvt_pk_bf16_f32 v99, v102, v103
    v_cvt_pk_bf16_f32 v100, v104, v105
    v_cvt_pk_bf16_f32 v101, v106, v107
    v_cvt_pk_bf16_f32 v102, v108, v109
    v_cvt_pk_bf16_f32 v103, v110, v111
    s_cmp_eq_u32 s53, 0
    s_cbranch_scc1 Lslow_91
    buffer_store_dwordx4 v[96:99], v1, s[8:11], s65 offen offset:0
    buffer_store_dwordx4 v[100:103], v1, s[8:11], s65 offen offset:1024
Ldone_92:
Lpf_93:
    s_add_u32 s6, s70, Lpf_93-Lstart+1024
    s_min_u32 s6, s6, Lcode_end-Lstart-4
    s_load_dword s72, s[44:45], s6
    s_add_u32 s65, s58, 6291456
    s_add_u32 s66, s65, 4096
    s_mov_b32 s55, 0
Lop_94:
    s_nop 0
    buffer_load_dwordx4 v[144:147], v1, s[8:11], s65 offen offset:0 sc1
    buffer_load_dwordx4 v[148:151], v1, s[8:11], s65 offen offset:1024 sc1
    buffer_load_dwordx4 v[152:155], v1, s[8:11], s65 offen offset:2048 sc1
    buffer_load_dwordx4 v[156:159], v1, s[8:11], s65 offen offset:3072 sc1
    buffer_load_dwordx4 v[160:163], v1, s[8:11], s66 offen offset:0 sc1
    buffer_load_dwordx4 v[164:167], v1, s[8:11], s66 offen offset:1024 sc1
    buffer_load_dwordx4 v[168:171], v1, s[8:11], s66 offen offset:2048 sc1
    buffer_load_dwordx4 v[172:175], v1, s[8:11], s66 offen offset:3072 sc1
    s_add_u32 s55, s55, 1
    s_cmp_ge_u32 s55, 200000
    s_cselect_b32 s88, 1024, 0
    s_or_b32 s79, s79, s88
    s_waitcnt vmcnt(6)
    v_max3_u32 v62, v144, v145, v146
    v_max_u32 v62, v147, v62
    v_max3_u32 v62, v148, v149, v62
    v_max3_u32 v62, v150, v151, v62
    s_waitcnt vmcnt(4)
    s_nop 0
    v_max3_u32 v62, v152, v153, v62
    v_max3_u32 v62, v154, v155, v62
    v_max3_u32 v62, v156, v157, v62
    v_max3_u32 v62, v158, v159, v62
    s_waitcnt vmcnt(2)
    s_nop 0
    v_max3_u32 v62, v160, v161, v62
    v_max3_u32 v62, v162, v163, v62
    v_max3_u32 v62, v164, v165, v62
    v_max3_u32 v62, v166, v167, v62
    s_waitcnt vmcnt(0)
    s_nop 0
    v_max3_u32 v62, v168, v169, v62
    v_max3_u32 v62, v170, v171, v62
    v_max3_u32 v62, v172, v173, v62
    v_max3_u32 v62, v174, v175, v62
    v_cmp_eq_u32 vcc, -1, v62
    s_nop 0
    s_cmp_eq_u64 vcc, 0
    s_cselect_b32 s89, 1, s88
    s_cmp_eq_u32 s89, 0
    s_cbranch_scc1 Lop_94
    ds_write_b128 v23, v[144:147] offset:0
    v_mfma_f32_32x32x16_bf16 v[32:47], a[0:3], v[144:147], v[32:47]
    ds_write_b128 v23, v[148:151] offset:1024
    v_mfma_f32_32x32x16_bf16 v[32:47], a[4:7], v[148:151], v[32:47]
    ds_write_b128 v23, v[152:155] offset:2048
    v_mfma_f32_32x32x16_bf16 v[32:47], a[8:11], v[152:155], v[32:47]
    ds_write_b128 v23, v[156:159] offset:3072
    v_mfma_f32_32x32x16_bf16 v[32:47], a[12:15], v[156:159], v[32:47]
    ds_write_b128 v23, v[160:163] offset:4096
    v_mfma_f32_32x32x16_bf16 v[32:47], a[16:19], v[160:163], v[32:47]
    ds_write_b128 v23, v[164:167] offset:5120
    v_mfma_f32_32x32x16_bf16 v[32:47], a[20:23], v[164:167], v[32:47]
    ds_write_b128 v23, v[168:171] offset:6144
    ds_write_b128 v23, v[172:175] offset:7168
    s_waitcnt lgkmcnt(0)
    s_barrier
    ds_read_b128 v[64:67], v16 offset:0
    ds_read_b128 v[68:71], v16 offset:1024
    ds_read_b128 v[72:75], v16 offset:2048
    ds_read_b128 v[76:79], v16 offset:3072
    v_mfma_f32_32x32x16_bf16 v[32:47], a[24:27], v[168:171], v[32:47]
    v_mfma_f32_32x32x16_bf16 v[32:47], a[28:31], v[172:175], v[32:47]
    ds_read_b128 v[80:83], v16 offset:4096
    ds_read_b128 v[84:87], v16 offset:5120
    ds_read_b128 v[88:91], v16 offset:6144
    ds_read_b128 v[92:95], v16 offset:7168
    s_add_u32 m0, s76, 0
    s_add_u32 s80, s76, s78
    s_add_u32 s80, s80, 27590656
    buffer_load_dwordx4 v3, s[8:11], s80 offen offset:1024 sc1 lds
    buffer_load_dwordx4 v3, s[8:11], s80 offen offset:2048 sc1 lds
    buffer_load_dwordx4 v3, s[8:11], s80 offen offset:3072 sc1 lds
    s_waitcnt lgkmcnt(7)
    v_mfma_f32_32x32x16_bf16 v[32:47], a[32:35], v[64:67], v[32:47]
    s_add_u32 m0, s77, 0
    s_add_u32 s80, s77, s78
    s_add_u32 s80, s80, 27590656
    buffer_load_dwordx4 v3, s[8:11], s80 offen offset:0 sc1 lds
    ds_read_b128 v[176:179], v17 offset:0
    s_waitcnt lgkmcnt(7)
    v_mfma_f32_32x32x16_bf16 v[32:47], a[36:39], v[68:71], v[32:47]
    ds_read_b128 v[180:183], v17 offset:1024
    s_waitcnt lgkmcnt(7)
    v_mfma_f32_32x32x16_bf16 v[32:47], a[40:43], v[72:75], v[32:47]
    ds_read_b128 v[184:187], v17 offset:2048
    s_waitcnt lgkmcnt(7)
    v_mfma_f32_32x32x16_bf16 v[32:47], a[44:47], v[76:79], v[32:47]
    ds_read_b128 v[188:191], v17 offset:3072
    s_waitcnt lgkmcnt(7)
    v_mfma_f32_32x32x16_bf16 v[32:47], a[48:51], v[80:83], v[32:47]
    buffer_load_dwordx4 v3, s[8:11], s80 offen offset:1024 sc1 lds
    ds_read_b128 v[192:195], v17 offset:4096
    s_waitcnt lgkmcnt(7)
    v_mfma_f32_32x32x16_bf16 v[32:47], a[52:55], v[84:87], v[32:47]
    ds_read_b128 v[196:199], v17 offset:5120
    s_waitcnt lgkmcnt(7)
    v_mfma_f32_32x32x16_bf16 v[32:47], a[56:59], v[88:91], v[32:47]
    ds_read_b128 v[200:203], v17 offset:6144
    s_waitcnt lgkmcnt(7)
    v_mfma_f32_32x32x16_bf16 v[32:47], a[60:63], v[92:95], v[32:47]
    buffer_load_dwordx4 v3, s[8:11], s80 offen offset:2048 sc1 lds
    ds_read_b128 v[204:207], v17 offset:7168
    s_waitcnt lgkmcnt(7)
    v_mfma_f32_32x32x16_bf16 v[32:47], a[64:67], v[176:179], v[32:47]
    ds_read_b128 v[208:211], v18 offset:0
    s_waitcnt lgkmcnt(7)
    v_mfma_f32_32x32x16_bf16 v[32:47], a[68:71], v[180:183], v[32:47]
    ds_read_b128 v[212:215], v18 offset:1024
    s_waitcnt lgkmcnt(7)
    v_mfma_f32_32x32x16_bf16 v[32:47], a[72:75], v[184:187], v[32:47]
    buffer_load_dwordx4 v3, s[8:11], s80 offen offset:3072 sc1 lds
    ds_read_b128 v[216:219], v18 offset:2048
    s_waitcnt lgkmcnt(7)
    v_mfma_f32_32x32x16_bf16 v[32:47], a[76:79], v[188:191], v[32:47]
    ds_read_b128 v[220:223], v18 offset:3072
    s_waitcnt lgkmcnt(7)
    v_mfma_f32_32x32x16_bf16 v[32:47], a[80:83], v[192:195], v[32:47]
    ds_read_b128 v[224:227], v18 offset:4096
    s_waitcnt lgkmcnt(7)
    v_mfma_f32_32x32x16_bf16 v[32:47], a[84:87], v[196:199], v[32:47]
    ds_read_b128 v[228:231], v18 offset:5120
    s_waitcnt lgkmcnt(7)
    v_mfma_f32_32x32x16_bf16 v[32:47], a[88:91], v[200:203], v[32:47]
    ds_read_b128 v[232:235], v18 offset:6144
    s_waitcnt lgkmcnt(7)
    v_mfma_f32_32x32x16_bf16 v[32:47], a[92:95], v[204:207], v[32:47]
    ds_read_b128 v[236:239], v18 offset:7168
    s_waitcnt lgkmcnt(7)
    v_mfma_f32_32x32x16_bf16 v[32:47], a[96:99], v[208:211], v[32:47]
    s_waitcnt lgkmcnt(6)
    v_mfma_f32_32x32x16_bf16 v[32:47], a[100:103], v[212:215], v[32:47]
    s_waitcnt lgkmcnt(5)
    v_mfma_f32_32x32x16_bf16 v[32:47], a[104:107], v[216:219], v[32:47]
    s_waitcnt lgkmcnt(4)
    v_mfma_f32_32x32x16_bf16 v[32:47], a[108:111], v[220:223], v[32:47]
    s_waitcnt lgkmcnt(3)
    v_mfma_f32_32x32x16_bf16 v[32:47], a[112:115], v[224:227], v[32:47]
    s_waitcnt lgkmcnt(2)
    v_mfma_f32_32x32x16_bf16 v[32:47], a[116:119], v[228:231], v[32:47]
    s_waitcnt lgkmcnt(1)
    v_mfma_f32_32x32x16_bf16 v[32:47], a[120:123], v[232:235], v[32:47]
    s_waitcnt lgkmcnt(0)
    v_mfma_f32_32x32x16_bf16 v[32:47], a[124:127], v[236:239], v[32:47]
    s_add_u32 s65, s59, 0
    v_mov_b32 v122, 0x3f803f80
    v_mov_b32 v120, 0
    v_mov_b32 v121, 0
    s_nop 7
    v_cvt_pk_bf16_f32 v112, v32, v33
    v_cvt_pk_bf16_f32 v113, v34, v35
    v_cvt_pk_bf16_f32 v114, v36, v37
    v_cvt_pk_bf16_f32 v115, v38, v39
    v_cvt_pk_bf16_f32 v116, v40, v41
    v_cvt_pk_bf16_f32 v117, v42, v43
    v_cvt_pk_bf16_f32 v118, v44, v45
    v_cvt_pk_bf16_f32 v119, v46, v47
    s_cmp_eq_u32 s53, 0
    s_cbranch_scc1 Lslow_95
    buffer_store_dwordx2 v[112:113], v7, s[8:11], s65 offen offset:0
    buffer_store_dwordx2 v[114:115], v7, s[8:11], s65 offen offset:512
    buffer_store_dwordx2 v[116:117], v7, s[8:11], s65 offen offset:1024
    s_mov_b32 exec_hi, 0
    buffer_store_dwordx2 v[118:119], v7, s[8:11], s65 offen offset:1536
    s_mov_b32 exec_hi, -1
Ldone_96:
    v_dot2_f32_bf16 v120, v112, v122, v120
    v_dot2_f32_bf16 v121, v112, v112, v121
    v_dot2_f32_bf16 v120, v113, v122, v120
    v_dot2_f32_bf16 v121, v113, v113, v121
    v_dot2_f32_bf16 v120, v114, v122, v120
    v_dot2_f32_bf16 v121, v114, v114, v121
    v_dot2_f32_bf16 v120, v115, v122, v120
    v_dot2_f32_bf16 v121, v115, v115, v121
    v_dot2_f32_bf16 v120, v116, v122, v120
    v_dot2_f32_bf16 v121, v116, v116, v121
    v_dot2_f32_bf16 v120, v117, v122, v120
    v_dot2_f32_bf16 v121, v117, v117, v121
    v_dot2_f32_bf16 v120, v118, v122, v120
    v_dot2_f32_bf16 v121, v118, v118, v121
    v_dot2_f32_bf16 v120, v119, v122, v120
    v_dot2_f32_bf16 v121, v119, v119, v121
    s_lshl_b32 s66, s50, 9
    s_add_u32 s66, s66, 119808
    v_lshl_add_u32 v124, v0, 3, s66
    ds_write_b64 v124, v[120:121]
    v_lshlrev_b32 v32, 16, v112
    v_and_b32 v33, 0xffff0000, v112
    v_lshlrev_b32 v34, 16, v113
    v_and_b32 v35, 0xffff0000, v113
    v_lshlrev_b32 v36, 16, v114
    v_and_b32 v37, 0xffff0000, v114
    v_lshlrev_b32 v38, 16, v115
    v_and_b32 v39, 0xffff0000, v115
    v_lshlrev_b32 v40, 16, v116
    v_and_b32 v41, 0xffff0000, v116
    v_lshlrev_b32 v42, 16, v117
    v_and_b32 v43, 0xffff0000, v117
    v_lshlrev_b32 v44, 16, v118
    v_and_b32 v45, 0xffff0000, v118
    v_lshlrev_b32 v46, 16, v119
    v_and_b32 v47, 0xffff0000, v119
    s_add_u32 s65, s56, 0
    v_mov_b32_e64 v60, 0
    v_mov_b32 v61, 0
    s_mov_b32 s55, 0
    s_waitcnt vmcnt(4) lgkmcnt(0)
    s_barrier
    s_cmp_lg_u32 s50, 0
    s_cbranch_scc1 Lst_97
    ds_read_b64 v[126:127], v124 offset:512
    ds_read_b64 v[128:129], v124 offset:1024
    ds_read_b64 v[130:131], v124 offset:1536
    s_add_u32 s66, s59, 0
    s_waitcnt lgkmcnt(0)
    v_pk_add_f32 v[120:121], v[120:121], v[126:127]
    v_pk_add_f32 v[128:129], v[128:129], v[130:131]
    v_pk_add_f32 v[120:121], v[120:121], v[128:129]
    v_mov_b32 v124, v120
    v_mov_b32 v125, v121
    s_nop 0
    v_permlane32_swap_b32 v120, v124
    v_permlane32_swap_b32 v121, v125
    v_pk_add_f32 v[120:121], v[120:121], v[124:125]
    v_min_u32 v120, -2, v120
    v_min_u32 v121, -2, v121
    s_cmp_eq_u32 s53, 0
    s_cbranch_scc1 Lslow_98
    s_mov_b32 exec_hi, 0
    buffer_store_dwordx2 v[120:121], v8, s[8:11], s66 offen offset:0
    s_mov_b32 exec_hi, -1
Ldone_99:
Lst_97:
Lpf_100:
    s_nop 0
    s_add_u32 s6, s70, Lpf_100-Lstart+1024
    s_min_u32 s6, s6, Lcode_end-Lstart-4
    s_load_dword s72, s[44:45], s6
Lg_101:
    s_mov_b64 exec, 65535
    buffer_load_dwordx2 v[60:61], v9, s[8:11], s65 offen offset:0 sc1
    s_mov_b64 exec, -1
    s_nop 0
    buffer_load_dwordx4 v[144:147], v1, s[8:11], s65 offen offset:0 sc1
    buffer_load_dwordx4 v[148:151], v1, s[8:11], s65 offen offset:1024 sc1
    buffer_load_dwordx4 v[152:155], v1, s[8:11], s65 offen offset:2048 sc1
    buffer_load_dwordx4 v[156:159], v1, s[8:11], s65 offen offset:3072 sc1
    s_add_u32 s55, s55, 1
    s_cmp_ge_u32 s55, 200000
    s_cselect_b32 s88, 4096, 0
    s_or_b32 s79, s79, s88
    s_waitcnt vmcnt(4)
    v_max_u32 v62, v60, v61
    v_cmp_eq_u32 vcc, -1, v62
    s_nop 0
    s_cmp_eq_u64 vcc, 0
    s_cselect_b32 s89, 1, s88
    s_cmp_eq_u32 s89, 0
    s_cbranch_scc1 Lg_101
    s_add_u32 s69, s65, 4096
    buffer_load_dwordx4 v[160:163], v1, s[8:11], s69 offen offset:0 sc1
    buffer_load_dwordx4 v[164:167], v1, s[8:11], s69 offen offset:1024 sc1
    buffer_load_dwordx4 v[168:171], v1, s[8:11], s69 offen offset:2048 sc1
    buffer_load_dwordx4 v[172:175], v1, s[8:11], s69 offen offset:3072 sc1
    s_add_u32 s69, s65, 8192
    buffer_load_dwordx4 v[176:179], v1, s[8:11], s69 offen offset:0 sc1
    buffer_load_dwordx4 v[180:183], v1, s[8:11], s69 offen offset:1024 sc1
    ds_read_b128 v[112:115], v1 offset:0
    ds_read_b128 v[116:119], v1 offset:28672
    ds_read_b128 v[120:123], v1 offset:1024
    ds_read_b128 v[124:127], v1 offset:29696
    ds_read_b128 v[128:131], v1 offset:2048
    ds_read_b128 v[132:135], v1 offset:30720
    s_waitcnt vmcnt(6)
    s_nop 0
    v_max3_u32 v62, v144, v145, v146
    v_max3_u32 v62, v147, v148, v62
    v_max3_u32 v62, v149, v150, v62
    v_max3_u32 v62, v151, v152, v62
    v_max3_u32 v62, v153, v154, v62
    v_max3_u32 v62, v155, v156, v62
    v_max3_u32 v62, v157, v158, v62
    v_max_u32_e64 v62, v159, v62
    v_cmp_eq_u32 vcc, -1, v62
    s_nop 0
    s_cmp_eq_u64 vcc, 0
    s_cselect_b32 s89, 1, s88
    s_cmp_eq_u32 s89, 0
    s_cbranch_scc1 Lg_101
    v_mov_b32 v63, 0
    s_waitcnt lgkmcnt(4)
    v_mfma_f32_32x32x16_bf16 v[64:79], v[112:115], v[144:147], 0
    v_mfma_f32_32x32x16_bf16 v[80:95], v[144:147], v[116:119], 0
    ds_read_b128 v[136:139], v1 offset:3072
    ds_read_b128 v[140:143], v1 offset:31744
    buffer_load_dwordx4 v[184:187], v1, s[8:11], s69 offen offset:2048 sc1
    buffer_load_dwordx4 v[188:191], v1, s[8:11], s69 offen offset:3072 sc1
    s_waitcnt lgkmcnt(4)
    s_nop 0
    v_mfma_f32_32x32x16_bf16 v[64:79], v[120:123], v[148:151], v[64:79]
    v_mfma_f32_32x32x16_bf16 v[80:95], v[148:151], v[124:127], v[80:95]
    ds_read_b128 v[112:115], v1 offset:4096
    ds_read_b128 v[116:119], v1 offset:32768
    s_add_u32 s69, s65, 12288
    buffer_load_dwordx4 v[192:195], v1, s[8:11], s69 offen offset:0 sc1
    buffer_load_dwordx4 v[196:199], v1, s[8:11], s69 offen offset:1024 sc1
    s_waitcnt lgkmcnt(4)
    s_nop 0
    v_mfma_f32_32x32x16_bf16 v[64:79], v[128:131], v[152:155], v[64:79]
    v_mfma_f32_32x32x16_bf16 v[80:95], v[152:155], v[132:135], v[80:95]
    ds_read_b128 v[120:123], v1 offset:5120
    ds_read_b128 v[124:127], v1 offset:33792
    buffer_load_dwordx4 v[200:203], v1, s[8:11], s69 offen offset:2048 sc1
    buffer_load_dwordx4 v[204:207], v1, s[8:11], s69 offen offset:3072 sc1
    s_waitcnt lgkmcnt(4)
    s_nop 0
    v_mfma_f32_32x32x16_bf16 v[64:79], v[136:139], v[156:159], v[64:79]
    v_mfma_f32_32x32x16_bf16 v[80:95], v[156:159], v[140:143], v[80:95]
    ds_read_b128 v[128:131], v1 offset:6144
    ds_read_b128 v[132:135], v1 offset:34816
    s_add_u32 s69, s65, 16384
    buffer_load_dwordx4 v[208:211], v1, s[8:11], s69 offen offset:0 sc1
    s_add_u32 s69, s65, 28672
    buffer_load_dwordx4 v[96:99], v1, s[8:11], s69 offen offset:0 sc1
    s_waitcnt vmcnt(13)
    s_waitcnt lgkmcnt(4)
    v_mfma_f32_32x32x16_bf16 v[64:79], v[112:115], v[160:163], v[64:79]
    v_max3_u32 v63, v160, v161, v63
    v_max3_u32 v63, v162, v163, v63
    v_mfma_f32_32x32x16_bf16 v[80:95], v[160:163], v[116:119], v[80:95]
    ds_read_b128 v[136:139], v1 offset:7168
    ds_read_b128 v[140:143], v1 offset:35840
    s_add_u32 s69, s65, 16384
    buffer_load_dwordx4 v[212:215], v1, s[8:11], s69 offen offset:1024 sc1
    buffer_load_dwordx4 v[216:219], v1, s[8:11], s69 offen offset:2048 sc1
    s_waitcnt vmcnt(14)
    s_waitcnt lgkmcnt(4)
    v_mfma_f32_32x32x16_bf16 v[64:79], v[120:123], v[164:167], v[64:79]
    v_max3_u32 v63, v164, v165, v63
    v_max3_u32 v63, v166, v167, v63
    v_mfma_f32_32x32x16_bf16 v[80:95], v[164:167], v[124:127], v[80:95]
    ds_read_b128 v[112:115], v1 offset:8192
    ds_read_b128 v[116:119], v1 offset:36864
    buffer_load_dwordx4 v[220:223], v1, s[8:11], s69 offen offset:3072 sc1
    s_add_u32 s69, s65, 20480
    buffer_load_dwordx4 v[224:227], v1, s[8:11], s69 offen offset:0 sc1
    s_waitcnt vmcnt(15)
    s_waitcnt lgkmcnt(4)
    v_mfma_f32_32x32x16_bf16 v[64:79], v[128:131], v[168:171], v[64:79]
    v_max3_u32 v63, v168, v169, v63
    v_max3_u32 v63, v170, v171, v63
    v_mfma_f32_32x32x16_bf16 v[80:95], v[168:171], v[132:135], v[80:95]
    ds_read_b128 v[120:123], v1 offset:9216
    ds_read_b128 v[124:127], v1 offset:37888
    buffer_load_dwordx4 v[228:231], v1, s[8:11], s69 offen offset:1024 sc1
    buffer_load_dwordx4 v[232:235], v1, s[8:11], s69 offen offset:2048 sc1
    s_waitcnt vmcnt(16)
    s_waitcnt lgkmcnt(4)
    v_mfma_f32_32x32x16_bf16 v[64:79], v[136:139], v[172:175], v[64:79]
    v_max3_u32 v63, v172, v173, v63
    v_max3_u32 v63, v174, v175, v63
    v_mfma_f32_32x32x16_bf16 v[80:95], v[172:175], v[140:143], v[80:95]
    ds_read_b128 v[128:131], v1 offset:10240
    ds_read_b128 v[132:135], v1 offset:38912
    buffer_load_dwordx4 v[236:239], v1, s[8:11], s69 offen offset:3072 sc1
    s_add_u32 s69, s65, 24576
    buffer_load_dwordx4 v[240:243], v1, s[8:11], s69 offen offset:0 sc1
    s_waitcnt vmcnt(17)
    s_waitcnt lgkmcnt(4)
    v_mfma_f32_32x32x16_bf16 v[64:79], v[112:115], v[176:179], v[64:79]
    v_max3_u32 v63, v176, v177, v63
    v_max3_u32 v63, v178, v179, v63
    v_mfma_f32_32x32x16_bf16 v[80:95], v[176:179], v[116:119], v[80:95]
    ds_read_b128 v[136:139], v1 offset:11264
    ds_read_b128 v[140:143], v1 offset:39936
    buffer_load_dwordx4 v[244:247], v1, s[8:11], s69 offen offset:1024 sc1
    s_waitcnt vmcnt(17)
    s_waitcnt lgkmcnt(4)
    v_mfma_f32_32x32x16_bf16 v[64:79], v[120:123], v[180:183], v[64:79]
    v_max3_u32 v63, v180, v181, v63
    v_max3_u32 v63, v182, v183, v63
    v_mfma_f32_32x32x16_bf16 v[80:95], v[180:183], v[124:127], v[80:95]
    ds_read_b128 v[112:115], v1 offset:12288
    ds_read_b128 v[116:119], v1 offset:40960
    buffer_load_dwordx4 v[248:251], v1, s[8:11], s69 offen offset:2048 sc1
    s_waitcnt vmcnt(17)
    s_waitcnt lgkmcnt(4)
    v_mfma_f32_32x32x16_bf16 v[64:79], v[128:131], v[184:187], v[64:79]
    v_max3_u32 v63, v184, v185, v63
    v_max3_u32 v63, v186, v187, v63
    v_mfma_f32_32x32x16_bf16 v[80:95], v[184:187], v[132:135], v[80:95]
    ds_read_b128 v[120:123], v1 offset:13312
    ds_read_b128 v[124:127], v1 offset:41984
    buffer_load_dwordx4 v[252:255], v1, s[8:11], s69 offen offset:3072 sc1
    s_waitcnt vmcnt(17)
    s_waitcnt lgkmcnt(4)
    v_mfma_f32_32x32x16_bf16 v[64:79], v[136:139], v[188:191], v[64:79]
    v_max3_u32 v63, v188, v189, v63
    v_max3_u32 v63, v190, v191, v63
    v_mfma_f32_32x32x16_bf16 v[80:95], v[188:191], v[140:143], v[80:95]
    ds_read_b128 v[128:131], v1 offset:14336
    ds_read_b128 v[132:135], v1 offset:43008
    s_waitcnt vmcnt(16)
    s_waitcnt lgkmcnt(4)
    v_mfma_f32_32x32x16_bf16 v[64:79], v[112:115], v[192:195], v[64:79]
    v_max3_u32 v63, v192, v193, v63
    v_max3_u32 v63, v194, v195, v63
    v_mfma_f32_32x32x16_bf16 v[80:95], v[192:195], v[116:119], v[80:95]
    ds_read_b128 v[136:139], v1 offset:15360
    ds_read_b128 v[140:143], v1 offset:44032
    s_waitcnt vmcnt(15)
    s_waitcnt lgkmcnt(4)
    v_mfma_f32_32x32x16_bf16 v[64:79], v[120:123], v[196:199], v[64:79]
    v_max3_u32 v63, v196, v197, v63
    v_max3_u32 v63, v198, v199, v63
    v_mfma_f32_32x32x16_bf16 v[80:95], v[196:199], v[124:127], v[80:95]
    ds_read_b128 v[112:115], v1 offset:16384
    ds_read_b128 v[116:119], v1 offset:45056
    s_waitcnt vmcnt(14)
    s_waitcnt lgkmcnt(4)
    v_mfma_f32_32x32x16_bf16 v[64:79], v[128:131], v[200:203], v[64:79]
    v_max3_u32 v63, v200, v201, v63
    v_max3_u32 v63, v202, v203, v63
    v_mfma_f32_32x32x16_bf16 v[80:95], v[200:203], v[132:135], v[80:95]
    ds_read_b128 v[120:123], v1 offset:17408
    ds_read_b128 v[124:127], v1 offset:46080
    s_waitcnt vmcnt(13)
    s_waitcnt lgkmcnt(4)
    v_mfma_f32_32x32x16_bf16 v[64:79], v[136:139], v[204:207], v[64:79]
    v_max3_u32 v63, v204, v205, v63
    v_max3_u32 v63, v206, v207, v63
    v_mfma_f32_32x32x16_bf16 v[80:95], v[204:207], v[140:143], v[80:95]
    ds_read_b128 v[128:131], v1 offset:18432
    ds_read_b128 v[132:135], v1 offset:47104
    s_waitcnt vmcnt(12)
    s_waitcnt lgkmcnt(4)
    v_mfma_f32_32x32x16_bf16 v[64:79], v[112:115], v[208:211], v[64:79]
    v_max3_u32 v63, v208, v209, v63
    v_max3_u32 v63, v210, v211, v63
    v_mfma_f32_32x32x16_bf16 v[80:95], v[208:211], v[116:119], v[80:95]
    ds_read_b128 v[136:139], v1 offset:19456
    ds_read_b128 v[140:143], v1 offset:48128
    s_waitcnt vmcnt(10)
    s_waitcnt lgkmcnt(4)
    v_mfma_f32_32x32x16_bf16 v[64:79], v[120:123], v[212:215], v[64:79]
    v_max3_u32 v63, v212, v213, v63
    v_max3_u32 v63, v214, v215, v63
    v_mfma_f32_32x32x16_bf16 v[80:95], v[212:215], v[124:127], v[80:95]
    ds_read_b128 v[112:115], v1 offset:20480
    ds_read_b128 v[116:119], v1 offset:49152
    v_max3_u32 v62, v96, v97, v98
    v_max_u32_e64 v62, v99, v62
    v_cmp_eq_u32 vcc, -1, v62
    s_nop 0
    s_cmp_eq_u64 vcc, 0
    s_cbranch_scc0 Lsr_103
Lsb_104:
    s_waitcnt vmcnt(9)
    s_waitcnt lgkmcnt(4)
    v_mfma_f32_32x32x16_bf16 v[64:79], v[128:131], v[216:219], v[64:79]
    v_max3_u32 v63, v216, v217, v63
    v_max3_u32 v63, v218, v219, v63
    v_pk_add_f32 v[60:61], v[96:97], v[98:99]
    v_mov_b32_e64 v58, v60
    v_mfma_f32_32x32x16_bf16 v[80:95], v[216:219], v[132:135], v[80:95]
    ds_read_b128 v[120:123], v1 offset:21504
    ds_read_b128 v[124:127], v1 offset:50176
    v_mov_b32 v59, v61
    v_permlane32_swap_b32 v60, v58
    s_nop 0
    v_permlane32_swap_b32 v61, v59
    s_waitcnt vmcnt(8)
    s_waitcnt lgkmcnt(4)
    v_mfma_f32_32x32x16_bf16 v[64:79], v[136:139], v[220:223], v[64:79]
    v_max3_u32 v63, v220, v221, v63
    v_max3_u32 v63, v222, v223, v63
    v_add_f32 v60, v60, v58
    v_add_f32 v61, v61, v59
    v_mfma_f32_32x32x16_bf16 v[80:95], v[220:223], v[140:143], v[80:95]
    ds_read_b128 v[128:131], v1 offset:22528
    ds_read_b128 v[132:135], v1 offset:51200
    v_mul_f32 v60, 0x3b124925, v60
    v_mul_f32 v61, 0x3b124925, v61
    v_fma_f32 v61, -v60, v60, v61
    s_waitcnt vmcnt(7)
    s_waitcnt lgkmcnt(4)
    v_mfma_f32_32x32x16_bf16 v[64:79], v[112:115], v[224:227], v[64:79]
    v_max3_u32 v63, v224, v225, v63
    v_max3_u32 v63, v226, v227, v63
    v_max_f32_e64 v61, 0, v61
    v_cvt_pk_bf16_f32 v54, v60, v60
    v_mfma_f32_32x32x16_bf16 v[80:95], v[224:227], v[116:119], v[80:95]
    ds_read_b128 v[136:139], v1 offset:23552
    ds_read_b128 v[140:143], v1 offset:52224
    v_cvt_pk_bf16_f32 v61, v61, v61
    v_and_b32 v61, 0xffff0000, v61
    v_add_f32 v61, 0x3727c5ac, v61
    v_cvt_pk_bf16_f32 v61, v61, v61
    v_and_b32 v61, 0xffff0000, v61
    s_waitcnt vmcnt(6)
    s_waitcnt lgkmcnt(4)
    v_mfma_f32_32x32x16_bf16 v[64:79], v[120:123], v[228:231], v[64:79]
    v_max3_u32 v63, v228, v229, v63
    v_max3_u32 v63, v230, v231, v63
    v_sqrt_f32 v61, v61
    s_nop 0
    v_cvt_pk_bf16_f32 v61, v61, v61
    v_and_b32 v61, 0xffff0000, v61
    v_mfma_f32_32x32x16_bf16 v[80:95], v[228:231], v[124:127], v[80:95]
    ds_read_b128 v[112:115], v1 offset:24576
    ds_read_b128 v[116:119], v1 offset:53248
    v_rcp_f32 v56, v61
    s_nop 0
    ds_write_b32 v12, v56
    v_mov_b32_e64 v96, v54
    s_waitcnt vmcnt(5)
    s_waitcnt lgkmcnt(5)
    v_mfma_f32_32x32x16_bf16 v[64:79], v[128:131], v[232:235], v[64:79]
    v_max3_u32 v63, v232, v233, v63
    v_max3_u32 v63, v234, v235, v63
    v_mov_b32 v100, v52
    v_mov_b32 v104, v53
    v_mfma_f32_32x32x16_bf16 v[80:95], v[232:235], v[132:135], v[80:95]
    ds_read_b128 v[120:123], v1 offset:25600
    ds_read_b128 v[124:127], v1 offset:54272
    v_mov_b32 v97, 0
    v_mov_b32 v101, 0
    v_mov_b32_e64 v105, 0
    s_waitcnt vmcnt(4)
    s_waitcnt lgkmcnt(5)
    v_mfma_f32_32x32x16_bf16 v[64:79], v[136:139], v[236:239], v[64:79]
    v_max3_u32 v63, v236, v237, v63
    v_max3_u32 v63, v238, v239, v63
    v_mov_b32 v98, 0
    v_mov_b32 v102, 0
    v_mfma_f32_32x32x16_bf16 v[80:95], v[236:239], v[140:143], v[80:95]
    ds_read_b128 v[128:131], v1 offset:26624
    ds_read_b128 v[132:135], v1 offset:55296
    v_mov_b32 v106, 0
    v_mov_b32 v99, 0
    v_mov_b32_e64 v103, 0
    s_waitcnt vmcnt(3)
    s_waitcnt lgkmcnt(5)
    v_mfma_f32_32x32x16_bf16 v[64:79], v[112:115], v[240:243], v[64:79]
    v_max3_u32 v63, v240, v241, v63
    v_max3_u32 v63, v242, v243, v63
    v_mov_b32_e64 v107, 0
    v_mfma_f32_32x32x16_bf16 v[80:95], v[240:243], v[116:119], v[80:95]
    ds_read_b128 v[136:139], v1 offset:27648
    ds_read_b128 v[140:143], v1 offset:56320
    s_waitcnt vmcnt(2)
    s_waitcnt lgkmcnt(4)
    v_mfma_f32_32x32x16_bf16 v[64:79], v[120:123], v[244:247], v[64:79]
    v_max3_u32 v63, v244, v245, v63
    v_max3_u32 v63, v246, v247, v63
    v_mfma_f32_32x32x16_bf16 v[80:95], v[244:247], v[124:127], v[80:95]
    v_mfma_f32_32x32x16_bf16 v[64:79], v[100:103], v[96:99], v[64:79]
    v_mfma_f32_32x32x16_bf16 v[80:95], v[96:99], v[104:107], v[80:95]
    ds_read_b128 v[96:99], v13 offset:0
    ds_read_b128 v[100:103], v13 offset:32
    ds_read_b128 v[104:107], v13 offset:64
    ds_read_b128 v[108:111], v13 offset:96
    s_waitcnt vmcnt(1)
    s_waitcnt lgkmcnt(6)
    v_mfma_f32_32x32x16_bf16 v[64:79], v[128:131], v[248:251], v[64:79]
    v_max3_u32 v63, v248, v249, v63
    v_max3_u32 v63, v250, v251, v63
    v_mfma_f32_32x32x16_bf16 v[80:95], v[248:251], v[132:135], v[80:95]
    s_waitcnt vmcnt(0)
    s_waitcnt lgkmcnt(4)
    v_mfma_f32_32x32x16_bf16 v[64:79], v[136:139], v[252:255], v[64:79]
    v_max3_u32 v63, v252, v253, v63
    v_max3_u32 v63, v254, v255, v63
    v_mfma_f32_32x32x16_bf16 v[80:95], v[252:255], v[140:143], v[80:95]
    v_cmp_eq_u32 vcc, -1, v63
    s_nop 0
    s_cmp_eq_u64 vcc, 0
    s_cbranch_scc0 Lgbad_105
Lgok_102:
    s_add_u32 s65, s62, 20971520
    s_nop 3
    s_nop 0
    v_pk_mul_f32 v[64:65], v[64:65], v[56:57] op_sel_hi:[1,0]
    v_pk_mul_f32 v[66:67], v[66:67], v[56:57] op_sel_hi:[1,0]
    v_pk_mul_f32 v[68:69], v[68:69], v[56:57] op_sel_hi:[1,0]
    v_pk_mul_f32 v[70:71], v[70:71], v[56:57] op_sel_hi:[1,0]
    v_pk_mul_f32 v[72:73], v[72:73], v[56:57] op_sel_hi:[1,0]
    v_pk_mul_f32 v[74:75], v[74:75], v[56:57] op_sel_hi:[1,0]
    v_pk_mul_f32 v[76:77], v[76:77], v[56:57] op_sel_hi:[1,0]
    v_pk_mul_f32 v[78:79], v[78:79], v[56:57] op_sel_hi:[1,0]
    v_cvt_pk_bf16_f32 v64, v64, v65
    v_cvt_pk_bf16_f32 v65, v66, v67
    v_cvt_pk_bf16_f32 v66, v68, v69
    v_cvt_pk_bf16_f32 v67, v70, v71
    v_cvt_pk_bf16_f32 v68, v72, v73
    v_cvt_pk_bf16_f32 v69, v74, v75
    v_cvt_pk_bf16_f32 v70, v76, v77
    v_cvt_pk_bf16_f32 v71, v78, v79
    buffer_store_dwordx4 v[64:67], v1, s[8:11], s65 offen offset:0 sc1
    buffer_store_dwordx4 v[68:71], v1, s[8:11], s65 offen offset:1024 sc1
    s_waitcnt lgkmcnt(0)
    s_nop 0
    v_pk_fma_f32 v[80:81], v[80:81], v[96:97], v[2:3] op_sel_hi:[1,1,0]
    v_pk_fma_f32 v[82:83], v[82:83], v[98:99], v[2:3] op_sel_hi:[1,1,0]
    v_pk_fma_f32 v[84:85], v[84:85], v[100:101], v[2:3] op_sel_hi:[1,1,0]
    v_pk_fma_f32 v[86:87], v[86:87], v[102:103], v[2:3] op_sel_hi:[1,1,0]
    v_pk_fma_f32 v[88:89], v[88:89], v[104:105], v[2:3] op_sel_hi:[1,1,0]
    v_pk_fma_f32 v[90:91], v[90:91], v[106:107], v[2:3] op_sel_hi:[1,1,0]
    v_pk_fma_f32 v[92:93], v[92:93], v[108:109], v[2:3] op_sel_hi:[1,1,0]
    v_pk_fma_f32 v[94:95], v[94:95], v[110:111], v[2:3] op_sel_hi:[1,1,0]
    v_cvt_pk_bf16_f32 v80, v80, v81
    v_cvt_pk_bf16_f32 v81, v82, v83
    v_cvt_pk_bf16_f32 v82, v84, v85
    v_cvt_pk_bf16_f32 v83, v86, v87
    v_cvt_pk_bf16_f32 v84, v88, v89
    v_cvt_pk_bf16_f32 v85, v90, v91
    v_cvt_pk_bf16_f32 v86, v92, v93
    v_cvt_pk_bf16_f32 v87, v94, v95
    buffer_store_dwordx4 v[80:83], v1, s[8:11], s65 offen offset:2048 sc1
    buffer_store_dwordx4 v[84:87], v1, s[8:11], s65 offen offset:3072 sc1
    ds_write_b128 v14, v[64:67] offset:32768
    ds_write_b128 v14, v[68:71] offset:33792
    ds_write_b128 v14, v[80:83] offset:34816
    ds_write_b128 v14, v[84:87] offset:35840
    s_lshl_b32 s65, s48, 1
    s_add_u32 s65, s65, s50
    s_add_u32 s66, s63, 20971520
    s_cmp_lt_u32 s65, 4
    s_cselect_b32 s65, 117440512, s66
    s_add_u32 s66, s65, 4096
    s_lshl_b32 s67, s50, 13
    s_add_u32 s67, s67, 86016
    ds_read_b128 v[112:115], v4 offset:0
    ds_read_b128 v[116:119], v4 offset:1024
    ds_read_b128 v[120:123], v4 offset:2048
    ds_read_b128 v[124:127], v4 offset:3072
    ds_read_b128 v[128:131], v4 offset:4096
    ds_read_b128 v[132:135], v4 offset:5120
    s_waitcnt lgkmcnt(5)
    v_mfma_f32_32x32x16_bf16 v[96:111], v[112:115], v[144:147], 0
    ds_read_b128 v[136:139], v4 offset:6144
    s_waitcnt lgkmcnt(5)
    v_mfma_f32_32x32x16_bf16 v[96:111], v[116:119], v[148:151], v[96:111]
    ds_read_b128 v[140:143], v4 offset:7168
    s_waitcnt lgkmcnt(5)
    v_mfma_f32_32x32x16_bf16 v[96:111], v[120:123], v[152:155], v[96:111]
    ds_read_b128 v[112:115], v4 offset:8192
    s_waitcnt lgkmcnt(5)
    v_mfma_f32_32x32x16_bf16 v[96:111], v[124:127], v[156:159], v[96:111]
    ds_read_b128 v[116:119], v4 offset:9216
    s_waitcnt lgkmcnt(5)
    v_mfma_f32_32x32x16_bf16 v[96:111], v[128:131], v[160:163], v[96:111]
    ds_read_b128 v[120:123], v4 offset:10240
    s_waitcnt lgkmcnt(5)
    v_mfma_f32_32x32x16_bf16 v[96:111], v[132:135], v[164:167], v[96:111]
    ds_read_b128 v[124:127], v4 offset:11264
    s_waitcnt lgkmcnt(5)
    v_mfma_f32_32x32x16_bf16 v[96:111], v[136:139], v[168:171], v[96:111]
    ds_read_b128 v[128:131], v4 offset:12288
    s_waitcnt lgkmcnt(5)
    v_mfma_f32_32x32x16_bf16 v[96:111], v[140:143], v[172:175], v[96:111]
    ds_read_b128 v[132:135], v4 offset:13312
    s_waitcnt lgkmcnt(5)
    s_nop 0
    v_mfma_f32_32x32x16_bf16 v[96:111], v[112:115], v[176:179], v[96:111]
    ds_read_b128 v[136:139], v4 offset:14336
    v_mov_b32 v57, 0xff61b1e6
    v_mov_b32 v60, 65535
    v_mov_b32 v61, 0xffff0000
    v_cmp_le_i32 s[82:83], 0, v21
    s_waitcnt lgkmcnt(5)
    s_nop 0
    v_mfma_f32_32x32x16_bf16 v[96:111], v[116:119], v[180:183], v[96:111]
    ds_read_b128 v[140:143], v4 offset:15360
    v_cmp_le_i32 s[84:85], 1, v21
    v_mov_b32 v58, 0xff61b1e6
    v_cndmask_b32 v160, v57, 0, s[82:83]
    v_cndmask_b32 v161, v57, 0, s[84:85]
    s_waitcnt lgkmcnt(5)
    s_nop 0
    v_mfma_f32_32x32x16_bf16 v[96:111], v[120:123], v[184:187], v[96:111]
    ds_read_b128 v[112:115], v4 offset:16384
    v_cndmask_b32 v144, 0, v57, s[82:83]
    v_cndmask_b32 v145, 0, v57, s[84:85]
    v_cndmask_b32 v62, 0, v60, s[82:83]
    v_cndmask_b32 v63, 0, v61, s[84:85]
    s_waitcnt lgkmcnt(5)
    s_nop 0
    v_mfma_f32_32x32x16_bf16 v[96:111], v[124:127], v[188:191], v[96:111]
    ds_read_b128 v[116:119], v4 offset:17408
    v_cmp_le_i32 s[82:83], 2, v21
    v_cmp_le_i32 s[84:85], 3, v21
    v_or_b32 v88, v62, v63
    v_cndmask_b32 v162, v57, 0, s[82:83]
    s_waitcnt lgkmcnt(5)
    v_mfma_f32_32x32x16_bf16 v[96:111], v[128:131], v[192:195], v[96:111]
    ds_read_b128 v[120:123], v4 offset:18432
    v_cndmask_b32 v163, v57, 0, s[84:85]
    v_cndmask_b32 v146, 0, v57, s[82:83]
    v_cndmask_b32 v147, 0, v57, s[84:85]
    v_cndmask_b32 v62, 0, v60, s[82:83]
    s_waitcnt lgkmcnt(5)
    s_nop 0
    v_mfma_f32_32x32x16_bf16 v[96:111], v[132:135], v[196:199], v[96:111]
    ds_read_b128 v[124:127], v4 offset:19456
    v_cndmask_b32 v63, 0, v61, s[84:85]
    v_cmp_le_i32 s[82:83], 8, v21
    v_cmp_le_i32 s[84:85], 9, v21
    v_or_b32 v89, v62, v63
    s_waitcnt lgkmcnt(5)
    v_mfma_f32_32x32x16_bf16 v[96:111], v[136:139], v[200:203], v[96:111]
    ds_read_b128 v[128:131], v4 offset:20480
    v_cndmask_b32 v164, v57, 0, s[82:83]
    v_cndmask_b32 v165, v57, 0, s[84:85]
    v_cndmask_b32 v148, 0, v57, s[82:83]
    v_cndmask_b32 v149, 0, v57, s[84:85]
    s_waitcnt lgkmcnt(5)
    s_nop 0
    v_mfma_f32_32x32x16_bf16 v[96:111], v[140:143], v[204:207], v[96:111]
    ds_read_b128 v[132:135], v4 offset:21504
    v_cndmask_b32 v62, 0, v60, s[82:83]
    v_cndmask_b32 v63, 0, v61, s[84:85]
    v_cmp_le_i32 s[82:83], 10, v21
    v_cmp_le_i32 s[84:85], 11, v21
    s_waitcnt lgkmcnt(5)
    v_mfma_f32_32x32x16_bf16 v[96:111], v[112:115], v[208:211], v[96:111]
    ds_read_b128 v[136:139], v4 offset:22528
    v_or_b32 v90, v62, v63
    v_cndmask_b32 v166, v57, 0, s[82:83]
    v_cndmask_b32 v167, v57, 0, s[84:85]
    v_cndmask_b32 v150, 0, v57, s[82:83]
    s_waitcnt lgkmcnt(5)
    s_nop 0
    v_mfma_f32_32x32x16_bf16 v[96:111], v[116:119], v[212:215], v[96:111]
    ds_read_b128 v[140:143], v4 offset:23552
    v_cndmask_b32 v151, 0, v57, s[84:85]
    v_cndmask_b32 v62, 0, v60, s[82:83]
    v_cndmask_b32 v63, 0, v61, s[84:85]
    v_cmp_le_i32 s[82:83], 16, v21
    s_waitcnt lgkmcnt(5)
    v_mfma_f32_32x32x16_bf16 v[96:111], v[120:123], v[216:219], v[96:111]
    ds_read_b128 v[112:115], v4 offset:24576
    v_cmp_le_i32 s[84:85], 17, v21
    v_or_b32 v91, v62, v63
    v_cndmask_b32 v168, v57, 0, s[82:83]
    v_cndmask_b32 v169, v57, 0, s[84:85]
    s_waitcnt lgkmcnt(5)
    s_nop 0
    v_mfma_f32_32x32x16_bf16 v[96:111], v[124:127], v[220:223], v[96:111]
    ds_read_b128 v[116:119], v4 offset:25600
    v_cndmask_b32 v152, 0, v57, s[82:83]
    v_cndmask_b32 v153, 0, v57, s[84:85]
    v_cndmask_b32 v62, 0, v60, s[82:83]
    v_cndmask_b32 v63, 0, v61, s[84:85]
    s_waitcnt lgkmcnt(5)
    v_mfma_f32_32x32x16_bf16 v[96:111], v[128:131], v[224:227], v[96:111]
    ds_read_b128 v[120:123], v4 offset:26624
    s_add_u32 m0, s67, 0
    s_nop 0
    buffer_load_dwordx4 v1, s[8:11], s65 offen offset:0 sc1 lds
    buffer_load_dwordx4 v1, s[8:11], s65 offen offset:1024 sc1 lds
    s_add_u32 m0, s67, 4096
    s_nop 0
    buffer_load_dwordx4 v1, s[8:11], s66 offen offset:0 sc1 lds
    buffer_load_dwordx4 v1, s[8:11], s66 offen offset:1024 sc1 lds
    v_cmp_le_i32 s[82:83], 18, v21
    v_cmp_le_i32 s[84:85], 19, v21
    v_or_b32 v92, v62, v63
    v_cndmask_b32 v170, v57, 0, s[82:83]
    s_waitcnt lgkmcnt(5)
    v_mfma_f32_32x32x16_bf16 v[96:111], v[132:135], v[228:231], v[96:111]
    ds_read_b128 v[124:127], v4 offset:27648
    v_cndmask_b32 v171, v57, 0, s[84:85]
    v_cndmask_b32 v154, 0, v57, s[82:83]
    v_cndmask_b32 v155, 0, v57, s[84:85]
    v_cndmask_b32 v62, 0, v60, s[82:83]
    s_waitcnt lgkmcnt(5)
    s_nop 0
    v_mfma_f32_32x32x16_bf16 v[96:111], v[136:139], v[232:235], v[96:111]
    v_cndmask_b32 v63, 0, v61, s[84:85]
    v_cmp_le_i32 s[82:83], 24, v21
    v_cmp_le_i32 s[84:85], 25, v21
    v_or_b32 v93, v62, v63
    s_waitcnt lgkmcnt(4)
    v_mfma_f32_32x32x16_bf16 v[96:111], v[140:143], v[236:239], v[96:111]
    v_cndmask_b32 v172, v57, 0, s[82:83]
    v_cndmask_b32 v173, v57, 0, s[84:85]
    v_cndmask_b32 v156, 0, v57, s[82:83]
    v_cndmask_b32 v157, 0, v57, s[84:85]
    s_waitcnt lgkmcnt(3)
    s_nop 0
    v_mfma_f32_32x32x16_bf16 v[96:111], v[112:115], v[240:243], v[96:111]
    v_cndmask_b32 v62, 0, v60, s[82:83]
    v_cndmask_b32 v63, 0, v61, s[84:85]
    v_cmp_le_i32 s[82:83], 26, v21
    v_cmp_le_i32 s[84:85], 27, v21
    v_mov_b32 v128, v54
    v_mov_b32 v132, v51
    s_waitcnt lgkmcnt(2)
    v_mfma_f32_32x32x16_bf16 v[96:111], v[116:119], v[244:247], v[96:111]
    v_or_b32 v94, v62, v63
    v_cndmask_b32 v174, v57, 0, s[82:83]
    v_cndmask_b32 v175, v57, 0, s[84:85]
    v_cndmask_b32 v158, 0, v57, s[82:83]
    v_mov_b32_e64 v129, 0
    v_mov_b32 v133, 0
    s_waitcnt lgkmcnt(1)
    v_mfma_f32_32x32x16_bf16 v[96:111], v[120:123], v[248:251], v[96:111]
    v_cndmask_b32 v159, 0, v57, s[84:85]
    v_cndmask_b32 v62, 0, v60, s[82:83]
    v_cndmask_b32 v63, 0, v61, s[84:85]
    v_or_b32 v95, v62, v63
    v_mov_b32 v130, 0
    v_mov_b32 v134, 0
    s_waitcnt lgkmcnt(0)
    v_mfma_f32_32x32x16_bf16 v[96:111], v[124:127], v[252:255], v[96:111]
    s_add_u32 m0, s67, 0
    s_nop 0
    buffer_load_dwordx4 v1, s[8:11], s65 offen offset:2048 sc1 lds
    buffer_load_dwordx4 v1, s[8:11], s65 offen offset:3072 sc1 lds
    s_add_u32 m0, s67, 4096
    s_nop 0
    s_nop 0
    buffer_load_dwordx4 v1, s[8:11], s66 offen offset:2048 sc1 lds
    buffer_load_dwordx4 v1, s[8:11], s66 offen offset:3072 sc1 lds
    v_mov_b32 v59, 0xff61b1e6
    v_mul_f32 v62, 0x3e8b97f6, v56
    v_mov_b32 v131, 0
    v_mov_b32 v135, 0
    s_nop 1
    v_mfma_f32_32x32x16_bf16 v[96:111], v[132:135], v[128:131], v[96:111]
    s_nop 11
    v_pk_mul_f32 v[96:97], v[96:97], v[62:63] op_sel_hi:[1,0]
    v_pk_mul_f32 v[98:99], v[98:99], v[62:63] op_sel_hi:[1,0]
    v_pk_mul_f32 v[100:101], v[100:101], v[62:63] op_sel_hi:[1,0]
    v_pk_mul_f32 v[102:103], v[102:103], v[62:63] op_sel_hi:[1,0]
    v_pk_mul_f32 v[104:105], v[104:105], v[62:63] op_sel_hi:[1,0]
    v_pk_mul_f32 v[106:107], v[106:107], v[62:63] op_sel_hi:[1,0]
    v_pk_mul_f32 v[108:109], v[108:109], v[62:63] op_sel_hi:[1,0]
    v_pk_mul_f32 v[110:111], v[110:111], v[62:63] op_sel_hi:[1,0]
    v_cvt_pk_bf16_f32 v96, v96, v97
    v_cvt_pk_bf16_f32 v97, v98, v99
    v_cvt_pk_bf16_f32 v98, v100, v101
    v_cvt_pk_bf16_f32 v99, v102, v103
    v_cvt_pk_bf16_f32 v100, v104, v105
    v_cvt_pk_bf16_f32 v101, v106, v107
    v_cvt_pk_bf16_f32 v102, v108, v109
    v_cvt_pk_bf16_f32 v103, v110, v111
    s_mov_b32 exec_lo, 0
    v_mov_b32 v102, 16256
    s_mov_b32 exec_lo, -1
    v_mfma_f32_32x32x16_bf16 v[160:175], v[64:67], v[96:99], v[160:175]
    v_mfma_f32_32x32x16_bf16 v[160:175], v[68:71], v[100:103], v[160:175]
    s_mov_b32 s55, 0
    s_waitcnt vmcnt(4)
    ds_read_b128 v[176:179], v6 offset:0
    ds_read_b128 v[180:183], v6 offset:1024
    ds_read_b128 v[184:187], v6 offset:4096
    ds_read_b128 v[188:191], v6 offset:5120
Lhp_106:
    s_waitcnt lgkmcnt(0)
    s_nop 0
    v_max3_u32 v62, v176, v177, v178
    v_max3_u32 v62, v179, v180, v62
    v_max3_u32 v62, v181, v182, v62
    v_max3_u32 v62, v183, v184, v62
    v_max3_u32 v62, v185, v186, v62
    v_max3_u32 v62, v187, v188, v62
    v_max3_u32 v62, v189, v190, v62
    v_max_u32_e64 v62, v191, v62
    v_cmp_eq_u32 vcc, -1, v62
    s_nop 0
    s_cmp_eq_u64 vcc, 0
    s_nop 1
    s_cbranch_scc1 Lho_107
    s_add_u32 s55, s55, 1
    s_cmp_ge_u32 s55, 200000
    s_cselect_b32 s88, 8192, 0
    s_or_b32 s79, s79, s88
    s_cmp_lg_u32 s88, 0
    s_cbranch_scc1 Lho_107
    s_sleep 1
    s_add_u32 m0, s67, 0
    s_nop 0
    buffer_load_dwordx4 v1, s[8:11], s65 offen offset:0 sc1 lds
    buffer_load_dwordx4 v1, s[8:11], s65 offen offset:1024 sc1 lds
    s_add_u32 m0, s67, 4096
    s_nop 0
    buffer_load_dwordx4 v1, s[8:11], s66 offen offset:0 sc1 lds
    buffer_load_dwordx4 v1, s[8:11], s66 offen offset:1024 sc1 lds
    s_add_u32 m0, s67, 0
    s_nop 0
    buffer_load_dwordx4 v1, s[8:11], s65 offen offset:2048 sc1 lds
    buffer_load_dwordx4 v1, s[8:11], s65 offen offset:3072 sc1 lds
    s_add_u32 m0, s67, 4096
    s_nop 0
    buffer_load_dwordx4 v1, s[8:11], s66 offen offset:2048 sc1 lds
    buffer_load_dwordx4 v1, s[8:11], s66 offen offset:3072 sc1 lds
    s_waitcnt vmcnt(4)
    s_nop 0
    ds_read_b128 v[176:179], v6 offset:0
    ds_read_b128 v[180:183], v6 offset:1024
    ds_read_b128 v[184:187], v6 offset:4096
    ds_read_b128 v[188:191], v6 offset:5120
    s_branch Lhp_106
Lho_107:
    s_cmp_lg_u32 s65, 117440512
    s_cbranch_scc1 Lmk_109
    v_mov_b32 v62, 65377
    s_mov_b32 exec_lo, 0
    ds_write_b32 v6, v62 offset:1032
    ds_write_b32 v6, v62 offset:5128
    s_mov_b32 exec_lo, -1
    s_waitcnt lgkmcnt(0)
Lmk_109:
    s_barrier
    ds_read_b128 v[64:67], v14 offset:0
    ds_read_b128 v[68:71], v14 offset:1024
    ds_read_b128 v[72:75], v14 offset:4096
    ds_read_b128 v[76:79], v14 offset:5120
    ds_read_b128 v[80:83], v14 offset:8192
    ds_read_b128 v[84:87], v14 offset:9216
    s_waitcnt lgkmcnt(4)
    s_nop 0
    v_mfma_f32_32x32x16_bf16 v[144:159], v[64:67], v[96:99], v[144:159]
    v_mfma_f32_32x32x16_bf16 v[144:159], v[68:71], v[100:103], v[144:159]
    ds_read_b128 v[64:67], v14 offset:12288
    ds_read_b128 v[68:71], v14 offset:13312
    s_waitcnt lgkmcnt(4)
    s_nop 0
    v_mfma_f32_32x32x16_bf16 v[112:127], v[72:75], v[96:99], 0
    v_mfma_f32_32x32x16_bf16 v[112:127], v[76:79], v[100:103], v[112:127]
    ds_read_b128 v[72:75], v14 offset:16384
    ds_read_b128 v[76:79], v14 offset:17408
    s_waitcnt lgkmcnt(4)
    v_mfma_f32_32x32x16_bf16 v[128:143], v[80:83], v[96:99], 0
    s_nop 2
    v_max_f32 v144, v144, v160
    v_max_f32 v145, v145, v161
    v_max_f32 v146, v146, v162
    v_max_f32 v147, v147, v163
    v_max_f32 v148, v148, v164
    v_max_f32 v149, v149, v165
    v_mfma_f32_32x32x16_bf16 v[128:143], v[84:87], v[100:103], v[128:143]
    ds_read_b128 v[80:83], v14 offset:20480
    ds_read_b128 v[84:87], v14 offset:21504
    v_max_f32 v150, v150, v166
    v_max_f32 v151, v151, v167
    v_max_f32 v152, v152, v168
    v_max_f32 v153, v153, v169
    v_max_f32 v154, v154, v170
    s_waitcnt lgkmcnt(4)
    v_mfma_f32_32x32x16_bf16 v[176:191], v[64:67], v[96:99], 0
    v_max_f32 v155, v155, v171
    v_max_f32 v156, v156, v172
    v_max_f32 v157, v157, v173
    v_max_f32 v158, v158, v174
    v_max_f32_e64 v159, v159, v175
    v_max3_f32 v58, v144, v145, v58
    v_mfma_f32_32x32x16_bf16 v[176:191], v[68:71], v[100:103], v[176:191]
    ds_read_b128 v[64:67], v14 offset:24576
    ds_read_b128 v[68:71], v14 offset:25600
    v_max3_f32 v59, v146, v147, v59
    v_max3_f32 v58, v148, v149, v58
    v_max3_f32 v59, v150, v151, v59
    v_max3_f32 v58, v152, v153, v58
    v_max3_f32 v59, v154, v155, v59
    s_waitcnt lgkmcnt(4)
    s_nop 0
    v_mfma_f32_32x32x16_bf16 v[192:207], v[72:75], v[96:99], 0
    v_max3_f32 v58, v156, v157, v58
    v_max3_f32 v59, v158, v159, v59
    v_max3_f32 v58, v112, v113, v58
    v_max3_f32 v59, v114, v115, v59
    v_max3_f32 v58, v116, v117, v58
    v_max3_f32 v59, v118, v119, v59
    v_mfma_f32_32x32x16_bf16 v[192:207], v[76:79], v[100:103], v[192:207]
    ds_read_b128 v[72:75], v14 offset:28672
    ds_read_b128 v[76:79], v14 offset:29696
    v_max3_f32 v58, v120, v121, v58
    v_max3_f32 v59, v122, v123, v59
    v_max3_f32 v58, v124, v125, v58
    v_max3_f32 v59, v126, v127, v59
    v_max3_f32 v58, v128, v129, v58
    s_waitcnt lgkmcnt(4)
    s_nop 0
    v_mfma_f32_32x32x16_bf16 v[208:223], v[80:83], v[96:99], 0
    v_max3_f32 v59, v130, v131, v59
    v_max3_f32 v58, v132, v133, v58
    v_max3_f32 v59, v134, v135, v59
    v_max3_f32 v58, v136, v137, v58
    v_max3_f32 v59, v138, v139, v59
    v_max3_f32 v58, v140, v141, v58
    v_mfma_f32_32x32x16_bf16 v[208:223], v[84:87], v[100:103], v[208:223]
    v_max3_f32 v59, v142, v143, v59
    v_max3_f32 v58, v176, v177, v58
    v_max3_f32 v59, v178, v179, v59
    v_max3_f32 v58, v180, v181, v58
    v_max3_f32 v59, v182, v183, v59
    s_waitcnt lgkmcnt(2)
    s_nop 0
    v_mfma_f32_32x32x16_bf16 v[224:239], v[64:67], v[96:99], 0
    v_max3_f32 v58, v184, v185, v58
    v_max3_f32 v59, v186, v187, v59
    v_max3_f32 v58, v188, v189, v58
    v_max3_f32 v59, v190, v191, v59
    v_max3_f32 v58, v192, v193, v58
    v_max3_f32 v59, v194, v195, v59
    v_mfma_f32_32x32x16_bf16 v[224:239], v[68:71], v[100:103], v[224:239]
    v_max3_f32 v58, v196, v197, v58
    v_max3_f32 v59, v198, v199, v59
    v_max3_f32 v58, v200, v201, v58
    v_max3_f32 v59, v202, v203, v59
    v_max3_f32 v58, v204, v205, v58
    s_waitcnt lgkmcnt(0)
    s_nop 0
    v_mfma_f32_32x32x16_bf16 v[240:255], v[72:75], v[96:99], 0
    v_max3_f32 v59, v206, v207, v59
    v_max3_f32 v58, v208, v209, v58
    v_max3_f32 v59, v210, v211, v59
    v_max3_f32 v58, v212, v213, v58
    v_max3_f32 v59, v214, v215, v59
    v_max3_f32 v58, v216, v217, v58
    v_mfma_f32_32x32x16_bf16 v[240:255], v[76:79], v[100:103], v[240:255]
    v_max3_f32 v59, v218, v219, v59
    v_max3_f32 v58, v220, v221, v58
    v_max3_f32 v59, v222, v223, v59
    v_max3_f32 v58, v224, v225, v58
    v_max3_f32 v59, v226, v227, v59
    v_max3_f32 v58, v228, v229, v58
    v_max3_f32 v59, v230, v231, v59
    v_max3_f32 v58, v232, v233, v58
    v_max3_f32 v59, v234, v235, v59
    v_max3_f32 v58, v236, v237, v58
    v_max3_f32 v59, v238, v239, v59
    s_nop 0
    s_nop 0
    v_max3_f32 v58, v240, v241, v58
    v_max3_f32 v59, v242, v243, v59
    v_max3_f32 v58, v244, v245, v58
    v_max3_f32 v59, v246, v247, v59
    v_max3_f32 v58, v248, v249, v58
    v_max3_f32 v59, v250, v251, v59
    v_max3_f32 v58, v252, v253, v58
    v_max3_f32 v59, v254, v255, v59
    v_max_f32 v58, v58, v59
    v_mov_b32 v60, v58
    s_nop 1
    v_permlane32_swap_b32 v58, v60
    v_max_f32 v58, v58, v60
    v_sub_f32 v58, 0, v58
    v_pk_add_f32 v[144:145], v[144:145], v[58:59] op_sel_hi:[1,0]
    v_pk_add_f32 v[146:147], v[146:147], v[58:59] op_sel_hi:[1,0]
    v_pk_add_f32 v[148:149], v[148:149], v[58:59] op_sel_hi:[1,0]
    v_pk_add_f32 v[150:151], v[150:151], v[58:59] op_sel_hi:[1,0]
    v_pk_add_f32 v[152:153], v[152:153], v[58:59] op_sel_hi:[1,0]
    v_pk_add_f32 v[154:155], v[154:155], v[58:59] op_sel_hi:[1,0]
    v_pk_add_f32 v[156:157], v[156:157], v[58:59] op_sel_hi:[1,0]
    v_pk_add_f32 v[158:159], v[158:159], v[58:59] op_sel_hi:[1,0]
    v_exp_f32 v144, v144
    v_exp_f32 v145, v145
    v_exp_f32 v146, v146
    v_exp_f32 v147, v147
    v_exp_f32 v148, v148
    v_exp_f32 v149, v149
    v_exp_f32 v150, v150
    v_exp_f32 v151, v151
    v_exp_f32 v152, v152
    v_exp_f32 v153, v153
    v_exp_f32 v154, v154
    v_exp_f32 v155, v155
    v_exp_f32 v156, v156
    v_exp_f32 v157, v157
    v_exp_f32_e64 v158, v158
    v_exp_f32 v159, v159
    s_waitcnt vmcnt(0)
    ds_read_b128 v[64:67], v6 offset:2048
    ds_read_b128 v[68:71], v6 offset:3072
    ds_read_b128 v[72:75], v6 offset:6144
    ds_read_b128 v[76:79], v6 offset:7168
    v_cvt_pk_bf16_f32 v144, v144, v145
    v_cvt_pk_bf16_f32 v145, v146, v147
    v_cvt_pk_bf16_f32 v146, v148, v149
    v_cvt_pk_bf16_f32 v147, v150, v151
    v_cvt_pk_bf16_f32 v148, v152, v153
    v_cvt_pk_bf16_f32 v149, v154, v155
    v_cvt_pk_bf16_f32 v150, v156, v157
    v_cvt_pk_bf16_f32 v151, v158, v159
    v_and_b32 v160, v144, v88
    v_xor_b32 v144, v144, v160
    v_and_b32 v161, v145, v89
    v_xor_b32 v145, v145, v161
    v_and_b32 v162, v146, v90
    v_xor_b32 v146, v146, v162
    v_and_b32 v163, v147, v91
    v_xor_b32 v147, v147, v163
    v_and_b32 v164, v148, v92
    v_xor_b32 v148, v148, v164
    v_and_b32 v165, v149, v93
    v_xor_b32 v149, v149, v165
    v_and_b32 v166, v150, v94
    v_xor_b32 v150, v150, v166
    v_and_b32 v167, v151, v95
    v_xor_b32 v151, v151, v167
    s_mov_b32 s55, 0
Lhp_110:
    s_waitcnt lgkmcnt(0)
    v_max3_u32 v62, v64, v65, v66
    v_max3_u32 v62, v67, v68, v62
    v_max3_u32 v62, v69, v70, v62
    v_max3_u32 v62, v71, v72, v62
    v_max3_u32 v62, v73, v74, v62
    v_max3_u32 v62, v75, v76, v62
    v_max3_u32 v62, v77, v78, v62
    v_max_u32_e64 v62, v79, v62
    v_cmp_eq_u32 vcc, -1, v62
    s_nop 0
    s_cmp_eq_u64 vcc, 0
    s_nop 1
    s_cbranch_scc1 Lho_111
    s_add_u32 s55, s55, 1
    s_cmp_ge_u32 s55, 200000
    s_cselect_b32 s88, 8192, 0
    s_or_b32 s79, s79, s88
    s_cmp_lg_u32 s88, 0
    s_cbranch_scc1 Lho_111
    s_sleep 1
    s_add_u32 m0, s67, 0
    s_nop 0
    buffer_load_dwordx4 v1, s[8:11], s65 offen offset:2048 sc1 lds
    buffer_load_dwordx4 v1, s[8:11], s65 offen offset:3072 sc1 lds
    s_add_u32 m0, s67, 4096
    s_nop 0
    buffer_load_dwordx4 v1, s[8:11], s66 offen offset:2048 sc1 lds
    buffer_load_dwordx4 v1, s[8:11], s66 offen offset:3072 sc1 lds
    s_waitcnt vmcnt(0)
    ds_read_b128 v[64:67], v6 offset:2048
    ds_read_b128 v[68:71], v6 offset:3072
    ds_read_b128 v[72:75], v6 offset:6144
    ds_read_b128 v[76:79], v6 offset:7168
    s_branch Lhp_110
Lho_111:
    s_barrier
    ds_read_b128 v[64:67], v14 offset:2048
    ds_read_b128 v[68:71], v14 offset:3072
    ds_read_b128 v[72:75], v14 offset:6144
    ds_read_b128 v[76:79], v14 offset:7168
    ds_read_b128 v[80:83], v14 offset:10240
    ds_read_b128 v[84:87], v14 offset:11264
    ds_read_b128 v[168:171], v14 offset:34816
    ds_read_b128 v[172:175], v14 offset:35840
    v_pk_add_f32 v[112:113], v[112:113], v[58:59] op_sel_hi:[1,0]
    v_pk_add_f32 v[114:115], v[114:115], v[58:59] op_sel_hi:[1,0]
    v_pk_add_f32 v[116:117], v[116:117], v[58:59] op_sel_hi:[1,0]
    v_pk_add_f32 v[118:119], v[118:119], v[58:59] op_sel_hi:[1,0]
    v_pk_add_f32 v[120:121], v[120:121], v[58:59] op_sel_hi:[1,0]
    v_pk_add_f32 v[122:123], v[122:123], v[58:59] op_sel_hi:[1,0]
    v_pk_add_f32 v[124:125], v[124:125], v[58:59] op_sel_hi:[1,0]
    v_pk_add_f32 v[126:127], v[126:127], v[58:59] op_sel_hi:[1,0]
    v_exp_f32 v112, v112
    v_exp_f32 v113, v113
    s_waitcnt lgkmcnt(6)
    v_mfma_f32_32x32x16_bf16 v[96:111], v[64:67], v[144:147], 0
    v_exp_f32 v114, v114
    v_exp_f32 v115, v115
    v_exp_f32 v116, v116
    v_exp_f32_e64 v117, v117
    v_mfma_f32_32x32x16_bf16 v[96:111], v[68:71], v[148:151], v[96:111]
    ds_read_b128 v[64:67], v14 offset:14336
    ds_read_b128 v[68:71], v14 offset:15360
    v_exp_f32 v118, v118
    v_exp_f32 v119, v119
    v_exp_f32 v120, v120
    v_exp_f32 v121, v121
    s_waitcnt lgkmcnt(2)
    v_mfma_f32_32x32x16_bf16 v[96:111], v[168:171], v[160:163], v[96:111]
    v_exp_f32 v122, v122
    v_exp_f32 v123, v123
    v_exp_f32 v124, v124
    v_exp_f32 v125, v125
    v_mfma_f32_32x32x16_bf16 v[96:111], v[172:175], v[164:167], v[96:111]
    v_exp_f32 v126, v126
    v_exp_f32_e64 v127, v127
    v_cvt_pk_bf16_f32 v112, v112, v113
    v_cvt_pk_bf16_f32 v113, v114, v115
    v_cvt_pk_bf16_f32 v114, v116, v117
    v_cvt_pk_bf16_f32 v115, v118, v119
    v_cvt_pk_bf16_f32 v116, v120, v121
    v_cvt_pk_bf16_f32 v117, v122, v123
    v_cvt_pk_bf16_f32 v118, v124, v125
    v_cvt_pk_bf16_f32 v119, v126, v127
    v_pk_add_f32 v[128:129], v[128:129], v[58:59] op_sel_hi:[1,0]
    v_pk_add_f32 v[130:131], v[130:131], v[58:59] op_sel_hi:[1,0]
    v_pk_add_f32 v[132:133], v[132:133], v[58:59] op_sel_hi:[1,0]
    v_pk_add_f32 v[134:135], v[134:135], v[58:59] op_sel_hi:[1,0]
    v_pk_add_f32 v[136:137], v[136:137], v[58:59] op_sel_hi:[1,0]
    v_pk_add_f32 v[138:139], v[138:139], v[58:59] op_sel_hi:[1,0]
    v_pk_add_f32 v[140:141], v[140:141], v[58:59] op_sel_hi:[1,0]
    v_pk_add_f32 v[142:143], v[142:143], v[58:59] op_sel_hi:[1,0]
    v_exp_f32 v128, v128
    v_exp_f32 v129, v129
    v_mfma_f32_32x32x16_bf16 v[96:111], v[72:75], v[112:115], v[96:111]
    v_exp_f32 v130, v130
    v_exp_f32 v131, v131
    v_exp_f32 v132, v132
    v_exp_f32 v133, v133
    v_mfma_f32_32x32x16_bf16 v[96:111], v[76:79], v[116:119], v[96:111]
    ds_read_b128 v[72:75], v14 offset:18432
    ds_read_b128 v[76:79], v14 offset:19456
    v_exp_f32 v134, v134
    v_exp_f32 v135, v135
    v_exp_f32 v136, v136
    v_exp_f32 v137, v137
    v_exp_f32 v138, v138
    v_exp_f32 v139, v139
    v_exp_f32 v140, v140
    v_exp_f32 v141, v141
    v_exp_f32 v142, v142
    v_exp_f32 v143, v143
    v_cvt_pk_bf16_f32 v128, v128, v129
    v_cvt_pk_bf16_f32 v129, v130, v131
    v_cvt_pk_bf16_f32 v130, v132, v133
    v_cvt_pk_bf16_f32 v131, v134, v135
    v_cvt_pk_bf16_f32 v132, v136, v137
    v_cvt_pk_bf16_f32 v133, v138, v139
    v_cvt_pk_bf16_f32 v134, v140, v141
    v_cvt_pk_bf16_f32 v135, v142, v143
    v_pk_add_f32 v[176:177], v[176:177], v[58:59] op_sel_hi:[1,0]
    v_pk_add_f32 v[178:179], v[178:179], v[58:59] op_sel_hi:[1,0]
    v_pk_add_f32 v[180:181], v[180:181], v[58:59] op_sel_hi:[1,0]
    v_pk_add_f32 v[182:183], v[182:183], v[58:59] op_sel_hi:[1,0]
    v_pk_add_f32 v[184:185], v[184:185], v[58:59] op_sel_hi:[1,0]
    v_pk_add_f32 v[186:187], v[186:187], v[58:59] op_sel_hi:[1,0]
    v_pk_add_f32 v[188:189], v[188:189], v[58:59] op_sel_hi:[1,0]
    v_pk_add_f32 v[190:191], v[190:191], v[58:59] op_sel_hi:[1,0]
    v_exp_f32 v176, v176
    v_exp_f32 v177, v177
    v_mfma_f32_32x32x16_bf16 v[96:111], v[80:83], v[128:131], v[96:111]
    v_exp_f32 v178, v178
    v_exp_f32 v179, v179
    v_exp_f32 v180, v180
    v_exp_f32 v181, v181
    v_mfma_f32_32x32x16_bf16 v[96:111], v[84:87], v[132:135], v[96:111]
    ds_read_b128 v[80:83], v14 offset:22528
    ds_read_b128 v[84:87], v14 offset:23552
    v_exp_f32 v182, v182
    v_exp_f32 v183, v183
    v_exp_f32 v184, v184
    v_exp_f32 v185, v185
    v_exp_f32 v186, v186
    v_exp_f32 v187, v187
    v_exp_f32 v188, v188
    v_exp_f32 v189, v189
    v_exp_f32 v190, v190
    v_exp_f32 v191, v191
    v_cvt_pk_bf16_f32 v176, v176, v177
    v_cvt_pk_bf16_f32 v177, v178, v179
    v_cvt_pk_bf16_f32 v178, v180, v181
    v_cvt_pk_bf16_f32 v179, v182, v183
    v_cvt_pk_bf16_f32 v180, v184, v185
    v_cvt_pk_bf16_f32 v181, v186, v187
    v_cvt_pk_bf16_f32 v182, v188, v189
    v_cvt_pk_bf16_f32 v183, v190, v191
    v_pk_add_f32 v[192:193], v[192:193], v[58:59] op_sel_hi:[1,0]
    v_pk_add_f32 v[194:195], v[194:195], v[58:59] op_sel_hi:[1,0]
    v_pk_add_f32 v[196:197], v[196:197], v[58:59] op_sel_hi:[1,0]
    v_pk_add_f32 v[198:199], v[198:199], v[58:59] op_sel_hi:[1,0]
    v_pk_add_f32 v[200:201], v[200:201], v[58:59] op_sel_hi:[1,0]
    v_pk_add_f32 v[202:203], v[202:203], v[58:59] op_sel_hi:[1,0]
    v_pk_add_f32 v[204:205], v[204:205], v[58:59] op_sel_hi:[1,0]
    v_pk_add_f32 v[206:207], v[206:207], v[58:59] op_sel_hi:[1,0]
    v_exp_f32 v192, v192
    v_exp_f32 v193, v193
    s_waitcnt lgkmcnt(4)
    v_mfma_f32_32x32x16_bf16 v[96:111], v[64:67], v[176:179], v[96:111]
    v_exp_f32 v194, v194
    v_exp_f32 v195, v195
    v_exp_f32 v196, v196
    v_exp_f32_e64 v197, v197
    v_mfma_f32_32x32x16_bf16 v[96:111], v[68:71], v[180:183], v[96:111]
    ds_read_b128 v[64:67], v14 offset:26624
    ds_read_b128 v[68:71], v14 offset:27648
    v_exp_f32 v198, v198
    v_exp_f32 v199, v199
    v_exp_f32 v200, v200
    v_exp_f32 v201, v201
    v_exp_f32 v202, v202
    v_exp_f32 v203, v203
    v_exp_f32 v204, v204
    v_exp_f32 v205, v205
    v_exp_f32 v206, v206
    v_exp_f32 v207, v207
    v_cvt_pk_bf16_f32 v192, v192, v193
    v_cvt_pk_bf16_f32 v193, v194, v195
    v_cvt_pk_bf16_f32 v194, v196, v197
    v_cvt_pk_bf16_f32 v195, v198, v199
    v_cvt_pk_bf16_f32 v196, v200, v201
    v_cvt_pk_bf16_f32 v197, v202, v203
    v_cvt_pk_bf16_f32 v198, v204, v205
    v_cvt_pk_bf16_f32 v199, v206, v207
    v_pk_add_f32 v[208:209], v[208:209], v[58:59] op_sel_hi:[1,0]
    v_pk_add_f32 v[210:211], v[210:211], v[58:59] op_sel_hi:[1,0]
    v_pk_add_f32 v[212:213], v[212:213], v[58:59] op_sel_hi:[1,0]
    v_pk_add_f32 v[214:215], v[214:215], v[58:59] op_sel_hi:[1,0]
    v_pk_add_f32 v[216:217], v[216:217], v[58:59] op_sel_hi:[1,0]
    v_pk_add_f32 v[218:219], v[218:219], v[58:59] op_sel_hi:[1,0]
    v_pk_add_f32 v[220:221], v[220:221], v[58:59] op_sel_hi:[1,0]
    v_pk_add_f32 v[222:223], v[222:223], v[58:59] op_sel_hi:[1,0]
    v_exp_f32 v208, v208
    v_exp_f32 v209, v209
    s_waitcnt lgkmcnt(4)
    v_mfma_f32_32x32x16_bf16 v[96:111], v[72:75], v[192:195], v[96:111]
    v_exp_f32 v210, v210
    v_exp_f32 v211, v211
    v_exp_f32 v212, v212
    v_exp_f32_e64 v213, v213
    v_mfma_f32_32x32x16_bf16 v[96:111], v[76:79], v[196:199], v[96:111]
    ds_read_b128 v[72:75], v14 offset:30720
    ds_read_b128 v[76:79], v14 offset:31744
    v_exp_f32 v214, v214
    v_exp_f32 v215, v215
    v_exp_f32 v216, v216
    v_exp_f32 v217, v217
    v_exp_f32 v218, v218
    v_exp_f32 v219, v219
    v_exp_f32 v220, v220
    v_exp_f32 v221, v221
    v_exp_f32 v222, v222
    v_exp_f32 v223, v223
    v_cvt_pk_bf16_f32 v208, v208, v209
    v_cvt_pk_bf16_f32 v209, v210, v211
    v_cvt_pk_bf16_f32 v210, v212, v213
    v_cvt_pk_bf16_f32 v211, v214, v215
    v_cvt_pk_bf16_f32 v212, v216, v217
    v_cvt_pk_bf16_f32 v213, v218, v219
    v_cvt_pk_bf16_f32 v214, v220, v221
    v_cvt_pk_bf16_f32 v215, v222, v223
    v_pk_add_f32 v[224:225], v[224:225], v[58:59] op_sel_hi:[1,0]
    v_pk_add_f32 v[226:227], v[226:227], v[58:59] op_sel_hi:[1,0]
    v_pk_add_f32 v[228:229], v[228:229], v[58:59] op_sel_hi:[1,0]
    v_pk_add_f32 v[230:231], v[230:231], v[58:59] op_sel_hi:[1,0]
    v_pk_add_f32 v[232:233], v[232:233], v[58:59] op_sel_hi:[1,0]
    v_pk_add_f32 v[234:235], v[234:235], v[58:59] op_sel_hi:[1,0]
    v_pk_add_f32 v[236:237], v[236:237], v[58:59] op_sel_hi:[1,0]
    v_pk_add_f32 v[238:239], v[238:239], v[58:59] op_sel_hi:[1,0]
    v_exp_f32 v224, v224
    v_exp_f32 v225, v225
    s_waitcnt lgkmcnt(4)
    v_mfma_f32_32x32x16_bf16 v[96:111], v[80:83], v[208:211], v[96:111]
    v_exp_f32 v226, v226
    v_exp_f32 v227, v227
    v_exp_f32 v228, v228
    v_exp_f32 v229, v229
    v_mfma_f32_32x32x16_bf16 v[96:111], v[84:87], v[212:215], v[96:111]
    v_exp_f32 v230, v230
    v_exp_f32 v231, v231
    v_exp_f32 v232, v232
    v_exp_f32 v233, v233
    v_exp_f32 v234, v234
    v_exp_f32 v235, v235
    v_exp_f32 v236, v236
    v_exp_f32 v237, v237
    v_exp_f32 v238, v238
    v_exp_f32_e64 v239, v239
    v_cvt_pk_bf16_f32 v224, v224, v225
    v_cvt_pk_bf16_f32 v225, v226, v227
    v_cvt_pk_bf16_f32 v226, v228, v229
    v_cvt_pk_bf16_f32 v227, v230, v231
    v_cvt_pk_bf16_f32 v228, v232, v233
    v_cvt_pk_bf16_f32 v229, v234, v235
    v_cvt_pk_bf16_f32 v230, v236, v237
    v_cvt_pk_bf16_f32 v231, v238, v239
    v_pk_add_f32 v[240:241], v[240:241], v[58:59] op_sel_hi:[1,0]
    v_pk_add_f32 v[242:243], v[242:243], v[58:59] op_sel_hi:[1,0]
    v_pk_add_f32 v[244:245], v[244:245], v[58:59] op_sel_hi:[1,0]
    v_pk_add_f32 v[246:247], v[246:247], v[58:59] op_sel_hi:[1,0]
    v_pk_add_f32 v[248:249], v[248:249], v[58:59] op_sel_hi:[1,0]
    v_pk_add_f32 v[250:251], v[250:251], v[58:59] op_sel_hi:[1,0]
    v_pk_add_f32 v[252:253], v[252:253], v[58:59] op_sel_hi:[1,0]
    v_pk_add_f32 v[254:255], v[254:255], v[58:59] op_sel_hi:[1,0]
    v_exp_f32 v240, v240
    v_exp_f32 v241, v241
    s_waitcnt lgkmcnt(2)
    v_mfma_f32_32x32x16_bf16 v[96:111], v[64:67], v[224:227], v[96:111]
    v_exp_f32 v242, v242
    v_exp_f32 v243, v243
    v_exp_f32 v244, v244
    v_exp_f32 v245, v245
    v_mfma_f32_32x32x16_bf16 v[96:111], v[68:71], v[228:231], v[96:111]
    v_exp_f32 v246, v246
    v_exp_f32 v247, v247
    v_exp_f32 v248, v248
    v_exp_f32 v249, v249
    v_exp_f32 v250, v250
    v_exp_f32 v251, v251
    v_exp_f32 v252, v252
    v_exp_f32 v253, v253
    v_exp_f32 v254, v254
    v_exp_f32_e64 v255, v255
    v_cvt_pk_bf16_f32 v240, v240, v241
    v_cvt_pk_bf16_f32 v241, v242, v243
    v_cvt_pk_bf16_f32 v242, v244, v245
    v_cvt_pk_bf16_f32 v243, v246, v247
    v_cvt_pk_bf16_f32 v244, v248, v249
    v_cvt_pk_bf16_f32 v245, v250, v251
    v_cvt_pk_bf16_f32 v246, v252, v253
    v_cvt_pk_bf16_f32 v247, v254, v255
    s_waitcnt lgkmcnt(0)
    v_mfma_f32_32x32x16_bf16 v[96:111], v[72:75], v[240:243], v[96:111]
    v_mfma_f32_32x32x16_bf16 v[96:111], v[76:79], v[244:247], v[96:111]
    s_nop 11
    v_mov_b32 v58, v108
    v_mov_b32 v60, v108
    s_add_u32 s65, s57, 8388608
    s_nop 0
    v_permlane32_swap_b32 v58, v60
    v_rcp_f32 v60, v60
    s_nop 0
    v_pk_mul_f32 v[96:97], v[96:97], v[60:61] op_sel_hi:[1,0]
    v_pk_mul_f32 v[98:99], v[98:99], v[60:61] op_sel_hi:[1,0]
    v_pk_mul_f32 v[100:101], v[100:101], v[60:61] op_sel_hi:[1,0]
    v_pk_mul_f32 v[102:103], v[102:103], v[60:61] op_sel_hi:[1,0]
    v_pk_mul_f32 v[104:105], v[104:105], v[60:61] op_sel_hi:[1,0]
    v_pk_mul_f32 v[106:107], v[106:107], v[60:61] op_sel_hi:[1,0]
    v_pk_mul_f32 v[108:109], v[108:109], v[60:61] op_sel_hi:[1,0]
    v_pk_mul_f32 v[110:111], v[110:111], v[60:61] op_sel_hi:[1,0]
    v_cvt_pk_bf16_f32 v96, v96, v97
    v_cvt_pk_bf16_f32 v97, v98, v99
    v_cvt_pk_bf16_f32 v98, v100, v101
    v_cvt_pk_bf16_f32 v99, v102, v103
    v_cvt_pk_bf16_f32 v100, v104, v105
    v_cvt_pk_bf16_f32 v101, v106, v107
    v_cvt_pk_bf16_f32 v102, v108, v109
    v_cvt_pk_bf16_f32 v103, v110, v111
    s_cmp_eq_u32 s53, 0
    s_cbranch_scc1 Lslow_113
    buffer_store_dwordx4 v[96:99], v1, s[8:11], s65 offen offset:0
    buffer_store_dwordx4 v[100:103], v1, s[8:11], s65 offen offset:1024
Ldone_114:
    s_add_u32 s65, s58, 8388608
    s_add_u32 s66, s65, 4096
    s_mov_b32 s55, 0
Lop_115:
    s_nop 0
    buffer_load_dwordx4 v[144:147], v1, s[8:11], s65 offen offset:0 sc1
    buffer_load_dwordx4 v[148:151], v1, s[8:11], s65 offen offset:1024 sc1
    buffer_load_dwordx4 v[152:155], v1, s[8:11], s65 offen offset:2048 sc1
    buffer_load_dwordx4 v[156:159], v1, s[8:11], s65 offen offset:3072 sc1
    buffer_load_dwordx4 v[160:163], v1, s[8:11], s66 offen offset:0 sc1
    buffer_load_dwordx4 v[164:167], v1, s[8:11], s66 offen offset:1024 sc1
    buffer_load_dwordx4 v[168:171], v1, s[8:11], s66 offen offset:2048 sc1
    buffer_load_dwordx4 v[172:175], v1, s[8:11], s66 offen offset:3072 sc1
    s_add_u32 s55, s55, 1
    s_cmp_ge_u32 s55, 200000
    s_cselect_b32 s88, 16384, 0
    s_or_b32 s79, s79, s88
    s_waitcnt vmcnt(6)
    v_max3_u32 v62, v144, v145, v146
    v_max_u32 v62, v147, v62
    v_max3_u32 v62, v148, v149, v62
    v_max3_u32 v62, v150, v151, v62
    s_waitcnt vmcnt(4)
    s_nop 0
    v_max3_u32 v62, v152, v153, v62
    v_max3_u32 v62, v154, v155, v62
    v_max3_u32 v62, v156, v157, v62
    v_max3_u32 v62, v158, v159, v62
    s_waitcnt vmcnt(2)
    s_nop 0
    v_max3_u32 v62, v160, v161, v62
    v_max3_u32 v62, v162, v163, v62
    v_max3_u32 v62, v164, v165, v62
    v_max3_u32 v62, v166, v167, v62
    s_waitcnt vmcnt(0)
    s_nop 0
    v_max3_u32 v62, v168, v169, v62
    v_max3_u32 v62, v170, v171, v62
    v_max3_u32 v62, v172, v173, v62
    v_max3_u32 v62, v174, v175, v62
    v_cmp_eq_u32 vcc, -1, v62
    s_nop 0
    s_cmp_eq_u64 vcc, 0
    s_cselect_b32 s89, 1, s88
    s_cmp_eq_u32 s89, 0
    s_cbranch_scc1 Lop_115
    ds_write_b128 v23, v[144:147] offset:0
    v_mfma_f32_32x32x16_bf16 v[32:47], a[128:131], v[144:147], v[32:47]
    ds_write_b128 v23, v[148:151] offset:1024
    v_mfma_f32_32x32x16_bf16 v[32:47], a[132:135], v[148:151], v[32:47]
    ds_write_b128 v23, v[152:155] offset:2048
    v_mfma_f32_32x32x16_bf16 v[32:47], a[136:139], v[152:155], v[32:47]
    ds_write_b128 v23, v[156:159] offset:3072
    v_mfma_f32_32x32x16_bf16 v[32:47], a[140:143], v[156:159], v[32:47]
    ds_write_b128 v23, v[160:163] offset:4096
    v_mfma_f32_32x32x16_bf16 v[32:47], a[144:147], v[160:163], v[32:47]
    ds_write_b128 v23, v[164:167] offset:5120
    v_mfma_f32_32x32x16_bf16 v[32:47], a[148:151], v[164:167], v[32:47]
    ds_write_b128 v23, v[168:171] offset:6144
    ds_write_b128 v23, v[172:175] offset:7168
    s_waitcnt lgkmcnt(0)
    s_barrier
    ds_read_b128 v[64:67], v16 offset:0
    ds_read_b128 v[68:71], v16 offset:1024
    ds_read_b128 v[72:75], v16 offset:2048
    ds_read_b128 v[76:79], v16 offset:3072
    v_mfma_f32_32x32x16_bf16 v[32:47], a[152:155], v[168:171], v[32:47]
    v_mfma_f32_32x32x16_bf16 v[32:47], a[156:159], v[172:175], v[32:47]
    ds_read_b128 v[80:83], v16 offset:4096
    ds_read_b128 v[84:87], v16 offset:5120
    ds_read_b128 v[88:91], v16 offset:6144
    ds_read_b128 v[92:95], v16 offset:7168
    s_waitcnt lgkmcnt(7)
    v_mfma_f32_32x32x16_bf16 v[32:47], a[160:163], v[64:67], v[32:47]
    ds_read_b128 v[176:179], v17 offset:0
    s_waitcnt lgkmcnt(7)
    v_mfma_f32_32x32x16_bf16 v[32:47], a[164:167], v[68:71], v[32:47]
    ds_read_b128 v[180:183], v17 offset:1024
    s_waitcnt lgkmcnt(7)
    v_mfma_f32_32x32x16_bf16 v[32:47], a[168:171], v[72:75], v[32:47]
    ds_read_b128 v[184:187], v17 offset:2048
    s_waitcnt lgkmcnt(7)
    v_mfma_f32_32x32x16_bf16 v[32:47], a[172:175], v[76:79], v[32:47]
    ds_read_b128 v[188:191], v17 offset:3072
    s_waitcnt lgkmcnt(7)
    v_mfma_f32_32x32x16_bf16 v[32:47], a[176:179], v[80:83], v[32:47]
    ds_read_b128 v[192:195], v17 offset:4096
    s_waitcnt lgkmcnt(7)
    v_mfma_f32_32x32x16_bf16 v[32:47], a[180:183], v[84:87], v[32:47]
    ds_read_b128 v[196:199], v17 offset:5120
    s_waitcnt lgkmcnt(7)
    v_mfma_f32_32x32x16_bf16 v[32:47], a[184:187], v[88:91], v[32:47]
    ds_read_b128 v[200:203], v17 offset:6144
    s_waitcnt lgkmcnt(7)
    v_mfma_f32_32x32x16_bf16 v[32:47], a[188:191], v[92:95], v[32:47]
    ds_read_b128 v[204:207], v17 offset:7168
    s_waitcnt lgkmcnt(7)
    v_mfma_f32_32x32x16_bf16 v[32:47], a[192:195], v[176:179], v[32:47]
    ds_read_b128 v[208:211], v18 offset:0
    s_waitcnt lgkmcnt(7)
    v_mfma_f32_32x32x16_bf16 v[32:47], a[196:199], v[180:183], v[32:47]
    ds_read_b128 v[212:215], v18 offset:1024
    s_waitcnt lgkmcnt(7)
    v_mfma_f32_32x32x16_bf16 v[32:47], a[200:203], v[184:187], v[32:47]
    ds_read_b128 v[216:219], v18 offset:2048
    s_waitcnt lgkmcnt(7)
    v_mfma_f32_32x32x16_bf16 v[32:47], a[204:207], v[188:191], v[32:47]
    ds_read_b128 v[220:223], v18 offset:3072
    s_waitcnt lgkmcnt(7)
    v_mfma_f32_32x32x16_bf16 v[32:47], a[208:211], v[192:195], v[32:47]
    ds_read_b128 v[224:227], v18 offset:4096
    s_waitcnt lgkmcnt(7)
    v_mfma_f32_32x32x16_bf16 v[32:47], a[212:215], v[196:199], v[32:47]
    ds_read_b128 v[228:231], v18 offset:5120
    s_waitcnt lgkmcnt(7)
    v_mfma_f32_32x32x16_bf16 v[32:47], a[216:219], v[200:203], v[32:47]
    ds_read_b128 v[232:235], v18 offset:6144
    s_waitcnt lgkmcnt(7)
    v_mfma_f32_32x32x16_bf16 v[32:47], a[220:223], v[204:207], v[32:47]
    ds_read_b128 v[236:239], v18 offset:7168
    s_waitcnt lgkmcnt(7)
    v_mfma_f32_32x32x16_bf16 v[32:47], a[224:227], v[208:211], v[32:47]
    s_waitcnt lgkmcnt(6)
    v_mfma_f32_32x32x16_bf16 v[32:47], a[228:231], v[212:215], v[32:47]
    s_waitcnt lgkmcnt(5)
    v_mfma_f32_32x32x16_bf16 v[32:47], a[232:235], v[216:219], v[32:47]
    s_waitcnt lgkmcnt(4)
    v_mfma_f32_32x32x16_bf16 v[32:47], a[236:239], v[220:223], v[32:47]
    s_waitcnt lgkmcnt(3)
    v_mfma_f32_32x32x16_bf16 v[32:47], a[240:243], v[224:227], v[32:47]
    s_waitcnt lgkmcnt(2)
    v_mfma_f32_32x32x16_bf16 v[32:47], a[244:247], v[228:231], v[32:47]
    s_waitcnt lgkmcnt(1)
    v_mfma_f32_32x32x16_bf16 v[32:47], a[248:251], v[232:235], v[32:47]
    s_waitcnt lgkmcnt(0)
    v_mfma_f32_32x32x16_bf16 v[32:47], a[252:255], v[236:239], v[32:47]
    s_nop 11
    s_nop 0
    v_cvt_pk_bf16_f32 v112, v32, v33
    v_cvt_pk_bf16_f32 v113, v34, v35
    v_cvt_pk_bf16_f32 v114, v36, v37
    v_cvt_pk_bf16_f32 v115, v38, v39
    v_cvt_pk_bf16_f32 v116, v40, v41
    v_cvt_pk_bf16_f32 v117, v42, v43
    v_cvt_pk_bf16_f32 v118, v44, v45
    v_cvt_pk_bf16_f32 v119, v46, v47
    buffer_store_dwordx2 v[112:113], v15, s[36:39], 0 offen offset:0
    buffer_store_dwordx2 v[114:115], v15, s[36:39], 0 offen offset:16
    buffer_store_dwordx2 v[116:117], v15, s[36:39], 0 offen offset:32
    s_mov_b32 exec_hi, 0
    buffer_store_dwordx2 v[118:119], v15, s[36:39], 0 offen offset:48
    s_mov_b32 exec_hi, -1
Lend:
    s_endpgm
Lfe_6:
    s_sleep 2
    buffer_load_dwordx2 v[80:81], v82, s[40:43], 0 offen sc1
    s_add_u32 s55, s55, 1
    s_waitcnt vmcnt(0)
    s_cmp_lt_u32 s55, 200000
    s_cbranch_scc1 Lfe_7
    s_or_b32 s79, s79, 536870912
    s_branch Lfe_8
Lfr_16:
    s_add_u32 s55, s55, 1
    s_cmp_ge_u32 s55, 200000
    s_cselect_b32 s88, 1073741824, 0
    s_or_b32 s79, s79, s88
    s_cmp_lg_u32 s88, 0
    s_cbranch_scc1 Lgo_17
    s_sleep 4
    s_mov_b32 s3, 25952256
    buffer_load_dwordx4 v[96:99], v104, s[8:11], s3 offen sc1
    buffer_load_dwordx4 v[100:103], v104, s[8:11], s3 offen offset:16 sc1
    s_waitcnt vmcnt(0)
    s_branch Lfp_15
Lslow_18:
    buffer_store_dwordx4 v[108:111], v1, s[8:11], s65 offen offset:0 sc1
    buffer_store_dwordx4 v[108:111], v1, s[8:11], s65 offen offset:1024 sc1
    s_nop 0
    s_branch Ldone_19
Lslow_26:
    s_add_u32 s65, s57, 0
    s_nop 0
    buffer_store_dwordx4 v[124:127], v1, s[8:11], s65 offen offset:0 sc1
    buffer_store_dwordx4 v[124:127], v1, s[8:11], s65 offen offset:1024 sc1
    s_add_u32 s65, s57, 8388608
    buffer_store_dwordx4 v[124:127], v1, s[8:11], s65 offen offset:0 sc1
    buffer_store_dwordx4 v[124:127], v1, s[8:11], s65 offen offset:1024 sc1
    s_add_u32 s65, s57, 2097152
    buffer_store_dwordx4 v[124:127], v1, s[8:11], s65 offen offset:0 sc1
    buffer_store_dwordx4 v[124:127], v1, s[8:11], s65 offen offset:1024 sc1
    s_nop 0
    s_branch Ldone_27
Lslow_37:
    buffer_store_dwordx4 v[96:99], v1, s[8:11], s65 offen offset:0 sc1
    buffer_store_dwordx4 v[100:103], v1, s[8:11], s65 offen offset:1024 sc1
    s_nop 0
    s_branch Ldone_38
Lfr_40:
    s_add_u32 s55, s55, 1
    s_cmp_ge_u32 s55, 200000
    s_cselect_b32 s88, 1073741824, 0
    s_or_b32 s79, s79, s88
    s_cmp_lg_u32 s88, 0
    s_cbranch_scc1 Lgo_41
    s_sleep 4
    s_mov_b32 s3, 25956352
    buffer_load_dwordx4 v[160:163], v168, s[8:11], s3 offen sc1
    buffer_load_dwordx4 v[164:167], v168, s[8:11], s3 offen offset:16 sc1
    s_waitcnt vmcnt(0)
    s_branch Lfp_39
Lslow_44:
    buffer_store_dwordx2 v[112:113], v7, s[8:11], s65 offen offset:0 sc1
    buffer_store_dwordx2 v[114:115], v7, s[8:11], s65 offen offset:512 sc1
    buffer_store_dwordx2 v[116:117], v7, s[8:11], s65 offen offset:1024 sc1
    s_mov_b32 exec_hi, 0
    buffer_store_dwordx2 v[118:119], v7, s[8:11], s65 offen offset:1536 sc1
    s_mov_b32 exec_hi, -1
    s_branch Ldone_45
Lslow_47:
    s_mov_b32 exec_hi, 0
    buffer_store_dwordx2 v[120:121], v8, s[8:11], s66 offen offset:0 sc1
    s_mov_b32 exec_hi, -1
    s_branch Ldone_48
Lsr_52:
    s_add_u32 s66, s65, 28672
    buffer_load_dwordx4 v[96:99], v1, s[8:11], s66 offen sc1
    s_add_u32 s55, s55, 1
    s_cmp_ge_u32 s55, 200000
    s_cselect_b32 s88, 128, 0
    s_or_b32 s79, s79, s88
    s_waitcnt vmcnt(0)
    v_max3_u32 v62, v96, v97, v98
    v_max_u32 v62, v99, v62
    v_cmp_eq_u32 vcc, -1, v62
    s_nop 0
    s_cmp_eq_u64 vcc, 0
    s_cselect_b32 s89, 1, s88
    s_cmp_eq_u32 s89, 0
    s_cbranch_scc1 Lsr_52
    s_branch Lsb_53
Lgbad_54:
    s_nop 15
    s_waitcnt lgkmcnt(0)
    v_mov_b32 v60, 0
    v_mov_b32 v61, 0
    s_add_u32 s55, s55, 8
    s_cmp_lt_u32 s55, 200000
    s_cbranch_scc1 Lg_50
    s_or_b32 s79, s79, 128
    s_branch Lgok_51
Lslow_59:
    s_add_u32 s68, s57, 6291456
    buffer_store_dwordx4 v[104:107], v1, s[8:11], s68 offen offset:0 sc1
    buffer_store_dwordx4 v[104:107], v1, s[8:11], s68 offen offset:1024 sc1
    s_nop 0
    s_branch Ldone_60
Lslow_64:
    buffer_store_dwordx4 v[96:99], v1, s[8:11], s65 offen offset:0 sc1
    buffer_store_dwordx4 v[100:103], v1, s[8:11], s65 offen offset:1024 sc1
    s_nop 0
    s_branch Ldone_65
Lslow_68:
    buffer_store_dwordx2 v[112:113], v7, s[8:11], s65 offen offset:0 sc1
    buffer_store_dwordx2 v[114:115], v7, s[8:11], s65 offen offset:512 sc1
    buffer_store_dwordx2 v[116:117], v7, s[8:11], s65 offen offset:1024 sc1
    s_mov_b32 exec_hi, 0
    buffer_store_dwordx2 v[118:119], v7, s[8:11], s65 offen offset:1536 sc1
    s_mov_b32 exec_hi, -1
    s_branch Ldone_69
Lslow_71:
    s_mov_b32 exec_hi, 0
    buffer_store_dwordx2 v[120:121], v8, s[8:11], s66 offen offset:0 sc1
    s_mov_b32 exec_hi, -1
    s_branch Ldone_72
Lsr_76:
    s_add_u32 s66, s65, 28672
    buffer_load_dwordx4 v[96:99], v1, s[8:11], s66 offen sc1
    s_add_u32 s55, s55, 1
    s_cmp_ge_u32 s55, 200000
    s_cselect_b32 s88, 2048, 0
    s_or_b32 s79, s79, s88
    s_waitcnt vmcnt(0)
    v_max3_u32 v62, v96, v97, v98
    v_max_u32 v62, v99, v62
    v_cmp_eq_u32 vcc, -1, v62
    s_nop 0
    s_cmp_eq_u64 vcc, 0
    s_cselect_b32 s89, 1, s88
    s_cmp_eq_u32 s89, 0
    s_cbranch_scc1 Lsr_76
    s_branch Lsb_77
Lgbad_78:
    s_nop 15
    s_waitcnt lgkmcnt(0)
    v_mov_b32 v60, 0
    v_mov_b32 v61, 0
    s_add_u32 s55, s55, 8
    s_cmp_lt_u32 s55, 200000
    s_cbranch_scc1 Lg_74
    s_or_b32 s79, s79, 2048
    s_branch Lgok_75
Lslow_80:
    s_add_u32 s65, s57, 0
    s_nop 0
    buffer_store_dwordx4 v[124:127], v1, s[8:11], s65 offen offset:0 sc1
    buffer_store_dwordx4 v[124:127], v1, s[8:11], s65 offen offset:1024 sc1
    s_add_u32 s65, s57, 8388608
    buffer_store_dwordx4 v[124:127], v1, s[8:11], s65 offen offset:0 sc1
    buffer_store_dwordx4 v[124:127], v1, s[8:11], s65 offen offset:1024 sc1
    s_nop 0
    s_branch Ldone_81
Lslow_91:
    buffer_store_dwordx4 v[96:99], v1, s[8:11], s65 offen offset:0 sc1
    buffer_store_dwordx4 v[100:103], v1, s[8:11], s65 offen offset:1024 sc1
    s_nop 0
    s_branch Ldone_92
Lslow_95:
    buffer_store_dwordx2 v[112:113], v7, s[8:11], s65 offen offset:0 sc1
    buffer_store_dwordx2 v[114:115], v7, s[8:11], s65 offen offset:512 sc1
    buffer_store_dwordx2 v[116:117], v7, s[8:11], s65 offen offset:1024 sc1
    s_mov_b32 exec_hi, 0
    buffer_store_dwordx2 v[118:119], v7, s[8:11], s65 offen offset:1536 sc1
    s_mov_b32 exec_hi, -1
    s_branch Ldone_96
Lslow_98:
    s_mov_b32 exec_hi, 0
    buffer_store_dwordx2 v[120:121], v8, s[8:11], s66 offen offset:0 sc1
    s_mov_b32 exec_hi, -1
    s_branch Ldone_99
Lsr_103:
    s_add_u32 s66, s65, 28672
    buffer_load_dwordx4 v[96:99], v1, s[8:11], s66 offen sc1
    s_add_u32 s55, s55, 1
    s_cmp_ge_u32 s55, 200000
    s_cselect_b32 s88, 32768, 0
    s_or_b32 s79, s79, s88
    s_waitcnt vmcnt(0)
    v_max3_u32 v62, v96, v97, v98
    v_max_u32 v62, v99, v62
    v_cmp_eq_u32 vcc, -1, v62
    s_nop 0
    s_cmp_eq_u64 vcc, 0
    s_cselect_b32 s89, 1, s88
    s_cmp_eq_u32 s89, 0
    s_cbranch_scc1 Lsr_103
    s_branch Lsb_104
Lgbad_105:
    s_nop 15
    s_waitcnt lgkmcnt(0)
    v_mov_b32 v60, 0
    v_mov_b32 v61, 0
    s_add_u32 s55, s55, 8
    s_cmp_lt_u32 s55, 200000
    s_cbranch_scc1 Lg_101
    s_or_b32 s79, s79, 32768
    s_branch Lgok_102
Lslow_113:
    buffer_store_dwordx4 v[96:99], v1, s[8:11], s65 offen offset:0 sc1
    buffer_store_dwordx4 v[100:103], v1, s[8:11], s65 offen offset:1024 sc1
    s_nop 0
    s_branch Ldone_114
Lcode_end:
.section .rodata,"a"
.p2align 6
.amdhsa_kernel interleave_layers__linear_kernel_hedgehog__sliding_block__prompt_kernel
  .amdhsa_next_free_vgpr 512
  .amdhsa_next_free_sgpr 102
  .amdhsa_accum_offset 256
  .amdhsa_group_segment_fixed_size 0
  .amdhsa_kernarg_size 80
  .amdhsa_user_sgpr_count 2
  .amdhsa_user_sgpr_kernarg_segment_ptr 1
  .amdhsa_system_sgpr_workgroup_id_x 1
.end_amdhsa_kernel
```
